```python
import torch

def _softmax(x, axis=-1):
    return torch.softmax(x, dim=axis)
def _gelu(x):
    return torch.nn.functional.gelu(x, approximate="tanh")
def _silu(x):
    return torch.nn.functional.silu(x)
def _sigmoid(x):
    return torch.sigmoid(x)
def _layernorm(x, axis=-1, eps=1e-5):
    m = x.mean(dim=axis, keepdim=True)
    v = x.var(dim=axis, keepdim=True, unbiased=False)
    return (x - m) / torch.sqrt(v + eps)
def _scatter_add(tgt, idx, src, axis=0):
    return tgt.clone().index_add_(axis, idx, src)
def _segment_sum(src, seg, n):
    out = torch.zeros((n,) + src.shape[1:], dtype=src.dtype)
    return out.index_add_(0, seg, src)
def _pad(x, pw):
    flat = tuple(v for pair in reversed(pw) for v in pair)
    return torch.nn.functional.pad(x, flat)

kernel_name = 'interleave_layers__softmax_full_mha__dense_activation_silu__prompt'

def setup_inputs():

    _w = (lambda a: (lambda t: t.to(torch.bfloat16) if t.is_floating_point() else t)(torch.as_tensor(a)))
    def _A_setup():
        B, S, D = 1, 2048, 448
        return {
            "x": _w((lambda *s: torch.randn(*s, dtype=torch.bfloat16) * 0.05)(B, S, D)),
            "wqkv": _w((lambda *s: torch.randn(*s, dtype=torch.bfloat16) * 0.05)(D, 3 * D)),
            "wo": _w((lambda *s: torch.randn(*s, dtype=torch.bfloat16) * 0.05)(D, D)),
        }
    _A_in = _A_setup()

    def _B_setup():
        B, S, D, F = 1, 2048, 448, 1792
        return {
            "x": _w((lambda *s: torch.randn(*s, dtype=torch.bfloat16) * 0.05)(B, S, D)),
            "w1": _w((lambda *s: torch.randn(*s, dtype=torch.bfloat16) * 1.6)(D, F) * (D ** -0.5)),
            "w2": _w((lambda *s: torch.randn(*s, dtype=torch.bfloat16) * 0.2)(F, D) * (F ** -0.5)),
        }
    _B_in = _B_setup()

    return {
        "A_x": _A_in["x"],
        "A_wqkv": _A_in["wqkv"],
        "A_wo": _A_in["wo"],
        "B_x": _B_in["x"],
        "B_w1": _B_in["w1"],
        "B_w2": _B_in["w2"],
    }

def reference(A_x, A_wqkv, A_wo, B_x, B_w1, B_w2):
    def _A_ref(x, wqkv, wo):
        B, S, D = x.shape
        H = 16; Dh = D // H
        qkv = (lambda x, *d: x.permute(*d))((x @ wqkv).reshape(B, S, 3, H, Dh), 2, 0, 3, 1, 4)
        q, k, v = qkv[0], qkv[1], qkv[2]
        scale = Dh ** -0.5
        scores = torch.einsum("bhqd,bhkd->bhqk", q, k) * scale
        p = _softmax(scores, axis=-1)
        o = torch.einsum("bhqk,bhkd->bhqd", p, v)
        return (lambda x, *d: x.permute(*d))(o, 0, 2, 1, 3).reshape(B, S, D) @ wo

    def _B_ref(x, w1, w2):
        h = torch.einsum("bsd,df->bsf", x, w1)
        h = _silu(h)
        out = torch.einsum("bsf,fd->bsd", h, w2)
        return out

    x = A_x
    x = x + _A_ref(_layernorm(x, axis=-1), A_wqkv, A_wo)
    x = x + _B_ref(_layernorm(x, axis=-1), B_w1, B_w2)
    x = x + _A_ref(_layernorm(x, axis=-1), A_wqkv, A_wo)
    x = x + _B_ref(_layernorm(x, axis=-1), B_w1, B_w2)
    return x
```

```asm
; @launch grid=(256,1,1) block=(256,1,1) lds=163840
.amdgcn_target "amdgcn-amd-amdhsa--gfx950"
.text
.globl interleave_layers__softmax_full_mha__dense_activation_silu__prompt_kernel
.p2align 8
.type interleave_layers__softmax_full_mha__dense_activation_silu__prompt_kernel,@function
interleave_layers__softmax_full_mha__dense_activation_silu__prompt_kernel:
s_cmp_ge_u32 s2, 256
s_cbranch_scc1 interleave_layers__softmax_full_mha__dense_activation_silu__prompt_kernel_end
s_load_dwordx4 s[20:23], s[0:1], 0
s_load_dwordx2 s[24:25], s[0:1], 16
s_load_dwordx4 s[28:31], s[0:1], 32
s_load_dwordx4 s[32:35], s[0:1], 48
s_load_dwordx2 s[36:37], s[0:1], 64
v_lshrrev_b32 v17, 6, v0
v_and_b32 v0, 63, v0
v_readfirstlane_b32 s14, v17
v_lshlrev_b32 v1, 4, v0
v_lshrrev_b32 v2, 5, v0
v_and_b32 v3, 31, v0
s_waitcnt lgkmcnt(0)
s_mov_b32 s56, s20
s_mov_b32 s57, s21
s_mov_b32 s58, 1835008
s_mov_b32 s59, 0x00020000
s_mov_b32 s60, s22
s_mov_b32 s61, s23
s_mov_b32 s62, 1204224
s_mov_b32 s63, 0x00020000
s_mov_b32 s64, s24
s_mov_b32 s65, s25
s_mov_b32 s66, 401408
s_mov_b32 s67, 0x00020000
s_mov_b32 s68, s28
s_mov_b32 s69, s29
s_mov_b32 s70, 1605632
s_mov_b32 s71, 0x00020000
s_mov_b32 s72, s30
s_mov_b32 s73, s31
s_mov_b32 s74, 1605632
s_mov_b32 s75, 0x00020000
s_mov_b32 s8, s32
s_mov_b32 s9, s33
s_mov_b32 s10, 1835008
s_mov_b32 s11, 0x00020000
s_mov_b32 s76, s34
s_mov_b32 s77, s35
s_mov_b32 s78, 256
s_mov_b32 s79, 0x00020000
s_mov_b32 s4, s36
s_mov_b32 s5, s37
s_mov_b32 s6, 268435456
s_mov_b32 s7, 0x00020000
s_getreg_b32 s30, hwreg(HW_REG_XCC_ID, 0, 4)
s_and_b32 s30, s30, 7
s_cmp_eq_u32 s14, 0
s_cbranch_scc1 Lep_4
s_barrier
s_cmp_lg_u32 s14, 1
s_cbranch_scc1 Lrt_5
s_cmp_lg_u32 s2, 0
s_cbranch_scc1 Lrt_5
v_mov_b32 v20, 98304
s_mov_b64 exec, 1
buffer_load_dword v22, v20, s[4:7], 0 offen sc1
s_waitcnt vmcnt(0)
v_add_u32 v23, 0x1000, v22
v_mov_b32 v22, 1
v_mov_b32 v21, 8
buffer_store_dwordx2 v[22:23], v21, s[76:79], 0 offen sc1
buffer_store_dword v23, v20, s[4:7], 0 offen sc1
s_mov_b64 exec, -1
Lrt_5:
v_lshlrev_b32 v24, 7, v0
v_min_u32 v26, 4224, v24
v_min_u32 v27, 2304, v24
s_lshr_b32 s26, s2, 3
s_and_b32 s26, s26, 31
s_and_b32 s27, s2, 7
s_lshl_b32 s27, s27, 2
s_mul_i32 s28, s26, 5
s_add_u32 s27, s27, s28
s_add_u32 s27, s27, 11
s_and_b32 s27, s27, 31
s_mul_i32 s29, s26, 3
s_add_u32 s29, s29, s14
s_sub_u32 s29, s29, 1
s_mul_i32 s28, s29, 12544
buffer_load_dword v25, v24, s[60:63], s28 offen
s_add_u32 s28, s28, 8192
buffer_load_dword v25, v26, s[60:63], s28 offen
s_mul_i32 s28, s30, 229376
s_mul_i32 s29, s29, 2432
s_add_u32 s28, s28, s29
buffer_load_dword v25, v27, s[56:59], s28 offen
s_mul_i32 s29, s27, 3
s_add_u32 s29, s29, s14
s_sub_u32 s29, s29, 1
s_mul_i32 s28, s29, 12544
buffer_load_dword v25, v24, s[60:63], s28 offen
s_add_u32 s28, s28, 8192
buffer_load_dword v25, v26, s[60:63], s28 offen
s_mul_i32 s28, s30, 229376
s_mul_i32 s29, s29, 2432
s_add_u32 s28, s28, s29
buffer_load_dword v25, v27, s[56:59], s28 offen
s_branch Lrole_1
Lep_4:
s_lshl_b32 s31, s30, 5
v_mov_b32 v20, s31
v_mov_b32 v21, 1
s_mov_b64 exec, 1
buffer_atomic_add v21, v20, s[76:79], 0 offen sc0 sc1
s_mov_b64 exec, -1
s_barrier
s_lshr_b32 s26, s2, 3
s_getpc_b64 s[28:29]
Lpc_6:
s_sub_u32 s28, s28, Lpc_6-interleave_layers__softmax_full_mha__dense_activation_silu__prompt_kernel
s_subb_u32 s29, s29, 0
s_and_b32 s27, s26, 7
s_lshl_b32 s27, s27, 13
v_lshlrev_b32 v26, 7, v0
v_add_u32 v26, s27, v26
v_min_u32 v26, interleave_layers__softmax_full_mha__dense_activation_silu__prompt_kernel_end-interleave_layers__softmax_full_mha__dense_activation_silu__prompt_kernel, v26
global_load_dword v25, v26, s[28:29]
s_mov_b64 exec, 1
s_waitcnt vmcnt(1)
v_readfirstlane_b32 s31, v21
s_nop 0
s_cmp_ge_u32 s31, 32
s_cbranch_scc1 Lovf_2
Lgot_3:
s_lshl_b32 s30, s30, 5
s_add_u32 s30, s30, s31
v_mov_b32 v21, s30
v_mov_b32 v20, 161792
ds_write_b32 v20, v21
s_waitcnt lgkmcnt(0)
s_mov_b64 exec, -1
Lrole_1:
s_barrier
v_mov_b32 v20, 161792
ds_read_b32 v21, v20
s_waitcnt lgkmcnt(0)
v_readfirstlane_b32 s30, v21
s_nop 0
s_cmp_ge_u32 s30, 256
s_cbranch_scc1 interleave_layers__softmax_full_mha__dense_activation_silu__prompt_kernel_end
s_lshr_b32 s24, s30, 5
s_mov_b32 s53, s24
s_lshl_b32 s24, s24, 1
s_and_b32 s25, s30, 1
s_or_b32 s12, s24, s25
s_and_b32 s24, s30, 31
s_lshr_b32 s13, s24, 1
s_branch Lrole2_7
Lovf_2:
v_mov_b32 v20, 16
v_mov_b32 v21, 1
buffer_atomic_add v21, v20, s[76:79], 0 offen sc0 sc1
s_waitcnt vmcnt(0)
v_readfirstlane_b32 s26, v21
s_mov_b32 s27, 0
Lovp_8:
s_mov_b64 exec, 0xff
v_lshlrev_b32 v20, 5, v0
buffer_load_dword v21, v20, s[76:79], 0 offen sc1
s_waitcnt vmcnt(0)
s_mov_b32 s28, 0
v_readlane_b32 s80, v21, 0
v_readlane_b32 s81, v21, 1
v_readlane_b32 s82, v21, 2
v_readlane_b32 s83, v21, 3
v_readlane_b32 s84, v21, 4
v_readlane_b32 s85, v21, 5
v_readlane_b32 s86, v21, 6
v_readlane_b32 s87, v21, 7
s_add_u32 s28, s28, s80
s_add_u32 s28, s28, s81
s_add_u32 s28, s28, s82
s_add_u32 s28, s28, s83
s_add_u32 s28, s28, s84
s_add_u32 s28, s28, s85
s_add_u32 s28, s28, s86
s_add_u32 s28, s28, s87
s_add_u32 s27, s27, 1
s_cmp_gt_u32 s27, 0x400000
s_cbranch_scc1 Lovn_9
s_cmp_lt_u32 s28, 256
s_cbranch_scc1 Lovp_8
s_mov_b32 s30, 0
s_mov_b32 s31, 0
s_min_u32 s28, s80, 32
s_sub_u32 s29, 32, s28
s_cmp_lt_u32 s26, s29
s_cbranch_scc0 Lovx_10
s_mov_b32 s30, 0
s_add_u32 s31, s28, s26
s_mov_b64 exec, 1
s_branch Lgot_3
Lovx_10:
s_sub_u32 s26, s26, s29
s_min_u32 s28, s81, 32
s_sub_u32 s29, 32, s28
s_cmp_lt_u32 s26, s29
s_cbranch_scc0 Lovx_11
s_mov_b32 s30, 1
s_add_u32 s31, s28, s26
s_mov_b64 exec, 1
s_branch Lgot_3
Lovx_11:
s_sub_u32 s26, s26, s29
s_min_u32 s28, s82, 32
s_sub_u32 s29, 32, s28
s_cmp_lt_u32 s26, s29
s_cbranch_scc0 Lovx_12
s_mov_b32 s30, 2
s_add_u32 s31, s28, s26
s_mov_b64 exec, 1
s_branch Lgot_3
Lovx_12:
s_sub_u32 s26, s26, s29
s_min_u32 s28, s83, 32
s_sub_u32 s29, 32, s28
s_cmp_lt_u32 s26, s29
s_cbranch_scc0 Lovx_13
s_mov_b32 s30, 3
s_add_u32 s31, s28, s26
s_mov_b64 exec, 1
s_branch Lgot_3
Lovx_13:
s_sub_u32 s26, s26, s29
s_min_u32 s28, s84, 32
s_sub_u32 s29, 32, s28
s_cmp_lt_u32 s26, s29
s_cbranch_scc0 Lovx_14
s_mov_b32 s30, 4
s_add_u32 s31, s28, s26
s_mov_b64 exec, 1
s_branch Lgot_3
Lovx_14:
s_sub_u32 s26, s26, s29
s_min_u32 s28, s85, 32
s_sub_u32 s29, 32, s28
s_cmp_lt_u32 s26, s29
s_cbranch_scc0 Lovx_15
s_mov_b32 s30, 5
s_add_u32 s31, s28, s26
s_mov_b64 exec, 1
s_branch Lgot_3
Lovx_15:
s_sub_u32 s26, s26, s29
s_min_u32 s28, s86, 32
s_sub_u32 s29, 32, s28
s_cmp_lt_u32 s26, s29
s_cbranch_scc0 Lovx_16
s_mov_b32 s30, 6
s_add_u32 s31, s28, s26
s_mov_b64 exec, 1
s_branch Lgot_3
Lovx_16:
s_sub_u32 s26, s26, s29
s_min_u32 s28, s87, 32
s_sub_u32 s29, 32, s28
s_cmp_lt_u32 s26, s29
s_cbranch_scc0 Lovx_17
s_mov_b32 s30, 7
s_add_u32 s31, s28, s26
s_mov_b64 exec, 1
s_branch Lgot_3
Lovx_17:
s_sub_u32 s26, s26, s29
Lovn_9:
s_mov_b32 s30, 8
s_mov_b32 s31, 0
s_mov_b64 exec, 1
s_branch Lgot_3
Lrole2_7:
s_min_u32 s24, s13, 13
s_cmp_ge_u32 s24, 7
s_cselect_b32 s17, 1, 0
s_mul_i32 s25, s17, 7
s_sub_u32 s18, s24, s25
s_lshl_b32 s19, s12, 2
s_add_u32 s19, s19, s14
s_lshl_b32 s24, s12, 2
s_lshl_b32 s25, s17, 1
s_add_u32 s24, s24, s25
s_lshr_b32 s25, s14, 1
s_add_u32 s50, s24, s25
s_lshl_b32 s24, s18, 1
s_and_b32 s25, s14, 1
s_add_u32 s51, s24, s25
s_mov_b32 s40, 0x10000000
s_mov_b32 s41, 0x10000000
s_mov_b32 s42, 0
s_mov_b32 s43, -1
s_mov_b32 s15, 0
s_mov_b32 s52, 0
s_lshl_b32 s34, s13, 2
s_add_u32 s34, s34, s14
s_lshl_b32 s26, s12, 7
s_lshl_b32 s27, s34, 1
s_add_u32 s26, s26, s27
s_mul_i32 s26, s26, 896
v_mov_b32 v62, 1073741824
v_cmp_gt_u32 vcc, 56, v0
s_nop 1
v_cndmask_b32 v61, v62, v1, vcc
buffer_load_dwordx4 v[24:27], v61, s[56:59], s26 offen
buffer_load_dwordx4 v[28:31], v61, s[56:59], s26 offen offset:896
v_lshrrev_b32 v63, 1, v0
v_lshlrev_b32 v63, 10, v63
v_and_b32 v64, 1, v0
v_lshlrev_b32 v64, 9, v64
v_add_u32 v63, v63, v64
v_cndmask_b32 v63, v62, v63, vcc
s_lshr_b32 s35, s34, 4
s_lshl_b32 s27, s12, 2
s_add_u32 s35, s35, s27
s_mul_i32 s37, s35, 28672
s_and_b32 s27, s34, 15
s_lshl_b32 s27, s27, 5
s_add_u32 s37, s37, s27
s_add_u32 s37, s37, 8388608
buffer_load_dword v65, v63, s[4:7], s37 offen sc1
v_lshrrev_b32 v15, 2, v0
v_mul_u32_u24 v15, 2688, v15
v_and_b32 v14, 3, v0
v_lshlrev_b32 v14, 4, v14
v_add_u32 v15, v15, v14
s_mul_i32 s22, s13, 56
s_mul_i32 s23, s14, 301056
s_add_u32 s22, s22, s23
s_add_u32 s20, s22, 896
s_add_u32 s21, s22, 1792
s_mul_i32 s23, s14, 7168
s_add_u32 s23, s23, 0
s_add_u32 m0, s23, 0
s_nop 0
buffer_load_dwordx4 v15, s[60:63], s20 offen lds
s_add_u32 m0, s23, 28672
s_nop 0
buffer_load_dwordx4 v15, s[60:63], s21 offen lds
s_add_u32 s20, s20, 43008
s_add_u32 s21, s21, 43008
s_add_u32 s23, s23, 1024
s_add_u32 m0, s23, 0
s_nop 0
buffer_load_dwordx4 v15, s[60:63], s20 offen lds
s_add_u32 m0, s23, 28672
s_nop 0
buffer_load_dwordx4 v15, s[60:63], s21 offen lds
s_add_u32 s20, s20, 43008
s_add_u32 s21, s21, 43008
s_add_u32 s23, s23, 1024
s_add_u32 m0, s23, 0
s_nop 0
buffer_load_dwordx4 v15, s[60:63], s20 offen lds
s_add_u32 m0, s23, 28672
s_nop 0
buffer_load_dwordx4 v15, s[60:63], s21 offen lds
s_add_u32 s20, s20, 43008
s_add_u32 s21, s21, 43008
s_add_u32 s23, s23, 1024
s_add_u32 m0, s23, 0
s_nop 0
buffer_load_dwordx4 v15, s[60:63], s20 offen lds
s_add_u32 m0, s23, 28672
s_nop 0
buffer_load_dwordx4 v15, s[60:63], s21 offen lds
s_add_u32 s20, s20, 43008
s_add_u32 s21, s21, 43008
s_add_u32 s23, s23, 1024
v_mov_b32 v20, 8
v_and_b32 v21, 7, v0
v_lshlrev_b32 v21, 5, v21
buffer_load_dwordx2 v[22:23], v20, s[76:79], 0 offen sc1
buffer_load_dword v60, v21, s[76:79], 0 offen sc1
s_add_u32 m0, s23, 0
s_nop 0
buffer_load_dwordx4 v15, s[60:63], s20 offen lds
s_add_u32 m0, s23, 28672
s_nop 0
buffer_load_dwordx4 v15, s[60:63], s21 offen lds
s_add_u32 s20, s20, 43008
s_add_u32 s21, s21, 43008
s_add_u32 s23, s23, 1024
s_add_u32 m0, s23, 0
s_nop 0
buffer_load_dwordx4 v15, s[60:63], s20 offen lds
s_add_u32 m0, s23, 28672
s_nop 0
buffer_load_dwordx4 v15, s[60:63], s21 offen lds
s_add_u32 s20, s20, 43008
s_add_u32 s21, s21, 43008
s_add_u32 s23, s23, 1024
s_add_u32 m0, s23, 0
s_nop 0
buffer_load_dwordx4 v15, s[60:63], s20 offen lds
s_add_u32 m0, s23, 28672
s_nop 0
buffer_load_dwordx4 v15, s[60:63], s21 offen lds
s_waitcnt vmcnt(16)
v_lshlrev_b32 v32, 16, v24
v_and_b32 v33, 0xffff0000, v24
v_lshlrev_b32 v34, 16, v25
v_and_b32 v35, 0xffff0000, v25
v_lshlrev_b32 v36, 16, v26
v_and_b32 v37, 0xffff0000, v26
v_lshlrev_b32 v38, 16, v27
v_and_b32 v39, 0xffff0000, v27
v_lshlrev_b32 v40, 16, v28
v_and_b32 v41, 0xffff0000, v28
v_lshlrev_b32 v42, 16, v29
v_and_b32 v43, 0xffff0000, v29
v_lshlrev_b32 v44, 16, v30
v_and_b32 v45, 0xffff0000, v30
v_lshlrev_b32 v46, 16, v31
v_and_b32 v47, 0xffff0000, v31
v_add_f32 v48, v32, v33
v_mul_f32 v49, v32, v32
v_fmac_f32 v49, v33, v33
v_add_f32 v48, v48, v34
v_fmac_f32 v49, v34, v34
v_add_f32 v48, v48, v35
v_fmac_f32 v49, v35, v35
v_add_f32 v48, v48, v36
v_fmac_f32 v49, v36, v36
v_add_f32 v48, v48, v37
v_fmac_f32 v49, v37, v37
v_add_f32 v48, v48, v38
v_fmac_f32 v49, v38, v38
v_add_f32 v48, v48, v39
v_fmac_f32 v49, v39, v39
v_add_f32 v50, v40, v41
v_mul_f32 v51, v40, v40
v_fmac_f32 v51, v41, v41
v_add_f32 v50, v50, v42
v_fmac_f32 v51, v42, v42
v_add_f32 v50, v50, v43
v_fmac_f32 v51, v43, v43
v_add_f32 v50, v50, v44
v_fmac_f32 v51, v44, v44
v_add_f32 v50, v50, v45
v_fmac_f32 v51, v45, v45
v_add_f32 v50, v50, v46
v_fmac_f32 v51, v46, v46
v_add_f32 v50, v50, v47
v_fmac_f32 v51, v47, v47
v_add_f32_dpp v48, v48, v48 quad_perm:[1,0,3,2] row_mask:0xf bank_mask:0xf
v_add_f32_dpp v49, v49, v49 quad_perm:[1,0,3,2] row_mask:0xf bank_mask:0xf
v_add_f32_dpp v50, v50, v50 quad_perm:[1,0,3,2] row_mask:0xf bank_mask:0xf
v_add_f32_dpp v51, v51, v51 quad_perm:[1,0,3,2] row_mask:0xf bank_mask:0xf
v_add_f32_dpp v48, v48, v48 quad_perm:[2,3,0,1] row_mask:0xf bank_mask:0xf
v_add_f32_dpp v49, v49, v49 quad_perm:[2,3,0,1] row_mask:0xf bank_mask:0xf
v_add_f32_dpp v50, v50, v50 quad_perm:[2,3,0,1] row_mask:0xf bank_mask:0xf
v_add_f32_dpp v51, v51, v51 quad_perm:[2,3,0,1] row_mask:0xf bank_mask:0xf
v_add_f32_dpp v48, v48, v48 row_half_mirror row_mask:0xf bank_mask:0xf
v_add_f32_dpp v49, v49, v49 row_half_mirror row_mask:0xf bank_mask:0xf
v_add_f32_dpp v50, v50, v50 row_half_mirror row_mask:0xf bank_mask:0xf
v_add_f32_dpp v51, v51, v51 row_half_mirror row_mask:0xf bank_mask:0xf
v_add_f32_dpp v48, v48, v48 row_mirror row_mask:0xf bank_mask:0xf
v_add_f32_dpp v49, v49, v49 row_mirror row_mask:0xf bank_mask:0xf
v_add_f32_dpp v50, v50, v50 row_mirror row_mask:0xf bank_mask:0xf
v_add_f32_dpp v51, v51, v51 row_mirror row_mask:0xf bank_mask:0xf
v_mov_b32 v52, v48
v_mov_b32 v53, v49
v_mov_b32 v54, v50
v_mov_b32 v55, v51
v_permlane16_swap_b32 v48, v52
v_permlane16_swap_b32 v49, v53
v_permlane16_swap_b32 v50, v54
v_permlane16_swap_b32 v51, v55
v_add_f32 v48, v48, v52
v_add_f32 v49, v49, v53
v_add_f32 v50, v50, v54
v_add_f32 v51, v51, v55
v_mov_b32 v52, v48
v_mov_b32 v53, v49
v_mov_b32 v54, v50
v_mov_b32 v55, v51
v_permlane32_swap_b32 v48, v52
v_permlane32_swap_b32 v49, v53
v_permlane32_swap_b32 v50, v54
v_permlane32_swap_b32 v51, v55
v_add_f32 v48, v48, v52
v_add_f32 v49, v49, v53
v_add_f32 v50, v50, v54
v_add_f32 v51, v51, v55
s_waitcnt vmcnt(6)
v_readfirstlane_b32 s24, v22
v_readfirstlane_b32 s25, v23
s_cmp_eq_u32 s24, 1
s_cbranch_scc1 Ltg_18
v_mov_b32 v20, 8
s_mov_b32 s44, 0
Ltag_20:
buffer_load_dwordx2 v[22:23], v20, s[76:79], 0 offen sc1
s_waitcnt vmcnt(0)
v_readfirstlane_b32 s24, v22
v_readfirstlane_b32 s25, v23
s_add_u32 s44, s44, 1
s_cmp_eq_u32 s24, 1
s_cbranch_scc1 Ltago_21
s_cmp_lt_u32 s44, 0x400000
s_cbranch_scc1 Ltag_20
s_branch interleave_layers__softmax_full_mha__dense_activation_silu__prompt_kernel_abort
Ltago_21:
s_add_u32 s16, s25, 1
s_branch Ltg2_19
Ltg_18:
s_add_u32 s16, s25, 1
Ltg2_19:
s_mov_b32 s44, 0
v_mov_b32 v21, v60
s_branch Lmdc_23
Lmd_22:
v_and_b32 v20, 7, v0
v_lshlrev_b32 v20, 5, v20
buffer_load_dword v21, v20, s[76:79], 0 offen sc1
s_waitcnt vmcnt(0)
Lmdc_23:
s_nop 0
v_readlane_b32 s24, v21, s53
s_nop 0
s_cmp_ge_u32 s24, 32
s_cbranch_scc1 Lmdf_24
s_mov_b32 s25, 0
v_readlane_b32 s24, v21, 0
s_nop 0
s_add_u32 s25, s25, s24
v_readlane_b32 s24, v21, 1
s_nop 0
s_add_u32 s25, s25, s24
v_readlane_b32 s24, v21, 2
s_nop 0
s_add_u32 s25, s25, s24
v_readlane_b32 s24, v21, 3
s_nop 0
s_add_u32 s25, s25, s24
v_readlane_b32 s24, v21, 4
s_nop 0
s_add_u32 s25, s25, s24
v_readlane_b32 s24, v21, 5
s_nop 0
s_add_u32 s25, s25, s24
v_readlane_b32 s24, v21, 6
s_nop 0
s_add_u32 s25, s25, s24
v_readlane_b32 s24, v21, 7
s_nop 0
s_add_u32 s25, s25, s24
s_mov_b32 s52, 0
s_cmp_ge_u32 s25, 256
s_cbranch_scc1 Lmdd_25
s_add_u32 s44, s44, 1
s_cmp_lt_u32 s44, 0x400000
s_cbranch_scc1 Lmd_22
s_branch interleave_layers__softmax_full_mha__dense_activation_silu__prompt_kernel_abort
Lmdf_24:
s_mov_b32 s52, 1
Lmdd_25:
v_mul_f32 v48, 0x3b124925, v48
v_mul_f32 v49, 0x3b124925, v49
v_fma_f32 v49, -v48, v48, v49
v_max_f32 v49, 0, v49
v_add_f32 v49, 0x3727c5ac, v49
v_rsq_f32 v49, v49
v_mul_f32 v50, 0x3b124925, v50
v_mul_f32 v51, 0x3b124925, v51
v_fma_f32 v51, -v50, v50, v51
v_max_f32 v51, 0, v51
v_add_f32 v51, 0x3727c5ac, v51
v_rsq_f32 v51, v51
v_sub_f32 v32, v32, v48
v_sub_f32 v33, v33, v48
v_sub_f32 v34, v34, v48
v_sub_f32 v35, v35, v48
v_sub_f32 v36, v36, v48
v_sub_f32 v37, v37, v48
v_sub_f32 v38, v38, v48
v_sub_f32 v39, v39, v48
v_mul_f32 v32, v32, v49
v_mul_f32 v33, v33, v49
v_mul_f32 v34, v34, v49
v_mul_f32 v35, v35, v49
v_mul_f32 v36, v36, v49
v_mul_f32 v37, v37, v49
v_mul_f32 v38, v38, v49
v_mul_f32 v39, v39, v49
v_cvt_pk_bf16_f32 v24, v32, v33
v_cvt_pk_bf16_f32 v25, v34, v35
v_cvt_pk_bf16_f32 v26, v36, v37
v_cvt_pk_bf16_f32 v27, v38, v39
v_sub_f32 v40, v40, v50
v_sub_f32 v41, v41, v50
v_sub_f32 v42, v42, v50
v_sub_f32 v43, v43, v50
v_sub_f32 v44, v44, v50
v_sub_f32 v45, v45, v50
v_sub_f32 v46, v46, v50
v_sub_f32 v47, v47, v50
v_mul_f32 v40, v40, v51
v_mul_f32 v41, v41, v51
v_mul_f32 v42, v42, v51
v_mul_f32 v43, v43, v51
v_mul_f32 v44, v44, v51
v_mul_f32 v45, v45, v51
v_mul_f32 v46, v46, v51
v_mul_f32 v47, v47, v51
v_cvt_pk_bf16_f32 v28, v40, v41
v_cvt_pk_bf16_f32 v29, v42, v43
v_cvt_pk_bf16_f32 v30, v44, v45
v_cvt_pk_bf16_f32 v31, v46, v47
s_cmp_eq_u32 s52, 1
s_cbranch_scc1 Lxf_26
buffer_store_dwordx4 v[24:27], v63, s[4:7], s37 offen sc1
buffer_store_dwordx4 v[28:31], v63, s[4:7], s37 offen offset:16 sc1
s_branch Lxe_27
Lxf_26:
buffer_store_dwordx4 v[24:27], v63, s[4:7], s37 offen
buffer_store_dwordx4 v[28:31], v63, s[4:7], s37 offen offset:16
Lxe_27:
s_waitcnt vmcnt(0)
s_lshl_b32 s28, s35, 7
s_and_b32 s29, s34, 15
s_lshl_b32 s29, s29, 2
s_add_u32 s28, s28, s29
s_add_u32 s28, s28, 90112
v_mov_b32 v16, s16
v_mov_b32 v17, 0
s_mov_b64 exec, 1
s_cmp_eq_u32 s52, 1
s_cbranch_scc1 Lff_28
buffer_store_dword v16, v17, s[4:7], s28 offen sc1
s_branch Lfe_29
Lff_28:
buffer_store_dword v16, v17, s[4:7], s28 offen
Lfe_29:
s_mov_b64 exec, -1
s_barrier
v_and_b32 v12, 15, v0
v_lshrrev_b32 v17, 2, v12
v_lshlrev_b32 v17, 6, v17
v_and_b32 v12, 3, v12
v_lshlrev_b32 v12, 3, v12
v_add_u32 v12, v12, v17
v_bfe_u32 v17, v0, 4, 1
v_lshlrev_b32 v17, 5, v17
v_add_u32 v12, v12, v17
v_mul_u32_u24 v17, 512, v2
v_add_u32 v12, v12, v17
v_add_u32 v13, 57344, v12
ds_read_b64_tr_b16 v[184:185], v12 offset:0
ds_read_b64_tr_b16 v[186:187], v12 offset:256
ds_read_b64_tr_b16 v[188:189], v12 offset:28672
ds_read_b64_tr_b16 v[190:191], v12 offset:28928
ds_read_b64_tr_b16 v[192:193], v12 offset:1024
ds_read_b64_tr_b16 v[194:195], v12 offset:1280
ds_read_b64_tr_b16 v[196:197], v12 offset:29696
ds_read_b64_tr_b16 v[198:199], v12 offset:29952
s_mul_i32 s24, s19, 28672
s_add_u32 s24, s24, 8388608
s_lshl_b32 s26, s19, 7
s_add_u32 s26, s26, 90112
v_and_b32 v14, 15, v0
v_lshlrev_b32 v14, 2, v14
s_mov_b32 s44, 0
buffer_load_dword v16, v14, s[4:7], s26 offen sc1
buffer_load_dword v23, v14, s[4:7], s26 offen sc1
Lpoll_30:
s_waitcnt vmcnt(1)
v_cmp_ne_u32 vcc, s16, v16
s_add_u32 s44, s44, 1
s_cbranch_vccz Lok_31
buffer_load_dword v16, v14, s[4:7], s26 offen sc1
s_waitcnt vmcnt(1)
v_cmp_ne_u32 vcc, s16, v23
s_add_u32 s44, s44, 1
s_cbranch_vccz Lok_31
buffer_load_dword v23, v14, s[4:7], s26 offen sc1
s_cmp_lt_u32 s44, 0x400000
s_cbranch_scc1 Lpoll_30
s_branch interleave_layers__softmax_full_mha__dense_activation_silu__prompt_kernel_abort
Lok_31:
buffer_load_dwordx4 v[24:27], v1, s[4:7], s24 offen offset:0
buffer_load_dwordx4 v[28:31], v1, s[4:7], s24 offen offset:1024
buffer_load_dwordx4 v[32:35], v1, s[4:7], s24 offen offset:2048
buffer_load_dwordx4 v[36:39], v1, s[4:7], s24 offen offset:3072
s_add_u32 s24, s24, 4096
buffer_load_dwordx4 v[40:43], v1, s[4:7], s24 offen offset:0
buffer_load_dwordx4 v[44:47], v1, s[4:7], s24 offen offset:1024
buffer_load_dwordx4 v[48:51], v1, s[4:7], s24 offen offset:2048
buffer_load_dwordx4 v[52:55], v1, s[4:7], s24 offen offset:3072
s_add_u32 s24, s24, 4096
buffer_load_dwordx4 v[56:59], v1, s[4:7], s24 offen offset:0
ds_read_b64_tr_b16 v[200:201], v12 offset:2048
ds_read_b64_tr_b16 v[202:203], v12 offset:2304
ds_read_b64_tr_b16 v[204:205], v12 offset:30720
ds_read_b64_tr_b16 v[206:207], v12 offset:30976
s_waitcnt vmcnt(8)
s_waitcnt lgkmcnt(8)
v_mfma_f32_32x32x16_bf16 v[136:151], v[184:187], v[24:27], 0
v_mfma_f32_32x32x16_bf16 v[152:167], v[24:27], v[188:191], 0
buffer_load_dwordx4 v[60:63], v1, s[4:7], s24 offen offset:1024
ds_read_b64_tr_b16 v[184:185], v12 offset:3072
ds_read_b64_tr_b16 v[186:187], v12 offset:3328
ds_read_b64_tr_b16 v[188:189], v12 offset:31744
ds_read_b64_tr_b16 v[190:191], v12 offset:32000
s_waitcnt vmcnt(8)
s_waitcnt lgkmcnt(8)
v_mfma_f32_32x32x16_bf16 v[136:151], v[192:195], v[28:31], v[136:151]
v_mfma_f32_32x32x16_bf16 v[152:167], v[28:31], v[196:199], v[152:167]
buffer_load_dwordx4 v[64:67], v1, s[4:7], s24 offen offset:2048
ds_read_b64_tr_b16 v[192:193], v12 offset:4096
ds_read_b64_tr_b16 v[194:195], v12 offset:4352
ds_read_b64_tr_b16 v[196:197], v12 offset:32768
ds_read_b64_tr_b16 v[198:199], v12 offset:33024
s_waitcnt vmcnt(8)
s_waitcnt lgkmcnt(8)
v_mfma_f32_32x32x16_bf16 v[136:151], v[200:203], v[32:35], v[136:151]
v_mfma_f32_32x32x16_bf16 v[152:167], v[32:35], v[204:207], v[152:167]
buffer_load_dwordx4 v[68:71], v1, s[4:7], s24 offen offset:3072
ds_read_b64_tr_b16 v[200:201], v12 offset:5120
ds_read_b64_tr_b16 v[202:203], v12 offset:5376
ds_read_b64_tr_b16 v[204:205], v12 offset:33792
ds_read_b64_tr_b16 v[206:207], v12 offset:34048
s_waitcnt vmcnt(8)
s_waitcnt lgkmcnt(8)
v_mfma_f32_32x32x16_bf16 v[136:151], v[184:187], v[36:39], v[136:151]
v_mfma_f32_32x32x16_bf16 v[152:167], v[36:39], v[188:191], v[152:167]
s_add_u32 s24, s24, 4096
buffer_load_dwordx4 v[72:75], v1, s[4:7], s24 offen offset:0
ds_read_b64_tr_b16 v[184:185], v12 offset:6144
ds_read_b64_tr_b16 v[186:187], v12 offset:6400
ds_read_b64_tr_b16 v[188:189], v12 offset:34816
ds_read_b64_tr_b16 v[190:191], v12 offset:35072
s_waitcnt vmcnt(8)
s_waitcnt lgkmcnt(8)
v_mfma_f32_32x32x16_bf16 v[136:151], v[192:195], v[40:43], v[136:151]
v_mfma_f32_32x32x16_bf16 v[152:167], v[40:43], v[196:199], v[152:167]
buffer_load_dwordx4 v[76:79], v1, s[4:7], s24 offen offset:1024
ds_read_b64_tr_b16 v[192:193], v12 offset:7168
ds_read_b64_tr_b16 v[194:195], v12 offset:7424
ds_read_b64_tr_b16 v[196:197], v12 offset:35840
ds_read_b64_tr_b16 v[198:199], v12 offset:36096
s_waitcnt vmcnt(8)
s_waitcnt lgkmcnt(8)
v_mfma_f32_32x32x16_bf16 v[136:151], v[200:203], v[44:47], v[136:151]
v_mfma_f32_32x32x16_bf16 v[152:167], v[44:47], v[204:207], v[152:167]
buffer_load_dwordx4 v[80:83], v1, s[4:7], s24 offen offset:2048
ds_read_b64_tr_b16 v[200:201], v12 offset:8192
ds_read_b64_tr_b16 v[202:203], v12 offset:8448
ds_read_b64_tr_b16 v[204:205], v12 offset:36864
ds_read_b64_tr_b16 v[206:207], v12 offset:37120
s_waitcnt vmcnt(8)
s_waitcnt lgkmcnt(8)
v_mfma_f32_32x32x16_bf16 v[136:151], v[184:187], v[48:51], v[136:151]
v_mfma_f32_32x32x16_bf16 v[152:167], v[48:51], v[188:191], v[152:167]
buffer_load_dwordx4 v[84:87], v1, s[4:7], s24 offen offset:3072
ds_read_b64_tr_b16 v[184:185], v12 offset:9216
ds_read_b64_tr_b16 v[186:187], v12 offset:9472
ds_read_b64_tr_b16 v[188:189], v12 offset:37888
ds_read_b64_tr_b16 v[190:191], v12 offset:38144
s_waitcnt vmcnt(8)
s_waitcnt lgkmcnt(8)
v_mfma_f32_32x32x16_bf16 v[136:151], v[192:195], v[52:55], v[136:151]
v_mfma_f32_32x32x16_bf16 v[152:167], v[52:55], v[196:199], v[152:167]
s_add_u32 s24, s24, 4096
buffer_load_dwordx4 v[88:91], v1, s[4:7], s24 offen offset:0
ds_read_b64_tr_b16 v[192:193], v12 offset:10240
ds_read_b64_tr_b16 v[194:195], v12 offset:10496
ds_read_b64_tr_b16 v[196:197], v12 offset:38912
ds_read_b64_tr_b16 v[198:199], v12 offset:39168
s_waitcnt vmcnt(8)
s_waitcnt lgkmcnt(8)
v_mfma_f32_32x32x16_bf16 v[136:151], v[200:203], v[56:59], v[136:151]
v_mfma_f32_32x32x16_bf16 v[152:167], v[56:59], v[204:207], v[152:167]
buffer_load_dwordx4 v[92:95], v1, s[4:7], s24 offen offset:1024
ds_read_b64_tr_b16 v[200:201], v12 offset:11264
ds_read_b64_tr_b16 v[202:203], v12 offset:11520
ds_read_b64_tr_b16 v[204:205], v12 offset:39936
ds_read_b64_tr_b16 v[206:207], v12 offset:40192
s_waitcnt vmcnt(8)
s_waitcnt lgkmcnt(8)
v_mfma_f32_32x32x16_bf16 v[136:151], v[184:187], v[60:63], v[136:151]
v_mfma_f32_32x32x16_bf16 v[152:167], v[60:63], v[188:191], v[152:167]
buffer_load_dwordx4 v[96:99], v1, s[4:7], s24 offen offset:2048
ds_read_b64_tr_b16 v[184:185], v12 offset:12288
ds_read_b64_tr_b16 v[186:187], v12 offset:12544
ds_read_b64_tr_b16 v[188:189], v12 offset:40960
ds_read_b64_tr_b16 v[190:191], v12 offset:41216
s_waitcnt vmcnt(8)
s_waitcnt lgkmcnt(8)
v_mfma_f32_32x32x16_bf16 v[136:151], v[192:195], v[64:67], v[136:151]
v_mfma_f32_32x32x16_bf16 v[152:167], v[64:67], v[196:199], v[152:167]
buffer_load_dwordx4 v[100:103], v1, s[4:7], s24 offen offset:3072
ds_read_b64_tr_b16 v[192:193], v12 offset:13312
ds_read_b64_tr_b16 v[194:195], v12 offset:13568
ds_read_b64_tr_b16 v[196:197], v12 offset:41984
ds_read_b64_tr_b16 v[198:199], v12 offset:42240
s_waitcnt vmcnt(8)
s_waitcnt lgkmcnt(8)
v_mfma_f32_32x32x16_bf16 v[136:151], v[200:203], v[68:71], v[136:151]
v_mfma_f32_32x32x16_bf16 v[152:167], v[68:71], v[204:207], v[152:167]
s_add_u32 s24, s24, 4096
buffer_load_dwordx4 v[104:107], v1, s[4:7], s24 offen offset:0
ds_read_b64_tr_b16 v[200:201], v12 offset:14336
ds_read_b64_tr_b16 v[202:203], v12 offset:14592
ds_read_b64_tr_b16 v[204:205], v12 offset:43008
ds_read_b64_tr_b16 v[206:207], v12 offset:43264
s_waitcnt vmcnt(8)
s_waitcnt lgkmcnt(8)
v_mfma_f32_32x32x16_bf16 v[136:151], v[184:187], v[72:75], v[136:151]
v_mfma_f32_32x32x16_bf16 v[152:167], v[72:75], v[188:191], v[152:167]
buffer_load_dwordx4 v[108:111], v1, s[4:7], s24 offen offset:1024
ds_read_b64_tr_b16 v[184:185], v12 offset:15360
ds_read_b64_tr_b16 v[186:187], v12 offset:15616
ds_read_b64_tr_b16 v[188:189], v12 offset:44032
ds_read_b64_tr_b16 v[190:191], v12 offset:44288
s_waitcnt vmcnt(8)
s_waitcnt lgkmcnt(8)
v_mfma_f32_32x32x16_bf16 v[136:151], v[192:195], v[76:79], v[136:151]
v_mfma_f32_32x32x16_bf16 v[152:167], v[76:79], v[196:199], v[152:167]
buffer_load_dwordx4 v[112:115], v1, s[4:7], s24 offen offset:2048
ds_read_b64_tr_b16 v[192:193], v12 offset:16384
ds_read_b64_tr_b16 v[194:195], v12 offset:16640
ds_read_b64_tr_b16 v[196:197], v12 offset:45056
ds_read_b64_tr_b16 v[198:199], v12 offset:45312
s_waitcnt vmcnt(8)
s_waitcnt lgkmcnt(8)
v_mfma_f32_32x32x16_bf16 v[136:151], v[200:203], v[80:83], v[136:151]
v_mfma_f32_32x32x16_bf16 v[152:167], v[80:83], v[204:207], v[152:167]
buffer_load_dwordx4 v[116:119], v1, s[4:7], s24 offen offset:3072
ds_read_b64_tr_b16 v[200:201], v12 offset:17408
ds_read_b64_tr_b16 v[202:203], v12 offset:17664
ds_read_b64_tr_b16 v[204:205], v12 offset:46080
ds_read_b64_tr_b16 v[206:207], v12 offset:46336
s_waitcnt vmcnt(8)
s_waitcnt lgkmcnt(8)
v_mfma_f32_32x32x16_bf16 v[136:151], v[184:187], v[84:87], v[136:151]
v_mfma_f32_32x32x16_bf16 v[152:167], v[84:87], v[188:191], v[152:167]
s_add_u32 s24, s24, 4096
buffer_load_dwordx4 v[120:123], v1, s[4:7], s24 offen offset:0
ds_read_b64_tr_b16 v[184:185], v12 offset:18432
ds_read_b64_tr_b16 v[186:187], v12 offset:18688
ds_read_b64_tr_b16 v[188:189], v12 offset:47104
ds_read_b64_tr_b16 v[190:191], v12 offset:47360
s_waitcnt vmcnt(8)
s_waitcnt lgkmcnt(8)
v_mfma_f32_32x32x16_bf16 v[136:151], v[192:195], v[88:91], v[136:151]
v_mfma_f32_32x32x16_bf16 v[152:167], v[88:91], v[196:199], v[152:167]
buffer_load_dwordx4 v[124:127], v1, s[4:7], s24 offen offset:1024
ds_read_b64_tr_b16 v[192:193], v12 offset:19456
ds_read_b64_tr_b16 v[194:195], v12 offset:19712
ds_read_b64_tr_b16 v[196:197], v12 offset:48128
ds_read_b64_tr_b16 v[198:199], v12 offset:48384
s_waitcnt vmcnt(8)
s_waitcnt lgkmcnt(8)
v_mfma_f32_32x32x16_bf16 v[136:151], v[200:203], v[92:95], v[136:151]
v_mfma_f32_32x32x16_bf16 v[152:167], v[92:95], v[204:207], v[152:167]
buffer_load_dwordx4 v[128:131], v1, s[4:7], s24 offen offset:2048
ds_read_b64_tr_b16 v[200:201], v12 offset:20480
ds_read_b64_tr_b16 v[202:203], v12 offset:20736
ds_read_b64_tr_b16 v[204:205], v12 offset:49152
ds_read_b64_tr_b16 v[206:207], v12 offset:49408
s_waitcnt vmcnt(8)
s_waitcnt lgkmcnt(8)
v_mfma_f32_32x32x16_bf16 v[136:151], v[184:187], v[96:99], v[136:151]
v_mfma_f32_32x32x16_bf16 v[152:167], v[96:99], v[188:191], v[152:167]
buffer_load_dwordx4 v[132:135], v1, s[4:7], s24 offen offset:3072
ds_read_b64_tr_b16 v[184:185], v12 offset:21504
ds_read_b64_tr_b16 v[186:187], v12 offset:21760
ds_read_b64_tr_b16 v[188:189], v12 offset:50176
ds_read_b64_tr_b16 v[190:191], v12 offset:50432
s_waitcnt vmcnt(8)
s_waitcnt lgkmcnt(8)
v_mfma_f32_32x32x16_bf16 v[136:151], v[192:195], v[100:103], v[136:151]
v_mfma_f32_32x32x16_bf16 v[152:167], v[100:103], v[196:199], v[152:167]
s_mul_i32 s23, s14, 7168
s_add_u32 s23, s23, 57344
s_mov_b32 m0, s23
s_nop 0
buffer_load_dwordx4 v15, s[60:63], s22 offen lds
s_add_u32 s22, s22, 43008
s_add_u32 s23, s23, 1024
ds_read_b64_tr_b16 v[192:193], v12 offset:22528
ds_read_b64_tr_b16 v[194:195], v12 offset:22784
ds_read_b64_tr_b16 v[196:197], v12 offset:51200
ds_read_b64_tr_b16 v[198:199], v12 offset:51456
s_waitcnt vmcnt(8)
s_waitcnt lgkmcnt(8)
v_mfma_f32_32x32x16_bf16 v[136:151], v[200:203], v[104:107], v[136:151]
v_mfma_f32_32x32x16_bf16 v[152:167], v[104:107], v[204:207], v[152:167]
s_mov_b32 m0, s23
s_nop 0
buffer_load_dwordx4 v15, s[60:63], s22 offen lds
s_add_u32 s22, s22, 43008
s_add_u32 s23, s23, 1024
ds_read_b64_tr_b16 v[200:201], v12 offset:23552
ds_read_b64_tr_b16 v[202:203], v12 offset:23808
ds_read_b64_tr_b16 v[204:205], v12 offset:52224
ds_read_b64_tr_b16 v[206:207], v12 offset:52480
s_waitcnt vmcnt(8)
s_waitcnt lgkmcnt(8)
v_mfma_f32_32x32x16_bf16 v[136:151], v[184:187], v[108:111], v[136:151]
v_mfma_f32_32x32x16_bf16 v[152:167], v[108:111], v[188:191], v[152:167]
s_mov_b32 m0, s23
s_nop 0
buffer_load_dwordx4 v15, s[60:63], s22 offen lds
s_add_u32 s22, s22, 43008
s_add_u32 s23, s23, 1024
ds_read_b64_tr_b16 v[184:185], v12 offset:24576
ds_read_b64_tr_b16 v[186:187], v12 offset:24832
ds_read_b64_tr_b16 v[188:189], v12 offset:53248
ds_read_b64_tr_b16 v[190:191], v12 offset:53504
s_waitcnt vmcnt(8)
s_waitcnt lgkmcnt(8)
v_mfma_f32_32x32x16_bf16 v[136:151], v[192:195], v[112:115], v[136:151]
v_mfma_f32_32x32x16_bf16 v[152:167], v[112:115], v[196:199], v[152:167]
s_mov_b32 m0, s23
s_nop 0
buffer_load_dwordx4 v15, s[60:63], s22 offen lds
s_add_u32 s22, s22, 43008
s_add_u32 s23, s23, 1024
ds_read_b64_tr_b16 v[192:193], v12 offset:25600
ds_read_b64_tr_b16 v[194:195], v12 offset:25856
ds_read_b64_tr_b16 v[196:197], v12 offset:54272
ds_read_b64_tr_b16 v[198:199], v12 offset:54528
s_waitcnt vmcnt(8)
s_waitcnt lgkmcnt(8)
v_mfma_f32_32x32x16_bf16 v[136:151], v[200:203], v[116:119], v[136:151]
v_mfma_f32_32x32x16_bf16 v[152:167], v[116:119], v[204:207], v[152:167]
s_mov_b32 m0, s23
s_nop 0
buffer_load_dwordx4 v15, s[60:63], s22 offen lds
s_add_u32 s22, s22, 43008
s_add_u32 s23, s23, 1024
ds_read_b64_tr_b16 v[200:201], v12 offset:26624
ds_read_b64_tr_b16 v[202:203], v12 offset:26880
ds_read_b64_tr_b16 v[204:205], v12 offset:55296
ds_read_b64_tr_b16 v[206:207], v12 offset:55552
s_waitcnt vmcnt(8)
s_waitcnt lgkmcnt(8)
v_mfma_f32_32x32x16_bf16 v[136:151], v[184:187], v[120:123], v[136:151]
v_mfma_f32_32x32x16_bf16 v[152:167], v[120:123], v[188:191], v[152:167]
s_mov_b32 m0, s23
s_nop 0
buffer_load_dwordx4 v15, s[60:63], s22 offen lds
s_add_u32 s22, s22, 43008
s_add_u32 s23, s23, 1024
ds_read_b64_tr_b16 v[184:185], v12 offset:27648
ds_read_b64_tr_b16 v[186:187], v12 offset:27904
ds_read_b64_tr_b16 v[188:189], v12 offset:56320
ds_read_b64_tr_b16 v[190:191], v12 offset:56576
s_waitcnt vmcnt(8)
s_waitcnt lgkmcnt(8)
v_mfma_f32_32x32x16_bf16 v[136:151], v[192:195], v[124:127], v[136:151]
v_mfma_f32_32x32x16_bf16 v[152:167], v[124:127], v[196:199], v[152:167]
s_mov_b32 m0, s23
s_nop 0
buffer_load_dwordx4 v15, s[60:63], s22 offen lds
s_add_u32 s22, s22, 43008
s_add_u32 s23, s23, 1024
s_waitcnt vmcnt(8)
s_waitcnt lgkmcnt(4)
v_mfma_f32_32x32x16_bf16 v[136:151], v[200:203], v[128:131], v[136:151]
v_mfma_f32_32x32x16_bf16 v[152:167], v[128:131], v[204:207], v[152:167]
s_waitcnt vmcnt(7)
s_waitcnt lgkmcnt(0)
v_mfma_f32_32x32x16_bf16 v[136:151], v[184:187], v[132:135], v[136:151]
v_mfma_f32_32x32x16_bf16 v[152:167], v[132:135], v[188:191], v[152:167]
s_mul_i32 s27, s15, 4194304
s_add_u32 s27, s27, 20971520
s_lshl_b32 s28, s13, 6
s_add_u32 s28, s28, s19
s_lshl_b32 s28, s28, 12
s_add_u32 s27, s27, s28
s_nop 4
v_cvt_pk_bf16_f32 v184, v136, v137
v_cvt_pk_bf16_f32 v185, v138, v139
v_cvt_pk_bf16_f32 v186, v140, v141
v_cvt_pk_bf16_f32 v187, v142, v143
v_cvt_pk_bf16_f32 v188, v144, v145
v_cvt_pk_bf16_f32 v189, v146, v147
v_cvt_pk_bf16_f32 v190, v148, v149
v_cvt_pk_bf16_f32 v191, v150, v151
v_mov_b32 v17, 0x3f803f80
v_mov_b32 v18, 0x3f80
v_cndmask_b32 v190, v190, v17, s[42:43]
v_cndmask_b32 v191, v191, v18, s[42:43]
v_mov_b32 v18, 0
buffer_store_dwordx4 v[184:187], v1, s[4:7], s27 offen sc1
buffer_store_dwordx4 v[188:191], v1, s[4:7], s27 offen offset:1024 sc1
v_mov_b32 v17, 0x3f803f80
v_cndmask_b32 v18, v18, v17, s[40:41]
v_mov_b32 v192, v18
v_mov_b32 v193, v18
v_mov_b32 v194, v18
v_mov_b32 v195, v18
v_mov_b32 v196, v18
v_mov_b32 v197, v18
v_mov_b32 v198, v18
v_mov_b32 v199, v18
s_mov_b32 exec_lo, 0x0fffffff
s_mov_b32 exec_hi, 0x0fffffff
v_cvt_pk_bf16_f32 v192, v152, v153
v_cvt_pk_bf16_f32 v193, v154, v155
v_cvt_pk_bf16_f32 v194, v156, v157
v_cvt_pk_bf16_f32 v195, v158, v159
v_cvt_pk_bf16_f32 v196, v160, v161
v_cvt_pk_bf16_f32 v197, v162, v163
v_cvt_pk_bf16_f32 v198, v164, v165
v_cvt_pk_bf16_f32 v199, v166, v167
s_mov_b64 exec, -1
buffer_store_dwordx4 v[192:195], v1, s[4:7], s27 offen offset:2048 sc1
buffer_store_dwordx4 v[196:199], v1, s[4:7], s27 offen offset:3072 sc1
s_lshl_b32 s28, s15, 4
s_add_u32 s28, s28, s13
s_lshl_b32 s28, s28, 6
s_add_u32 s28, s28, s19
s_lshl_b32 s28, s28, 2
s_add_u32 s28, s28, 0
s_waitcnt vmcnt(4)
s_barrier
ds_read_b64_tr_b16 v[200:201], v13 offset:0
ds_read_b64_tr_b16 v[202:203], v13 offset:256
ds_read_b64_tr_b16 v[204:205], v13 offset:1024
ds_read_b64_tr_b16 v[206:207], v13 offset:1280
ds_read_b64_tr_b16 v[240:241], v13 offset:2048
ds_read_b64_tr_b16 v[242:243], v13 offset:2304
s_waitcnt lgkmcnt(4)
v_mfma_f32_32x32x16_bf16 v[136:151], v[200:203], v[24:27], 0
ds_read_b64_tr_b16 v[200:201], v13 offset:3072
ds_read_b64_tr_b16 v[202:203], v13 offset:3328
s_waitcnt lgkmcnt(4)
v_mfma_f32_32x32x16_bf16 v[136:151], v[204:207], v[28:31], v[136:151]
ds_read_b64_tr_b16 v[204:205], v13 offset:4096
ds_read_b64_tr_b16 v[206:207], v13 offset:4352
s_waitcnt lgkmcnt(4)
v_mfma_f32_32x32x16_bf16 v[136:151], v[240:243], v[32:35], v[136:151]
ds_read_b64_tr_b16 v[240:241], v13 offset:5120
ds_read_b64_tr_b16 v[242:243], v13 offset:5376
s_waitcnt lgkmcnt(4)
v_mfma_f32_32x32x16_bf16 v[136:151], v[200:203], v[36:39], v[136:151]
ds_read_b64_tr_b16 v[200:201], v13 offset:6144
ds_read_b64_tr_b16 v[202:203], v13 offset:6400
s_waitcnt lgkmcnt(4)
v_mfma_f32_32x32x16_bf16 v[136:151], v[204:207], v[40:43], v[136:151]
ds_read_b64_tr_b16 v[204:205], v13 offset:7168
ds_read_b64_tr_b16 v[206:207], v13 offset:7424
s_waitcnt lgkmcnt(4)
v_mfma_f32_32x32x16_bf16 v[136:151], v[240:243], v[44:47], v[136:151]
ds_read_b64_tr_b16 v[240:241], v13 offset:8192
ds_read_b64_tr_b16 v[242:243], v13 offset:8448
s_waitcnt lgkmcnt(4)
v_mfma_f32_32x32x16_bf16 v[136:151], v[200:203], v[48:51], v[136:151]
ds_read_b64_tr_b16 v[200:201], v13 offset:9216
ds_read_b64_tr_b16 v[202:203], v13 offset:9472
s_waitcnt lgkmcnt(4)
v_mfma_f32_32x32x16_bf16 v[136:151], v[204:207], v[52:55], v[136:151]
ds_read_b64_tr_b16 v[204:205], v13 offset:10240
ds_read_b64_tr_b16 v[206:207], v13 offset:10496
s_waitcnt lgkmcnt(4)
v_mfma_f32_32x32x16_bf16 v[136:151], v[240:243], v[56:59], v[136:151]
ds_read_b64_tr_b16 v[240:241], v13 offset:11264
ds_read_b64_tr_b16 v[242:243], v13 offset:11520
s_waitcnt lgkmcnt(4)
v_mfma_f32_32x32x16_bf16 v[136:151], v[200:203], v[60:63], v[136:151]
ds_read_b64_tr_b16 v[200:201], v13 offset:12288
ds_read_b64_tr_b16 v[202:203], v13 offset:12544
s_waitcnt lgkmcnt(4)
v_mfma_f32_32x32x16_bf16 v[136:151], v[204:207], v[64:67], v[136:151]
ds_read_b64_tr_b16 v[204:205], v13 offset:13312
ds_read_b64_tr_b16 v[206:207], v13 offset:13568
s_waitcnt lgkmcnt(4)
v_mfma_f32_32x32x16_bf16 v[136:151], v[240:243], v[68:71], v[136:151]
ds_read_b64_tr_b16 v[240:241], v13 offset:14336
ds_read_b64_tr_b16 v[242:243], v13 offset:14592
s_waitcnt lgkmcnt(4)
v_mfma_f32_32x32x16_bf16 v[136:151], v[200:203], v[72:75], v[136:151]
ds_read_b64_tr_b16 v[200:201], v13 offset:15360
ds_read_b64_tr_b16 v[202:203], v13 offset:15616
s_waitcnt lgkmcnt(4)
v_mfma_f32_32x32x16_bf16 v[136:151], v[204:207], v[76:79], v[136:151]
ds_read_b64_tr_b16 v[204:205], v13 offset:16384
ds_read_b64_tr_b16 v[206:207], v13 offset:16640
s_waitcnt lgkmcnt(4)
v_mfma_f32_32x32x16_bf16 v[136:151], v[240:243], v[80:83], v[136:151]
ds_read_b64_tr_b16 v[240:241], v13 offset:17408
ds_read_b64_tr_b16 v[242:243], v13 offset:17664
s_waitcnt lgkmcnt(4)
v_mfma_f32_32x32x16_bf16 v[136:151], v[200:203], v[84:87], v[136:151]
ds_read_b64_tr_b16 v[200:201], v13 offset:18432
ds_read_b64_tr_b16 v[202:203], v13 offset:18688
s_waitcnt lgkmcnt(4)
v_mfma_f32_32x32x16_bf16 v[136:151], v[204:207], v[88:91], v[136:151]
s_waitcnt vmcnt(0)
v_mov_b32 v16, s16
v_mov_b32 v17, 0
s_mov_b64 exec, 1
buffer_store_dword v16, v17, s[4:7], s28 offen sc1
s_mov_b64 exec, -1
s_sub_u32 s34, s13, 14
s_cmp_ge_u32 s13, 14
s_cselect_b32 s34, s34, s13
s_cmp_ge_u32 s34, 7
s_cselect_b32 s36, 1, 0
s_mul_i32 s35, s36, 7
s_sub_u32 s35, s34, s35
s_lshl_b32 s27, s14, 12
s_add_u32 s27, s27, 135168
v_lshrrev_b32 v17, 2, v0
v_and_b32 v18, 3, v0
v_lshlrev_b32 v18, 4, v18
s_cmp_lt_u32 s13, 2
s_cbranch_scc1 Lpb_32
s_cmp_ge_u32 s19, 28
s_cbranch_scc1 Lpc_33
v_mul_u32_u24 v17, 3584, v17
v_add_u32 v17, v17, v18
s_mul_hi_u32 s28, s19, 613566757
s_mul_i32 s29, s28, 7
s_sub_u32 s29, s19, s29
s_mul_i32 s29, s29, 229376
s_lshl_b32 s28, s28, 6
s_add_u32 s29, s29, s28
s_lshl_b32 s28, s34, 8
s_add_u32 s29, s29, s28
s_add_u32 m0, s27, 0
s_add_u32 s28, s29, 0
buffer_load_dwordx4 v17, s[68:71], s28 offen lds
s_add_u32 m0, s27, 1024
s_add_u32 s28, s29, 57344
buffer_load_dwordx4 v17, s[68:71], s28 offen lds
s_add_u32 m0, s27, 2048
s_add_u32 s28, s29, 114688
buffer_load_dwordx4 v17, s[68:71], s28 offen lds
s_add_u32 m0, s27, 3072
s_add_u32 s28, s29, 172032
buffer_load_dwordx4 v17, s[68:71], s28 offen lds
s_branch Lpe_34
Lpb_32:
v_mul_u32_u24 v17, 896, v17
v_add_u32 v17, v17, v18
s_lshl_b32 s28, s13, 6
s_add_u32 s28, s28, s19
s_min_u32 s28, s28, 111
s_and_b32 s29, s28, 15
s_mul_i32 s29, s29, 25088
s_lshr_b32 s28, s28, 4
s_lshl_b32 s28, s28, 7
s_add_u32 s29, s29, s28
s_add_u32 m0, s27, 0
s_add_u32 s28, s29, 0
buffer_load_dwordx4 v17, s[64:67], s28 offen lds
s_add_u32 m0, s27, 1024
s_add_u32 s28, s29, 64
buffer_load_dwordx4 v17, s[64:67], s28 offen lds
s_add_u32 m0, s27, 2048
s_add_u32 s28, s29, 14336
buffer_load_dwordx4 v17, s[64:67], s28 offen lds
s_add_u32 m0, s27, 3072
s_add_u32 s28, s29, 14400
buffer_load_dwordx4 v17, s[64:67], s28 offen lds
s_branch Lpe_34
Lpc_33:
v_mul_u32_u24 v17, 896, v17
v_add_u32 v17, v17, v18
s_min_u32 s28, s19, 55
s_sub_u32 s28, s28, 28
s_mul_i32 s29, s36, 28
s_add_u32 s28, s28, s29
s_mul_i32 s29, s28, 28672
s_lshl_b32 s28, s35, 7
s_add_u32 s29, s29, s28
s_add_u32 m0, s27, 0
s_add_u32 s28, s29, 0
buffer_load_dwordx4 v17, s[72:75], s28 offen lds
s_add_u32 m0, s27, 1024
s_add_u32 s28, s29, 64
buffer_load_dwordx4 v17, s[72:75], s28 offen lds
s_add_u32 m0, s27, 2048
s_add_u32 s28, s29, 14336
buffer_load_dwordx4 v17, s[72:75], s28 offen lds
s_add_u32 m0, s27, 3072
s_add_u32 s28, s29, 14400
buffer_load_dwordx4 v17, s[72:75], s28 offen lds
Lpe_34:
ds_read_b64_tr_b16 v[204:205], v13 offset:19456
ds_read_b64_tr_b16 v[206:207], v13 offset:19712
s_waitcnt lgkmcnt(4)
v_mfma_f32_32x32x16_bf16 v[136:151], v[240:243], v[92:95], v[136:151]
ds_read_b64_tr_b16 v[240:241], v13 offset:20480
ds_read_b64_tr_b16 v[242:243], v13 offset:20736
s_waitcnt lgkmcnt(4)
v_mfma_f32_32x32x16_bf16 v[136:151], v[200:203], v[96:99], v[136:151]
ds_read_b64_tr_b16 v[200:201], v13 offset:21504
ds_read_b64_tr_b16 v[202:203], v13 offset:21760
s_waitcnt lgkmcnt(4)
v_mfma_f32_32x32x16_bf16 v[136:151], v[204:207], v[100:103], v[136:151]
ds_read_b64_tr_b16 v[204:205], v13 offset:22528
ds_read_b64_tr_b16 v[206:207], v13 offset:22784
s_waitcnt lgkmcnt(4)
v_mfma_f32_32x32x16_bf16 v[136:151], v[240:243], v[104:107], v[136:151]
ds_read_b64_tr_b16 v[240:241], v13 offset:23552
ds_read_b64_tr_b16 v[242:243], v13 offset:23808
s_waitcnt lgkmcnt(4)
v_mfma_f32_32x32x16_bf16 v[136:151], v[200:203], v[108:111], v[136:151]
ds_read_b64_tr_b16 v[200:201], v13 offset:24576
ds_read_b64_tr_b16 v[202:203], v13 offset:24832
s_waitcnt lgkmcnt(4)
v_mfma_f32_32x32x16_bf16 v[136:151], v[204:207], v[112:115], v[136:151]
ds_read_b64_tr_b16 v[204:205], v13 offset:25600
ds_read_b64_tr_b16 v[206:207], v13 offset:25856
s_waitcnt lgkmcnt(4)
v_mfma_f32_32x32x16_bf16 v[136:151], v[240:243], v[116:119], v[136:151]
ds_read_b64_tr_b16 v[240:241], v13 offset:26624
ds_read_b64_tr_b16 v[242:243], v13 offset:26880
s_waitcnt lgkmcnt(4)
v_mfma_f32_32x32x16_bf16 v[136:151], v[200:203], v[120:123], v[136:151]
ds_read_b64_tr_b16 v[200:201], v13 offset:27648
ds_read_b64_tr_b16 v[202:203], v13 offset:27904
s_waitcnt lgkmcnt(4)
v_mfma_f32_32x32x16_bf16 v[136:151], v[204:207], v[124:127], v[136:151]
s_waitcnt lgkmcnt(2)
v_mfma_f32_32x32x16_bf16 v[136:151], v[240:243], v[128:131], v[136:151]
s_waitcnt lgkmcnt(0)
v_mfma_f32_32x32x16_bf16 v[136:151], v[200:203], v[132:135], v[136:151]
v_mov_b32 v18, 0x3e8b97f6
s_nop 10
v_pk_mul_f32 v[136:137], v[18:19], v[136:137] op_sel_hi:[0,1]
v_pk_mul_f32 v[138:139], v[18:19], v[138:139] op_sel_hi:[0,1]
v_pk_mul_f32 v[140:141], v[18:19], v[140:141] op_sel_hi:[0,1]
v_pk_mul_f32 v[142:143], v[18:19], v[142:143] op_sel_hi:[0,1]
v_pk_mul_f32 v[144:145], v[18:19], v[144:145] op_sel_hi:[0,1]
v_pk_mul_f32 v[146:147], v[18:19], v[146:147] op_sel_hi:[0,1]
v_pk_mul_f32 v[148:149], v[18:19], v[148:149] op_sel_hi:[0,1]
v_pk_mul_f32 v[150:151], v[18:19], v[150:151] op_sel_hi:[0,1]
v_cvt_pk_bf16_f32 v168, v136, v137
v_cvt_pk_bf16_f32 v169, v138, v139
v_cvt_pk_bf16_f32 v170, v140, v141
v_cvt_pk_bf16_f32 v171, v142, v143
v_cvt_pk_bf16_f32 v172, v144, v145
v_cvt_pk_bf16_f32 v173, v146, v147
v_cvt_pk_bf16_f32 v174, v148, v149
v_cvt_pk_bf16_f32 v175, v150, v151
v_mov_b32 v17, 0
v_cndmask_b32 v174, v174, v17, s[42:43]
v_cndmask_b32 v175, v175, v17, s[42:43]
s_mul_i32 s26, s14, 12288
s_add_u32 s26, s26, 86016
v_add_u32 v14, s26, v1
ds_write_b128 v14, v[168:171]
ds_write_b128 v14, v[172:175] offset:1024
s_waitcnt lgkmcnt(0)
s_barrier
s_xor_b32 s26, s14, 0
s_mul_i32 s26, s26, 12288
s_add_u32 s26, s26, 86016
v_add_u32 v14, s26, v1
ds_read_b128 a[224:227], v14
ds_read_b128 a[228:231], v14 offset:1024
s_xor_b32 s26, s14, 1
s_mul_i32 s26, s26, 12288
s_add_u32 s26, s26, 86016
v_add_u32 v14, s26, v1
ds_read_b128 a[232:235], v14
ds_read_b128 a[236:239], v14 offset:1024
s_xor_b32 s26, s14, 2
s_mul_i32 s26, s26, 12288
s_add_u32 s26, s26, 86016
v_add_u32 v14, s26, v1
ds_read_b128 a[240:243], v14
ds_read_b128 a[244:247], v14 offset:1024
s_xor_b32 s26, s14, 3
s_mul_i32 s26, s26, 12288
s_add_u32 s26, s26, 86016
v_add_u32 v14, s26, v1
ds_read_b128 a[248:251], v14
ds_read_b128 a[252:255], v14 offset:1024
s_waitcnt vmcnt(0)
v_and_b32 v14, 15, v0
v_lshrrev_b32 v17, 2, v14
v_lshlrev_b32 v17, 6, v17
v_and_b32 v14, 3, v14
v_lshlrev_b32 v14, 3, v14
v_add_u32 v14, v14, v17
v_bfe_u32 v17, v0, 4, 1
v_lshlrev_b32 v17, 5, v17
v_add_u32 v14, v14, v17
v_mul_u32_u24 v17, 256, v2
v_add_u32 v14, v14, v17
s_lshl_b32 s27, s14, 12
s_add_u32 s27, s27, 135168
v_add_u32 v14, s27, v14
ds_read_b64_tr_b16 v[136:137], v14 offset:0
ds_read_b64_tr_b16 v[138:139], v14 offset:512
ds_read_b64_tr_b16 v[140:141], v14 offset:1024
ds_read_b64_tr_b16 v[142:143], v14 offset:1536
ds_read_b64_tr_b16 v[144:145], v14 offset:2048
ds_read_b64_tr_b16 v[146:147], v14 offset:2560
ds_read_b64_tr_b16 v[148:149], v14 offset:3072
ds_read_b64_tr_b16 v[150:151], v14 offset:3584
s_waitcnt lgkmcnt(0)
s_cmp_lt_u32 s13, 2
s_cbranch_scc1 Lqb_36
s_cmp_ge_u32 s19, 28
s_cbranch_scc1 Lqc_37
s_mul_i32 s28, s34, 112
s_lshl_b32 s29, s19, 2
s_add_u32 s28, s28, s29
s_lshl_b32 s29, s28, 7
s_add_u32 s29, s29, 434176
s_lshl_b32 s28, s28, 10
s_add_u32 s28, s28, 3670016
v_mov_b32 v17, 0x3f803f80
v_lshlrev_b32 v18, 2, v3
v_dot2_f32_bf16 v152, v136, v17, 0
v_dot2_f32_bf16 v152, v137, v17, v152
v_dot2_f32_bf16 v152, v138, v17, v152
v_dot2_f32_bf16 v152, v139, v17, v152
s_nop 2
v_mov_b32 v153, v152
s_nop 1
v_permlane32_swap_b32 v152, v153
v_add_f32 v152, v152, v153
buffer_store_dword v152, v18, s[4:7], s29 offen offset:0 sc1
v_dot2_f32_bf16 v154, v140, v17, 0
v_dot2_f32_bf16 v154, v141, v17, v154
v_dot2_f32_bf16 v154, v142, v17, v154
v_dot2_f32_bf16 v154, v143, v17, v154
s_nop 2
v_mov_b32 v155, v154
s_nop 1
v_permlane32_swap_b32 v154, v155
v_add_f32 v154, v154, v155
buffer_store_dword v154, v18, s[4:7], s29 offen offset:128 sc1
v_dot2_f32_bf16 v156, v144, v17, 0
v_dot2_f32_bf16 v156, v145, v17, v156
v_dot2_f32_bf16 v156, v146, v17, v156
v_dot2_f32_bf16 v156, v147, v17, v156
s_nop 2
v_mov_b32 v157, v156
s_nop 1
v_permlane32_swap_b32 v156, v157
v_add_f32 v156, v156, v157
buffer_store_dword v156, v18, s[4:7], s29 offen offset:256 sc1
v_dot2_f32_bf16 v158, v148, v17, 0
v_dot2_f32_bf16 v158, v149, v17, v158
v_dot2_f32_bf16 v158, v150, v17, v158
v_dot2_f32_bf16 v158, v151, v17, v158
s_nop 2
v_mov_b32 v159, v158
s_nop 1
v_permlane32_swap_b32 v158, v159
v_add_f32 v158, v158, v159
buffer_store_dword v158, v18, s[4:7], s29 offen offset:384 sc1
s_branch Lqs_38
Lqb_36:
s_lshl_b32 s28, s13, 6
s_add_u32 s28, s28, s19
s_min_u32 s28, s28, 111
v_mov_b32 v17, 0
v_cndmask_b32 v146, v146, v17, s[42:43]
v_cndmask_b32 v147, v147, v17, s[42:43]
v_cndmask_b32 v150, v150, v17, s[42:43]
v_cndmask_b32 v151, v151, v17, s[42:43]
s_lshl_b32 s28, s28, 12
s_add_u32 s28, s28, 5373952
s_branch Lqs_38
Lqc_37:
s_min_u32 s28, s19, 55
s_sub_u32 s28, s28, 28
s_mul_i32 s29, s36, 28
s_add_u32 s28, s28, s29
s_mul_i32 s29, s35, 56
s_add_u32 s28, s28, s29
s_lshl_b32 s28, s28, 12
s_add_u32 s28, s28, 6291456
Lqs_38:
buffer_store_dwordx4 v[136:139], v1, s[4:7], s28 offen offset:0 sc1
buffer_store_dwordx4 v[140:143], v1, s[4:7], s28 offen offset:1024 sc1
buffer_store_dwordx4 v[144:147], v1, s[4:7], s28 offen offset:2048 sc1
buffer_store_dwordx4 v[148:151], v1, s[4:7], s28 offen offset:3072 sc1
s_nop 1
Lqe_39:
v_and_b32 v14, 15, v0
v_lshrrev_b32 v17, 2, v14
v_lshlrev_b32 v17, 6, v17
v_and_b32 v14, 3, v14
v_lshlrev_b32 v14, 3, v14
v_add_u32 v14, v14, v17
v_bfe_u32 v17, v0, 4, 1
v_lshlrev_b32 v17, 5, v17
v_add_u32 v14, v14, v17
v_mul_u32_u24 v17, 256, v2
v_add_u32 v14, v14, v17
s_mov_b32 s26, 0xf0000000
s_mov_b32 s27, 0xf0000000
v_mov_b32 v18, 0
s_add_u32 s28, s19, 0
s_lshl_b32 s29, s28, 10
v_add_u32 v17, s29, v14
ds_read_b64_tr_b16 v[160:161], v17
ds_read_b64_tr_b16 v[162:163], v17 offset:512
s_waitcnt lgkmcnt(0)
v_cndmask_b32 v160, v160, v18, s[26:27]
v_cndmask_b32 v161, v161, v18, s[26:27]
v_cndmask_b32 v162, v162, v18, s[26:27]
v_cndmask_b32 v163, v163, v18, s[26:27]
s_mul_i32 s29, s13, 84
s_add_u32 s29, s29, s28
s_lshl_b32 s29, s29, 10
s_add_u32 s29, s29, 2097152
buffer_store_dwordx4 v[160:163], v1, s[4:7], s29 offen sc1
v_mov_b32 v17, 0x3f803f80
v_dot2_f32_bf16 v168, v160, v17, 0
v_dot2_f32_bf16 v168, v161, v17, v168
v_dot2_f32_bf16 v168, v162, v17, v168
v_dot2_f32_bf16 v168, v163, v17, v168
s_nop 2
v_mov_b32 v169, v168
s_nop 1
v_permlane32_swap_b32 v168, v169
v_add_f32 v168, v168, v169
s_mul_i32 s29, s13, 84
s_add_u32 s29, s29, s28
s_lshl_b32 s29, s29, 7
s_add_u32 s29, s29, 262144
v_lshlrev_b32 v17, 2, v3
buffer_store_dword v168, v17, s[4:7], s29 offen sc1
Lwq_40:
s_add_u32 s28, s19, 64
s_cmp_ge_u32 s28, 84
s_cbranch_scc1 Lwq_41
s_lshl_b32 s29, s28, 10
v_add_u32 v17, s29, v14
ds_read_b64_tr_b16 v[164:165], v17
ds_read_b64_tr_b16 v[166:167], v17 offset:512
s_waitcnt lgkmcnt(0)
v_cndmask_b32 v164, v164, v18, s[26:27]
v_cndmask_b32 v165, v165, v18, s[26:27]
v_cndmask_b32 v166, v166, v18, s[26:27]
v_cndmask_b32 v167, v167, v18, s[26:27]
s_mul_i32 s29, s13, 84
s_add_u32 s29, s29, s28
s_lshl_b32 s29, s29, 10
s_add_u32 s29, s29, 2097152
buffer_store_dwordx4 v[164:167], v1, s[4:7], s29 offen sc1
v_mov_b32 v17, 0x3f803f80
v_dot2_f32_bf16 v170, v164, v17, 0
v_dot2_f32_bf16 v170, v165, v17, v170
v_dot2_f32_bf16 v170, v166, v17, v170
v_dot2_f32_bf16 v170, v167, v17, v170
s_nop 2
v_mov_b32 v171, v170
s_nop 1
v_permlane32_swap_b32 v170, v171
v_add_f32 v170, v170, v171
s_mul_i32 s29, s13, 84
s_add_u32 s29, s29, s28
s_lshl_b32 s29, s29, 7
s_add_u32 s29, s29, 262144
v_lshlrev_b32 v17, 2, v3
buffer_store_dword v170, v17, s[4:7], s29 offen sc1
Lwq_41:
s_nop 1
s_lshl_b32 s28, s13, 6
s_add_u32 s28, s28, s19
s_lshl_b32 s28, s28, 2
s_add_u32 s28, s28, 81920
s_waitcnt vmcnt(0)
v_mov_b32 v16, s16
v_mov_b32 v17, 0
s_mov_b64 exec, 1
buffer_store_dword v16, v17, s[4:7], s28 offen sc1
s_mov_b64 exec, -1
s_barrier
s_branch interleave_layers__softmax_full_mha__dense_activation_silu__prompt_kernel_att
interleave_layers__softmax_full_mha__dense_activation_silu__prompt_kernel_layer:
s_mul_i32 s24, s19, 28672
s_add_u32 s24, s24, 14680064
s_mul_i32 s25, s19, 3584
s_add_u32 s25, s25, 1343488
s_lshl_b32 s26, s19, 7
s_add_u32 s26, s26, 65536
v_min_u32 v12, 13, v3
v_lshlrev_b32 v12, 2, v12
s_mov_b32 s44, 0
buffer_load_dword v16, v12, s[4:7], s26 offen sc1
buffer_load_dword v23, v12, s[4:7], s26 offen sc1
Lpoll_42:
s_waitcnt vmcnt(1)
v_cmp_ne_u32 vcc, s16, v16
s_add_u32 s44, s44, 1
s_cbranch_vccz Lok_43
buffer_load_dword v16, v12, s[4:7], s26 offen sc1
s_waitcnt vmcnt(1)
v_cmp_ne_u32 vcc, s16, v23
s_add_u32 s44, s44, 1
s_cbranch_vccz Lok_43
buffer_load_dword v23, v12, s[4:7], s26 offen sc1
s_cmp_lt_u32 s44, 0x400000
s_cbranch_scc1 Lpoll_42
s_branch interleave_layers__softmax_full_mha__dense_activation_silu__prompt_kernel_abort
Lok_43:
buffer_load_dwordx4 v[24:27], v1, s[4:7], s24 offen offset:0
buffer_load_dwordx4 v[28:31], v1, s[4:7], s24 offen offset:1024
buffer_load_dwordx4 v[32:35], v1, s[4:7], s24 offen offset:2048
buffer_load_dwordx4 v[36:39], v1, s[4:7], s24 offen offset:3072
v_lshlrev_b32 v12, 11, v2
v_lshlrev_b32 v13, 4, v3
v_add_u32 v12, v12, v13
v_lshlrev_b32 v13, 30, v2
v_add_u32 v13, v12, v13
buffer_load_dwordx4 v[208:211], v12, s[4:7], s25 offen offset:0
buffer_load_dwordx4 v[212:215], v12, s[4:7], s25 offen offset:512
buffer_load_dwordx4 v[216:219], v12, s[4:7], s25 offen offset:1024
buffer_load_dwordx4 v[220:223], v13, s[4:7], s25 offen offset:1536
s_add_u32 s24, s24, 4096
buffer_load_dwordx4 v[40:43], v1, s[4:7], s24 offen offset:0
buffer_load_dwordx4 v[44:47], v1, s[4:7], s24 offen offset:1024
buffer_load_dwordx4 v[48:51], v1, s[4:7], s24 offen offset:2048
buffer_load_dwordx4 v[52:55], v1, s[4:7], s24 offen offset:3072
v_add_u32 v13, 57344, v1
ds_read_b128 v[184:187], v1 offset:0
ds_read_b128 v[188:191], v1 offset:28672
ds_read_b128 v[192:195], v1 offset:1024
ds_read_b128 v[196:199], v1 offset:29696
s_add_u32 s24, s24, 4096
buffer_load_dwordx4 v[56:59], v1, s[4:7], s24 offen offset:0
ds_read_b128 v[200:203], v1 offset:2048
ds_read_b128 v[204:207], v1 offset:30720
s_waitcnt vmcnt(12)
s_waitcnt lgkmcnt(4)
v_mfma_f32_32x32x16_bf16 v[136:151], v[184:187], v[24:27], 0
v_mfma_f32_32x32x16_bf16 v[152:167], v[24:27], v[188:191], 0
buffer_load_dwordx4 v[60:63], v1, s[4:7], s24 offen offset:1024
ds_read_b128 v[184:187], v1 offset:3072
ds_read_b128 v[188:191], v1 offset:31744
s_waitcnt vmcnt(12)
s_waitcnt lgkmcnt(4)
v_mfma_f32_32x32x16_bf16 v[136:151], v[192:195], v[28:31], v[136:151]
v_mfma_f32_32x32x16_bf16 v[152:167], v[28:31], v[196:199], v[152:167]
buffer_load_dwordx4 v[64:67], v1, s[4:7], s24 offen offset:2048
ds_read_b128 v[192:195], v1 offset:4096
ds_read_b128 v[196:199], v1 offset:32768
s_waitcnt vmcnt(12)
s_waitcnt lgkmcnt(4)
v_mfma_f32_32x32x16_bf16 v[136:151], v[200:203], v[32:35], v[136:151]
v_mfma_f32_32x32x16_bf16 v[152:167], v[32:35], v[204:207], v[152:167]
buffer_load_dwordx4 v[68:71], v1, s[4:7], s24 offen offset:3072
ds_read_b128 v[200:203], v1 offset:5120
ds_read_b128 v[204:207], v1 offset:33792
s_waitcnt vmcnt(12)
s_waitcnt lgkmcnt(4)
v_mfma_f32_32x32x16_bf16 v[136:151], v[184:187], v[36:39], v[136:151]
v_mfma_f32_32x32x16_bf16 v[152:167], v[36:39], v[188:191], v[152:167]
s_add_u32 s24, s24, 4096
buffer_load_dwordx4 v[72:75], v1, s[4:7], s24 offen offset:0
ds_read_b128 v[184:187], v1 offset:6144
ds_read_b128 v[188:191], v1 offset:34816
s_waitcnt vmcnt(8)
s_waitcnt lgkmcnt(4)
v_mfma_f32_32x32x16_bf16 v[136:151], v[192:195], v[40:43], v[136:151]
v_add_f32 v208, v208, v210
v_add_f32 v209, v209, v211
v_mfma_f32_32x32x16_bf16 v[152:167], v[40:43], v[196:199], v[152:167]
v_add_f32 v208, v208, v212
v_add_f32 v209, v209, v213
buffer_load_dwordx4 v[76:79], v1, s[4:7], s24 offen offset:1024
ds_read_b128 v[192:195], v1 offset:7168
ds_read_b128 v[196:199], v1 offset:35840
s_waitcnt vmcnt(8)
s_waitcnt lgkmcnt(4)
v_mfma_f32_32x32x16_bf16 v[136:151], v[200:203], v[44:47], v[136:151]
v_add_f32 v208, v208, v214
v_add_f32 v209, v209, v215
v_mfma_f32_32x32x16_bf16 v[152:167], v[44:47], v[204:207], v[152:167]
v_add_f32 v208, v208, v216
v_add_f32 v209, v209, v217
buffer_load_dwordx4 v[80:83], v1, s[4:7], s24 offen offset:2048
ds_read_b128 v[200:203], v1 offset:8192
ds_read_b128 v[204:207], v1 offset:36864
s_waitcnt vmcnt(8)
s_waitcnt lgkmcnt(4)
v_mfma_f32_32x32x16_bf16 v[136:151], v[184:187], v[48:51], v[136:151]
v_add_f32 v208, v208, v218
v_add_f32 v209, v209, v219
v_mfma_f32_32x32x16_bf16 v[152:167], v[48:51], v[188:191], v[152:167]
v_add_f32 v208, v208, v220
v_add_f32 v209, v209, v221
buffer_load_dwordx4 v[84:87], v1, s[4:7], s24 offen offset:3072
ds_read_b128 v[184:187], v1 offset:9216
ds_read_b128 v[188:191], v1 offset:37888
s_waitcnt vmcnt(8)
s_waitcnt lgkmcnt(4)
v_mfma_f32_32x32x16_bf16 v[136:151], v[192:195], v[52:55], v[136:151]
v_add_f32 v208, v208, v222
v_add_f32 v209, v209, v223
v_mfma_f32_32x32x16_bf16 v[152:167], v[52:55], v[196:199], v[152:167]
v_mov_b32 v210, v208
v_mov_b32 v211, v209
s_add_u32 s24, s24, 4096
buffer_load_dwordx4 v[88:91], v1, s[4:7], s24 offen offset:0
ds_read_b128 v[192:195], v1 offset:10240
ds_read_b128 v[196:199], v1 offset:38912
s_waitcnt vmcnt(8)
s_waitcnt lgkmcnt(4)
v_mfma_f32_32x32x16_bf16 v[136:151], v[200:203], v[56:59], v[136:151]
v_permlane32_swap_b32 v208, v210
v_permlane32_swap_b32 v209, v211
v_mfma_f32_32x32x16_bf16 v[152:167], v[56:59], v[204:207], v[152:167]
v_add_f32 v208, v208, v210
v_add_f32 v209, v209, v211
buffer_load_dwordx4 v[92:95], v1, s[4:7], s24 offen offset:1024
ds_read_b128 v[200:203], v1 offset:11264
ds_read_b128 v[204:207], v1 offset:39936
s_waitcnt vmcnt(8)
s_waitcnt lgkmcnt(4)
v_mfma_f32_32x32x16_bf16 v[136:151], v[184:187], v[60:63], v[136:151]
v_mul_f32 v222, 0xbb124925, v208
v_mul_f32 v209, 0x3b124925, v209
v_mfma_f32_32x32x16_bf16 v[152:167], v[60:63], v[188:191], v[152:167]
v_fma_f32 v209, -v222, v222, v209
v_max_f32 v209, 0, v209
buffer_load_dwordx4 v[96:99], v1, s[4:7], s24 offen offset:2048
ds_read_b128 v[184:187], v1 offset:12288
ds_read_b128 v[188:191], v1 offset:40960
s_waitcnt vmcnt(8)
s_waitcnt lgkmcnt(4)
v_mfma_f32_32x32x16_bf16 v[136:151], v[192:195], v[64:67], v[136:151]
v_add_f32 v209, 0x3727c5ac, v209
v_rsq_f32 v223, v209
v_mfma_f32_32x32x16_bf16 v[152:167], v[64:67], v[196:199], v[152:167]
s_lshl_b32 s26, s14, 8
s_add_u32 s26, s26, 160768
buffer_load_dwordx4 v[100:103], v1, s[4:7], s24 offen offset:3072
ds_read_b128 v[192:195], v1 offset:13312
ds_read_b128 v[196:199], v1 offset:41984
s_waitcnt vmcnt(8)
s_waitcnt lgkmcnt(4)
v_mfma_f32_32x32x16_bf16 v[136:151], v[200:203], v[68:71], v[136:151]
v_lshlrev_b32 v14, 2, v3
v_add_u32 v14, s26, v14
v_mfma_f32_32x32x16_bf16 v[152:167], v[68:71], v[204:207], v[152:167]
ds_write_b32 v14, v222
ds_write_b32 v14, v223 offset:128
s_add_u32 s24, s24, 4096
buffer_load_dwordx4 v[104:107], v1, s[4:7], s24 offen offset:0
ds_read_b128 v[200:203], v1 offset:14336
ds_read_b128 v[204:207], v1 offset:43008
s_waitcnt vmcnt(8)
s_waitcnt lgkmcnt(6)
v_mfma_f32_32x32x16_bf16 v[136:151], v[184:187], v[72:75], v[136:151]
v_lshlrev_b32 v14, 4, v2
v_add_u32 v14, s26, v14
v_mfma_f32_32x32x16_bf16 v[152:167], v[72:75], v[188:191], v[152:167]
ds_read_b128 v[240:243], v14 offset:0
ds_read_b128 v[244:247], v14 offset:32
buffer_load_dwordx4 v[108:111], v1, s[4:7], s24 offen offset:1024
ds_read_b128 v[184:187], v1 offset:15360
ds_read_b128 v[188:191], v1 offset:44032
s_waitcnt vmcnt(8)
s_waitcnt lgkmcnt(8)
v_mfma_f32_32x32x16_bf16 v[136:151], v[192:195], v[76:79], v[136:151]
ds_read_b128 v[248:251], v14 offset:64
ds_read_b128 v[252:255], v14 offset:96
v_mfma_f32_32x32x16_bf16 v[152:167], v[76:79], v[196:199], v[152:167]
ds_read_b128 v[168:171], v14 offset:128
ds_read_b128 v[172:175], v14 offset:160
buffer_load_dwordx4 v[112:115], v1, s[4:7], s24 offen offset:2048
ds_read_b128 v[192:195], v1 offset:16384
ds_read_b128 v[196:199], v1 offset:45056
s_waitcnt vmcnt(8)
s_waitcnt lgkmcnt(10)
v_mfma_f32_32x32x16_bf16 v[136:151], v[200:203], v[80:83], v[136:151]
ds_read_b128 v[176:179], v14 offset:192
ds_read_b128 v[180:183], v14 offset:224
v_mfma_f32_32x32x16_bf16 v[152:167], v[80:83], v[204:207], v[152:167]
v_lshlrev_b32 v15, 4, v2
v_add_u32 v15, 159744, v15
buffer_load_dwordx4 v[116:119], v1, s[4:7], s24 offen offset:3072
ds_read_b128 v[200:203], v1 offset:17408
ds_read_b128 v[204:207], v1 offset:46080
s_waitcnt vmcnt(8)
s_waitcnt lgkmcnt(10)
v_mfma_f32_32x32x16_bf16 v[136:151], v[184:187], v[84:87], v[136:151]
ds_read_b128 v[224:227], v15 offset:0
ds_read_b128 v[228:231], v15 offset:32
v_mfma_f32_32x32x16_bf16 v[152:167], v[84:87], v[188:191], v[152:167]
ds_read_b128 v[232:235], v15 offset:64
ds_read_b128 v[236:239], v15 offset:96
s_add_u32 s24, s24, 4096
buffer_load_dwordx4 v[120:123], v1, s[4:7], s24 offen offset:0
ds_read_b128 v[184:187], v1 offset:18432
ds_read_b128 v[188:191], v1 offset:47104
s_waitcnt vmcnt(8)
s_waitcnt lgkmcnt(10)
v_mfma_f32_32x32x16_bf16 v[136:151], v[192:195], v[88:91], v[136:151]
v_lshlrev_b32 v15, 2, v3
v_add_u32 v15, 159872, v15
v_mfma_f32_32x32x16_bf16 v[152:167], v[88:91], v[196:199], v[152:167]
ds_read_b32 v208, v15
buffer_load_dwordx4 v[124:127], v1, s[4:7], s24 offen offset:1024
ds_read_b128 v[192:195], v1 offset:19456
ds_read_b128 v[196:199], v1 offset:48128
s_waitcnt vmcnt(8)
s_waitcnt lgkmcnt(9)
v_mfma_f32_32x32x16_bf16 v[136:151], v[200:203], v[92:95], v[136:151]
v_mfma_f32_32x32x16_bf16 v[152:167], v[92:95], v[204:207], v[152:167]
buffer_load_dwordx4 v[128:131], v1, s[4:7], s24 offen offset:2048
ds_read_b128 v[200:203], v1 offset:20480
ds_read_b128 v[204:207], v1 offset:49152
s_waitcnt vmcnt(8)
s_waitcnt lgkmcnt(5)
v_mfma_f32_32x32x16_bf16 v[136:151], v[184:187], v[96:99], v[136:151]
v_mfma_f32_32x32x16_bf16 v[152:167], v[96:99], v[188:191], v[152:167]
buffer_load_dwordx4 v[132:135], v1, s[4:7], s24 offen offset:3072
ds_read_b128 v[184:187], v1 offset:21504
ds_read_b128 v[188:191], v1 offset:50176
s_waitcnt vmcnt(8)
s_waitcnt lgkmcnt(4)
v_mfma_f32_32x32x16_bf16 v[136:151], v[192:195], v[100:103], v[136:151]
v_mfma_f32_32x32x16_bf16 v[152:167], v[100:103], v[196:199], v[152:167]
s_mul_i32 s20, s13, 86016
s_mul_i32 s21, s14, 7168
s_add_u32 s20, s20, s21
s_add_u32 s20, s20, 2154496
s_add_u32 s21, s21, 57344
s_mov_b32 m0, s21
s_nop 0
buffer_load_dwordx4 v1, s[4:7], s20 offen offset:0 lds
ds_read_b128 v[192:195], v1 offset:22528
ds_read_b128 v[196:199], v1 offset:51200
s_waitcnt vmcnt(8)
s_waitcnt lgkmcnt(4)
v_mfma_f32_32x32x16_bf16 v[136:151], v[200:203], v[104:107], v[136:151]
v_mfma_f32_32x32x16_bf16 v[152:167], v[104:107], v[204:207], v[152:167]
buffer_load_dwordx4 v1, s[4:7], s20 offen offset:1024 lds
ds_read_b128 v[200:203], v1 offset:23552
ds_read_b128 v[204:207], v1 offset:52224
s_waitcnt vmcnt(8)
s_waitcnt lgkmcnt(4)
v_mfma_f32_32x32x16_bf16 v[136:151], v[184:187], v[108:111], v[136:151]
v_mfma_f32_32x32x16_bf16 v[152:167], v[108:111], v[188:191], v[152:167]
buffer_load_dwordx4 v1, s[4:7], s20 offen offset:2048 lds
ds_read_b128 v[184:187], v1 offset:24576
ds_read_b128 v[188:191], v1 offset:53248
s_waitcnt vmcnt(8)
s_waitcnt lgkmcnt(4)
v_mfma_f32_32x32x16_bf16 v[136:151], v[192:195], v[112:115], v[136:151]
v_mfma_f32_32x32x16_bf16 v[152:167], v[112:115], v[196:199], v[152:167]
buffer_load_dwordx4 v1, s[4:7], s20 offen offset:3072 lds
s_add_u32 s20, s20, 4096
s_add_u32 s21, s21, 4096
ds_read_b128 v[192:195], v1 offset:25600
ds_read_b128 v[196:199], v1 offset:54272
s_waitcnt vmcnt(8)
s_waitcnt lgkmcnt(4)
v_mfma_f32_32x32x16_bf16 v[136:151], v[200:203], v[116:119], v[136:151]
v_mfma_f32_32x32x16_bf16 v[152:167], v[116:119], v[204:207], v[152:167]
s_mov_b32 m0, s21
s_nop 0
buffer_load_dwordx4 v1, s[4:7], s20 offen offset:0 lds
ds_read_b128 v[200:203], v1 offset:26624
ds_read_b128 v[204:207], v1 offset:55296
s_waitcnt vmcnt(8)
s_waitcnt lgkmcnt(4)
v_mfma_f32_32x32x16_bf16 v[136:151], v[184:187], v[120:123], v[136:151]
v_mfma_f32_32x32x16_bf16 v[152:167], v[120:123], v[188:191], v[152:167]
buffer_load_dwordx4 v1, s[4:7], s20 offen offset:1024 lds
ds_read_b128 v[184:187], v1 offset:27648
ds_read_b128 v[188:191], v1 offset:56320
s_waitcnt vmcnt(8)
s_waitcnt lgkmcnt(4)
v_mfma_f32_32x32x16_bf16 v[136:151], v[192:195], v[124:127], v[136:151]
v_mfma_f32_32x32x16_bf16 v[152:167], v[124:127], v[196:199], v[152:167]
buffer_load_dwordx4 v1, s[4:7], s20 offen offset:2048 lds
s_waitcnt vmcnt(8)
s_waitcnt lgkmcnt(2)
v_mfma_f32_32x32x16_bf16 v[136:151], v[200:203], v[128:131], v[136:151]
v_mfma_f32_32x32x16_bf16 v[152:167], v[128:131], v[204:207], v[152:167]
s_waitcnt vmcnt(7)
s_waitcnt lgkmcnt(0)
v_mfma_f32_32x32x16_bf16 v[136:151], v[184:187], v[132:135], v[136:151]
v_mfma_f32_32x32x16_bf16 v[152:167], v[132:135], v[188:191], v[152:167]
s_waitcnt lgkmcnt(0)
s_mul_i32 s27, s15, 4194304
s_add_u32 s27, s27, 20971520
s_lshl_b32 s28, s13, 6
s_add_u32 s28, s28, s19
s_lshl_b32 s28, s28, 12
s_add_u32 s27, s27, s28
s_nop 3
v_pk_fma_f32 v[136:137], v[222:223], v[224:225], v[136:137] op_sel_hi:[0,1,1]
v_pk_fma_f32 v[138:139], v[222:223], v[226:227], v[138:139] op_sel_hi:[0,1,1]
v_pk_fma_f32 v[140:141], v[222:223], v[228:229], v[140:141] op_sel_hi:[0,1,1]
v_pk_fma_f32 v[142:143], v[222:223], v[230:231], v[142:143] op_sel_hi:[0,1,1]
v_pk_fma_f32 v[144:145], v[222:223], v[232:233], v[144:145] op_sel_hi:[0,1,1]
v_pk_fma_f32 v[146:147], v[222:223], v[234:235], v[146:147] op_sel_hi:[0,1,1]
v_pk_fma_f32 v[148:149], v[222:223], v[236:237], v[148:149] op_sel_hi:[0,1,1]
v_pk_fma_f32 v[150:151], v[222:223], v[238:239], v[150:151] op_sel_hi:[0,1,1]
v_pk_mul_f32 v[136:137], v[222:223], v[136:137] op_sel:[1,0] op_sel_hi:[1,1]
v_pk_mul_f32 v[138:139], v[222:223], v[138:139] op_sel:[1,0] op_sel_hi:[1,1]
v_pk_mul_f32 v[140:141], v[222:223], v[140:141] op_sel:[1,0] op_sel_hi:[1,1]
v_pk_mul_f32 v[142:143], v[222:223], v[142:143] op_sel:[1,0] op_sel_hi:[1,1]
v_pk_mul_f32 v[144:145], v[222:223], v[144:145] op_sel:[1,0] op_sel_hi:[1,1]
v_pk_mul_f32 v[146:147], v[222:223], v[146:147] op_sel:[1,0] op_sel_hi:[1,1]
v_pk_mul_f32 v[148:149], v[222:223], v[148:149] op_sel:[1,0] op_sel_hi:[1,1]
v_pk_mul_f32 v[150:151], v[222:223], v[150:151] op_sel:[1,0] op_sel_hi:[1,1]
v_cvt_pk_bf16_f32 v184, v136, v137
v_cvt_pk_bf16_f32 v185, v138, v139
v_cvt_pk_bf16_f32 v186, v140, v141
v_cvt_pk_bf16_f32 v187, v142, v143
v_cvt_pk_bf16_f32 v188, v144, v145
v_cvt_pk_bf16_f32 v189, v146, v147
v_cvt_pk_bf16_f32 v190, v148, v149
v_cvt_pk_bf16_f32 v191, v150, v151
v_mov_b32 v17, 0x3f803f80
v_mov_b32 v18, 0x3f80
v_cndmask_b32 v190, v190, v17, s[42:43]
v_cndmask_b32 v191, v191, v18, s[42:43]
v_mov_b32 v18, 0
buffer_store_dwordx4 v[184:187], v1, s[4:7], s27 offen sc1
buffer_store_dwordx4 v[188:191], v1, s[4:7], s27 offen offset:1024 sc1
v_mov_b32 v17, 0x3f803f80
v_cndmask_b32 v18, v18, v17, s[40:41]
v_mov_b32 v192, v18
v_mov_b32 v193, v18
v_mov_b32 v194, v18
v_mov_b32 v195, v18
v_mov_b32 v196, v18
v_mov_b32 v197, v18
v_mov_b32 v198, v18
v_mov_b32 v199, v18
v_pk_fma_f32 v[152:153], v[240:241], v[208:209], v[152:153] op_sel_hi:[1,0,1]
v_pk_fma_f32 v[154:155], v[242:243], v[208:209], v[154:155] op_sel_hi:[1,0,1]
v_pk_fma_f32 v[156:157], v[244:245], v[208:209], v[156:157] op_sel_hi:[1,0,1]
v_pk_fma_f32 v[158:159], v[246:247], v[208:209], v[158:159] op_sel_hi:[1,0,1]
v_pk_fma_f32 v[160:161], v[248:249], v[208:209], v[160:161] op_sel_hi:[1,0,1]
v_pk_fma_f32 v[162:163], v[250:251], v[208:209], v[162:163] op_sel_hi:[1,0,1]
v_pk_fma_f32 v[164:165], v[252:253], v[208:209], v[164:165] op_sel_hi:[1,0,1]
v_pk_fma_f32 v[166:167], v[254:255], v[208:209], v[166:167] op_sel_hi:[1,0,1]
v_pk_mul_f32 v[152:153], v[168:169], v[152:153]
v_pk_mul_f32 v[154:155], v[170:171], v[154:155]
v_pk_mul_f32 v[156:157], v[172:173], v[156:157]
v_pk_mul_f32 v[158:159], v[174:175], v[158:159]
v_pk_mul_f32 v[160:161], v[176:177], v[160:161]
v_pk_mul_f32 v[162:163], v[178:179], v[162:163]
v_pk_mul_f32 v[164:165], v[180:181], v[164:165]
v_pk_mul_f32 v[166:167], v[182:183], v[166:167]
s_mov_b32 exec_lo, 0x0fffffff
s_mov_b32 exec_hi, 0x0fffffff
v_cvt_pk_bf16_f32 v192, v152, v153
v_cvt_pk_bf16_f32 v193, v154, v155
v_cvt_pk_bf16_f32 v194, v156, v157
v_cvt_pk_bf16_f32 v195, v158, v159
v_cvt_pk_bf16_f32 v196, v160, v161
v_cvt_pk_bf16_f32 v197, v162, v163
v_cvt_pk_bf16_f32 v198, v164, v165
v_cvt_pk_bf16_f32 v199, v166, v167
s_mov_b64 exec, -1
buffer_store_dwordx4 v[192:195], v1, s[4:7], s27 offen offset:2048 sc1
buffer_store_dwordx4 v[196:199], v1, s[4:7], s27 offen offset:3072 sc1
s_lshl_b32 s28, s15, 4
s_add_u32 s28, s28, s13
s_lshl_b32 s28, s28, 6
s_add_u32 s28, s28, s19
s_lshl_b32 s28, s28, 2
s_add_u32 s28, s28, 0
s_waitcnt vmcnt(0)
v_mov_b32 v16, s16
v_mov_b32 v17, 0
s_mov_b64 exec, 1
buffer_store_dword v16, v17, s[4:7], s28 offen sc1
s_mov_b64 exec, -1
s_barrier
ds_read_b128 v[200:203], v13 offset:0
ds_read_b128 v[204:207], v13 offset:1024
ds_read_b128 v[240:243], v13 offset:2048
s_waitcnt lgkmcnt(2)
v_mfma_f32_32x32x16_bf16 v[168:183], v[200:203], v[24:27], 0
ds_read_b128 v[200:203], v13 offset:3072
s_waitcnt lgkmcnt(2)
v_mfma_f32_32x32x16_bf16 v[168:183], v[204:207], v[28:31], v[168:183]
ds_read_b128 v[204:207], v13 offset:4096
s_waitcnt lgkmcnt(2)
v_mfma_f32_32x32x16_bf16 v[168:183], v[240:243], v[32:35], v[168:183]
ds_read_b128 v[240:243], v13 offset:5120
s_waitcnt lgkmcnt(2)
v_mfma_f32_32x32x16_bf16 v[168:183], v[200:203], v[36:39], v[168:183]
ds_read_b128 v[200:203], v13 offset:6144
s_waitcnt lgkmcnt(2)
v_mfma_f32_32x32x16_bf16 v[168:183], v[204:207], v[40:43], v[168:183]
ds_read_b128 v[204:207], v13 offset:7168
s_waitcnt lgkmcnt(2)
v_mfma_f32_32x32x16_bf16 v[168:183], v[240:243], v[44:47], v[168:183]
ds_read_b128 v[240:243], v13 offset:8192
s_waitcnt lgkmcnt(2)
v_mfma_f32_32x32x16_bf16 v[168:183], v[200:203], v[48:51], v[168:183]
ds_read_b128 v[200:203], v13 offset:9216
s_waitcnt lgkmcnt(2)
v_mfma_f32_32x32x16_bf16 v[168:183], v[204:207], v[52:55], v[168:183]
ds_read_b128 v[204:207], v13 offset:10240
s_waitcnt lgkmcnt(2)
v_mfma_f32_32x32x16_bf16 v[168:183], v[240:243], v[56:59], v[168:183]
ds_read_b128 v[240:243], v13 offset:11264
s_waitcnt lgkmcnt(2)
v_mfma_f32_32x32x16_bf16 v[168:183], v[200:203], v[60:63], v[168:183]
ds_read_b128 v[200:203], v13 offset:12288
s_waitcnt lgkmcnt(2)
v_mfma_f32_32x32x16_bf16 v[168:183], v[204:207], v[64:67], v[168:183]
ds_read_b128 v[204:207], v13 offset:13312
s_waitcnt lgkmcnt(2)
v_mfma_f32_32x32x16_bf16 v[168:183], v[240:243], v[68:71], v[168:183]
ds_read_b128 v[240:243], v13 offset:14336
s_waitcnt lgkmcnt(2)
v_mfma_f32_32x32x16_bf16 v[168:183], v[200:203], v[72:75], v[168:183]
ds_read_b128 v[200:203], v13 offset:15360
s_waitcnt lgkmcnt(2)
v_mfma_f32_32x32x16_bf16 v[168:183], v[204:207], v[76:79], v[168:183]
ds_read_b128 v[204:207], v13 offset:16384
s_waitcnt lgkmcnt(2)
v_mfma_f32_32x32x16_bf16 v[168:183], v[240:243], v[80:83], v[168:183]
ds_read_b128 v[240:243], v13 offset:17408
s_waitcnt lgkmcnt(2)
v_mfma_f32_32x32x16_bf16 v[168:183], v[200:203], v[84:87], v[168:183]
ds_read_b128 v[200:203], v13 offset:18432
s_waitcnt lgkmcnt(2)
v_mfma_f32_32x32x16_bf16 v[168:183], v[204:207], v[88:91], v[168:183]
ds_read_b128 v[204:207], v13 offset:19456
s_waitcnt lgkmcnt(2)
v_mfma_f32_32x32x16_bf16 v[168:183], v[240:243], v[92:95], v[168:183]
ds_read_b128 v[240:243], v13 offset:20480
s_waitcnt lgkmcnt(2)
v_mfma_f32_32x32x16_bf16 v[168:183], v[200:203], v[96:99], v[168:183]
ds_read_b128 v[200:203], v13 offset:21504
s_waitcnt lgkmcnt(2)
v_mfma_f32_32x32x16_bf16 v[168:183], v[204:207], v[100:103], v[168:183]
ds_read_b128 v[204:207], v13 offset:22528
s_waitcnt lgkmcnt(2)
v_mfma_f32_32x32x16_bf16 v[168:183], v[240:243], v[104:107], v[168:183]
ds_read_b128 v[240:243], v13 offset:23552
s_waitcnt lgkmcnt(2)
v_mfma_f32_32x32x16_bf16 v[168:183], v[200:203], v[108:111], v[168:183]
ds_read_b128 v[200:203], v13 offset:24576
s_waitcnt lgkmcnt(2)
v_mfma_f32_32x32x16_bf16 v[168:183], v[204:207], v[112:115], v[168:183]
ds_read_b128 v[204:207], v13 offset:25600
s_waitcnt lgkmcnt(2)
v_mfma_f32_32x32x16_bf16 v[168:183], v[240:243], v[116:119], v[168:183]
ds_read_b128 v[240:243], v13 offset:26624
s_waitcnt lgkmcnt(2)
v_mfma_f32_32x32x16_bf16 v[168:183], v[200:203], v[120:123], v[168:183]
ds_read_b128 v[200:203], v13 offset:27648
s_waitcnt lgkmcnt(2)
v_mfma_f32_32x32x16_bf16 v[168:183], v[204:207], v[124:127], v[168:183]
s_waitcnt lgkmcnt(1)
v_mfma_f32_32x32x16_bf16 v[168:183], v[240:243], v[128:131], v[168:183]
s_waitcnt lgkmcnt(0)
v_mfma_f32_32x32x16_bf16 v[168:183], v[200:203], v[132:135], v[168:183]
v_lshlrev_b32 v15, 4, v2
v_add_u32 v15, 160000, v15
ds_read_b128 v[224:227], v15 offset:0
ds_read_b128 v[228:231], v15 offset:32
ds_read_b128 v[232:235], v15 offset:64
ds_read_b128 v[236:239], v15 offset:96
s_waitcnt lgkmcnt(0)
v_mul_f32 v223, 0x3e8b97f6, v223
s_nop 3
v_pk_fma_f32 v[168:169], v[222:223], v[224:225], v[168:169] op_sel_hi:[0,1,1]
v_pk_fma_f32 v[170:171], v[222:223], v[226:227], v[170:171] op_sel_hi:[0,1,1]
v_pk_fma_f32 v[172:173], v[222:223], v[228:229], v[172:173] op_sel_hi:[0,1,1]
v_pk_fma_f32 v[174:175], v[222:223], v[230:231], v[174:175] op_sel_hi:[0,1,1]
v_pk_fma_f32 v[176:177], v[222:223], v[232:233], v[176:177] op_sel_hi:[0,1,1]
v_pk_fma_f32 v[178:179], v[222:223], v[234:235], v[178:179] op_sel_hi:[0,1,1]
v_pk_fma_f32 v[180:181], v[222:223], v[236:237], v[180:181] op_sel_hi:[0,1,1]
v_pk_fma_f32 v[182:183], v[222:223], v[238:239], v[182:183] op_sel_hi:[0,1,1]
v_pk_mul_f32 v[168:169], v[222:223], v[168:169] op_sel:[1,0] op_sel_hi:[1,1]
v_pk_mul_f32 v[170:171], v[222:223], v[170:171] op_sel:[1,0] op_sel_hi:[1,1]
v_pk_mul_f32 v[172:173], v[222:223], v[172:173] op_sel:[1,0] op_sel_hi:[1,1]
v_pk_mul_f32 v[174:175], v[222:223], v[174:175] op_sel:[1,0] op_sel_hi:[1,1]
v_pk_mul_f32 v[176:177], v[222:223], v[176:177] op_sel:[1,0] op_sel_hi:[1,1]
v_pk_mul_f32 v[178:179], v[222:223], v[178:179] op_sel:[1,0] op_sel_hi:[1,1]
v_pk_mul_f32 v[180:181], v[222:223], v[180:181] op_sel:[1,0] op_sel_hi:[1,1]
v_pk_mul_f32 v[182:183], v[222:223], v[182:183] op_sel:[1,0] op_sel_hi:[1,1]
v_cvt_pk_bf16_f32 v136, v168, v169
v_cvt_pk_bf16_f32 v137, v170, v171
v_cvt_pk_bf16_f32 v138, v172, v173
v_cvt_pk_bf16_f32 v139, v174, v175
v_cvt_pk_bf16_f32 v140, v176, v177
v_cvt_pk_bf16_f32 v141, v178, v179
v_cvt_pk_bf16_f32 v142, v180, v181
v_cvt_pk_bf16_f32 v143, v182, v183
v_mov_b32 v17, 0
v_cndmask_b32 v142, v142, v17, s[42:43]
v_cndmask_b32 v143, v143, v17, s[42:43]
s_mul_i32 s26, s14, 12288
s_add_u32 s26, s26, 86016
v_add_u32 v14, s26, v1
ds_write_b128 v14, v[136:139]
ds_write_b128 v14, v[140:143] offset:1024
s_waitcnt lgkmcnt(0)
s_barrier
s_xor_b32 s26, s14, 0
s_mul_i32 s26, s26, 12288
s_add_u32 s26, s26, 86016
v_add_u32 v14, s26, v1
ds_read_b128 a[224:227], v14
ds_read_b128 a[228:231], v14 offset:1024
s_xor_b32 s26, s14, 1
s_mul_i32 s26, s26, 12288
s_add_u32 s26, s26, 86016
v_add_u32 v14, s26, v1
ds_read_b128 a[232:235], v14
ds_read_b128 a[236:239], v14 offset:1024
s_xor_b32 s26, s14, 2
s_mul_i32 s26, s26, 12288
s_add_u32 s26, s26, 86016
v_add_u32 v14, s26, v1
ds_read_b128 a[240:243], v14
ds_read_b128 a[244:247], v14 offset:1024
s_xor_b32 s26, s14, 3
s_mul_i32 s26, s26, 12288
s_add_u32 s26, s26, 86016
v_add_u32 v14, s26, v1
ds_read_b128 a[248:251], v14
ds_read_b128 a[252:255], v14 offset:1024
interleave_layers__softmax_full_mha__dense_activation_silu__prompt_kernel_att:
v_mov_b32 v88, v184
v_mov_b32 v89, v185
v_mov_b32 v90, v186
v_mov_b32 v91, v187
v_mov_b32 v92, v188
v_mov_b32 v93, v189
v_mov_b32 v94, v190
v_mov_b32 v95, v191
v_mov_b32 v96, v192
v_mov_b32 v97, v193
v_mov_b32 v98, v194
v_mov_b32 v99, v195
v_mov_b32 v100, v196
v_mov_b32 v101, v197
v_mov_b32 v102, v198
v_mov_b32 v103, v199
v_mov_b32 v24, 0
v_mov_b32 v25, 0
v_mov_b32 v26, 0
v_mov_b32 v27, 0
v_mov_b32 v28, 0
v_mov_b32 v29, 0
v_mov_b32 v30, 0
v_mov_b32 v31, 0
v_mov_b32 v32, 0
v_mov_b32 v33, 0
v_mov_b32 v34, 0
v_mov_b32 v35, 0
v_mov_b32 v36, 0
v_mov_b32 v37, 0
v_mov_b32 v38, 0
v_mov_b32 v39, 0
v_mov_b32 v40, 0
v_mov_b32 v41, 0
v_mov_b32 v42, 0
v_mov_b32 v43, 0
v_mov_b32 v44, 0
v_mov_b32 v45, 0
v_mov_b32 v46, 0
v_mov_b32 v47, 0
v_mov_b32 v48, 0
v_mov_b32 v49, 0
v_mov_b32 v50, 0
v_mov_b32 v51, 0
v_mov_b32 v52, 0
v_mov_b32 v53, 0
v_mov_b32 v54, 0
v_mov_b32 v55, 0
v_mov_b32 v56, 0
v_mov_b32 v57, 0
v_mov_b32 v58, 0
v_mov_b32 v59, 0
v_mov_b32 v60, 0
v_mov_b32 v61, 0
v_mov_b32 v62, 0
v_mov_b32 v63, 0
v_mov_b32 v64, 0
v_mov_b32 v65, 0
v_mov_b32 v66, 0
v_mov_b32 v67, 0
v_mov_b32 v68, 0
v_mov_b32 v69, 0
v_mov_b32 v70, 0
v_mov_b32 v71, 0
v_mov_b32 v72, 0
v_mov_b32 v73, 0
v_mov_b32 v74, 0
v_mov_b32 v75, 0
v_mov_b32 v76, 0
v_mov_b32 v77, 0
v_mov_b32 v78, 0
v_mov_b32 v79, 0
v_mov_b32 v80, 0
v_mov_b32 v81, 0
v_mov_b32 v82, 0
v_mov_b32 v83, 0
v_mov_b32 v84, 0
v_mov_b32 v85, 0
v_mov_b32 v86, 0
v_mov_b32 v87, 0
v_mov_b32 v184, 0
v_mov_b32 v185, 0
v_mov_b32 v186, 0
v_mov_b32 v187, 0
v_mov_b32 v188, 0
v_mov_b32 v189, 0
v_mov_b32 v190, 0
v_mov_b32 v191, 0
v_mov_b32 v192, 0
v_mov_b32 v193, 0
v_mov_b32 v194, 0
v_mov_b32 v195, 0
v_mov_b32 v196, 0
v_mov_b32 v197, 0
v_mov_b32 v198, 0
v_mov_b32 v199, 0
v_mov_b32 v148, 0
v_mov_b32 v149, 0
v_mov_b32 v150, 0
v_mov_b32 v151, 0
s_lshl_b32 s30, s18, 16
s_lshl_b32 s31, s14, 14
s_add_u32 s30, s30, s31
s_add_u32 s30, s30, 5373952
s_add_u32 s31, s31, 0
s_min_u32 s32, s13, 13
s_mul_i32 s32, s32, 114688
s_mul_i32 s33, s14, 7168
s_min_u32 s33, s33, 20480
s_add_u32 s32, s32, s33
s_add_u32 s32, s32, 3670016
s_add_u32 s33, s33, 65536
v_lshlrev_b32 v206, 7, v0
v_min_u32 v205, 15, v0
v_lshlrev_b32 v205, 7, v205
v_min_u32 v207, 3, v0
v_lshlrev_b32 v207, 7, v207
s_mul_i32 s34, s15, 2097152
s_add_u32 s34, s34, 16777216
s_lshl_b32 s28, s19, 4
s_add_u32 s28, s28, s13
s_lshl_b32 s28, s28, 11
s_add_u32 s34, s34, s28
s_mul_i32 s35, s15, 2097152
s_add_u32 s35, s35, 10485760
s_mul_i32 s36, s15, 229376
s_add_u32 s36, s36, 884736
s_mul_i32 s37, s15, 8388608
s_add_u32 s37, s37, 33554432
s_mul_i32 s26, s50, 28
s_lshl_b32 s27, s51, 1
s_add_u32 s26, s26, s27
s_lshl_b32 s26, s26, 10
s_add_u32 s35, s35, s26
s_mul_i32 s26, s50, 3584
s_add_u32 s36, s36, s26
s_lshr_b32 s26, s51, 1
s_lshl_b32 s26, s26, 9
s_add_u32 s36, s36, s26
s_mul_i32 s26, s19, 112
s_lshl_b32 s28, s13, 3
s_add_u32 s26, s26, s28
s_lshl_b32 s26, s26, 10
s_add_u32 s37, s37, s26
s_cmp_lt_u32 s13, 14
s_cbranch_scc1 Lt14_44
s_mov_b32 s35, s34
s_mov_b32 s36, s34
s_mov_b32 s37, s34
v_mov_b32 v206, v205
Lt14_44:
s_cmp_eq_u32 s15, 0
s_cbranch_scc1 Lt1_45
s_mov_b32 s37, s34
v_mov_b32 v206, v205
Lt1_45:
s_lshl_b32 s28, s15, 4
s_add_u32 s28, s28, s13
s_lshl_b32 s28, s28, 8
s_lshl_b32 s29, s14, 2
s_add_u32 s28, s28, s29
s_add_u32 s28, s28, 0
v_and_b32 v12, 15, v0
v_lshlrev_b32 v12, 4, v12
s_mov_b32 s44, 0
buffer_load_dword v16, v12, s[4:7], s28 offen sc1
buffer_load_dword v23, v12, s[4:7], s28 offen sc1
Lpoll_46:
s_waitcnt vmcnt(1)
v_cmp_ne_u32 vcc, s16, v16
s_add_u32 s44, s44, 1
s_cbranch_vccz Lok_47
buffer_load_dword v16, v12, s[4:7], s28 offen sc1
s_waitcnt vmcnt(1)
v_cmp_ne_u32 vcc, s16, v23
s_add_u32 s44, s44, 1
s_cbranch_vccz Lok_47
buffer_load_dword v23, v12, s[4:7], s28 offen sc1
s_cmp_lt_u32 s44, 0x400000
s_cbranch_scc1 Lpoll_46
s_branch interleave_layers__softmax_full_mha__dense_activation_silu__prompt_kernel_abort
Lok_47:
s_mul_i32 s24, s15, 4194304
s_add_u32 s24, s24, 20971520
s_lshl_b32 s26, s13, 18
s_lshl_b32 s27, s12, 14
s_add_u32 s26, s26, s27
s_add_u32 s24, s24, s26
s_mov_b32 s25, 65536
s_lshl_b32 s26, s14, 12
v_add_u32 v201, s26, v1
s_add_u32 s38, s24, s26
s_xor_b32 s24, s24, 16384
buffer_load_dwordx4 v[104:107], v201, s[4:7], s24 offen offset:0
buffer_load_dwordx4 v[108:111], v201, s[4:7], s24 offen offset:1024
buffer_load_dwordx4 v[112:115], v201, s[4:7], s24 offen offset:2048
buffer_load_dwordx4 v[116:119], v201, s[4:7], s24 offen offset:3072
s_waitcnt lgkmcnt(0)
v_mfma_f32_32x32x16_bf16 v[152:167], v[88:91], a[224:227], 0
v_mov_b32 v214, 0
buffer_load_dword v204, v214, s[4:7], s28 offen sc1
buffer_load_dword v204, v214, s[4:7], s28 offen sc1
s_xor_b32 s24, s24, 32768
buffer_load_dwordx4 v[120:123], v201, s[4:7], s24 offen offset:0
buffer_load_dwordx4 v[124:127], v201, s[4:7], s24 offen offset:1024
buffer_load_dwordx4 v[128:131], v201, s[4:7], s24 offen offset:2048
buffer_load_dwordx4 v[132:135], v201, s[4:7], s24 offen offset:3072
v_mfma_f32_32x32x16_bf16 v[152:167], v[92:95], a[228:231], v[152:167]
v_and_b32 v213, 15, v0
v_lshlrev_b32 v213, 2, v213
v_mov_b32 v212, v213
s_lshl_b32 s20, s18, 6
s_add_u32 s20, s20, 81920
s_mov_b32 s21, s20
s_mov_b32 s22, s20
s_mov_b32 s23, s20
s_mov_b32 s39, s30
s_mov_b32 s30, s38
s_mov_b32 s38, 0
s_mov_b32 s29, 0
s_mov_b32 m0, s31
s_cmp_eq_u32 s15, 0
s_cselect_b64 vcc, 1, 0
.p2align 6
Latt_48:
v_mfma_f32_32x32x16_bf16 v[168:183], v[88:91], a[232:235], 0
v_exp_f32 v152, v152
v_exp_f32 v153, v153
v_exp_f32 v154, v154
v_cvt_pk_bf16_f32 v184, v152, v153
v_exp_f32 v155, v155
v_mfma_f32_32x32x16_bf16 v[72:87], v[148:151], v[196:199], v[72:87]
s_xor_b32 s24, s24, 16384
buffer_load_dwordx4 v[136:139], v201, s[4:7], s24 offen offset:0
buffer_load_dwordx4 v[140:143], v201, s[4:7], s24 offen offset:1024
buffer_load_dwordx4 v[144:147], v201, s[4:7], s24 offen offset:2048
buffer_load_dwordx4 v[148:151], v201, s[4:7], s24 offen offset:3072
v_cvt_pk_bf16_f32 v185, v154, v155
v_exp_f32 v156, v156
v_exp_f32 v157, v157
v_exp_f32 v158, v158
v_cvt_pk_bf16_f32 v186, v156, v157
v_exp_f32 v159, v159
v_mfma_f32_32x32x16_bf16 v[168:183], v[92:95], a[236:239], v[168:183]
v_cvt_pk_bf16_f32 v187, v158, v159
v_exp_f32 v160, v160
v_exp_f32 v161, v161
v_exp_f32 v162, v162
v_cvt_pk_bf16_f32 v188, v160, v161
v_exp_f32 v163, v163
v_mfma_f32_32x32x16_bf16 v[24:39], v[96:99], v[184:187], v[24:39]
v_cvt_pk_bf16_f32 v189, v162, v163
v_exp_f32 v164, v164
v_exp_f32 v165, v165
v_exp_f32 v166, v166
v_exp_f32 v167, v167
v_cvt_pk_bf16_f32 v190, v164, v165
v_cvt_pk_bf16_f32 v191, v166, v167
v_mfma_f32_32x32x16_bf16 v[152:167], v[88:91], a[240:243], 0
v_exp_f32 v168, v168
v_exp_f32 v169, v169
v_exp_f32 v170, v170
v_cvt_pk_bf16_f32 v192, v168, v169
v_exp_f32 v171, v171
v_mfma_f32_32x32x16_bf16 v[24:39], v[100:103], v[188:191], v[24:39]
buffer_load_dwordx4 v1, s[4:7], s30 offen offset:0 lds
v_cvt_pk_bf16_f32 v193, v170, v171
v_exp_f32 v172, v172
v_exp_f32 v173, v173
v_exp_f32 v174, v174
v_cvt_pk_bf16_f32 v194, v172, v173
v_exp_f32 v175, v175
v_mfma_f32_32x32x16_bf16 v[152:167], v[92:95], a[244:247], v[152:167]
v_cvt_pk_bf16_f32 v195, v174, v175
v_exp_f32 v176, v176
v_exp_f32 v177, v177
v_exp_f32 v178, v178
v_cvt_pk_bf16_f32 v196, v176, v177
v_exp_f32 v179, v179
v_mfma_f32_32x32x16_bf16 v[40:55], v[96:99], v[192:195], v[40:55]
v_cvt_pk_bf16_f32 v197, v178, v179
v_exp_f32 v180, v180
v_exp_f32 v181, v181
v_exp_f32 v182, v182
v_exp_f32 v183, v183
v_cvt_pk_bf16_f32 v198, v180, v181
v_cvt_pk_bf16_f32 v199, v182, v183
v_mfma_f32_32x32x16_bf16 v[168:183], v[88:91], a[248:251], 0
v_exp_f32 v152, v152
v_exp_f32 v153, v153
v_exp_f32 v154, v154
v_cvt_pk_bf16_f32 v184, v152, v153
v_exp_f32 v155, v155
v_mfma_f32_32x32x16_bf16 v[40:55], v[100:103], v[196:199], v[40:55]
buffer_load_dwordx4 v1, s[4:7], s30 offen offset:1024 lds
s_add_u32 s30, s30, s38
s_add_u32 m0, m0, 2048
v_cvt_pk_bf16_f32 v185, v154, v155
v_exp_f32 v156, v156
v_exp_f32 v157, v157
v_exp_f32 v158, v158
v_cvt_pk_bf16_f32 v186, v156, v157
v_exp_f32 v159, v159
v_mfma_f32_32x32x16_bf16 v[168:183], v[92:95], a[252:255], v[168:183]
v_cvt_pk_bf16_f32 v187, v158, v159
v_exp_f32 v160, v160
v_exp_f32 v161, v161
v_exp_f32 v162, v162
v_cvt_pk_bf16_f32 v188, v160, v161
v_exp_f32 v163, v163
v_mfma_f32_32x32x16_bf16 v[56:71], v[96:99], v[184:187], v[56:71]
v_cvt_pk_bf16_f32 v189, v162, v163
v_exp_f32 v164, v164
v_exp_f32 v165, v165
v_exp_f32 v166, v166
v_exp_f32 v167, v167
v_cvt_pk_bf16_f32 v190, v164, v165
v_cvt_pk_bf16_f32 v191, v166, v167
s_waitcnt vmcnt(12)
v_mfma_f32_32x32x16_bf16 v[152:167], v[104:107], a[224:227], 0
v_exp_f32 v168, v168
v_exp_f32 v169, v169
v_exp_f32 v170, v170
v_cvt_pk_bf16_f32 v192, v168, v169
v_exp_f32 v171, v171
v_mfma_f32_32x32x16_bf16 v[56:71], v[100:103], v[188:191], v[56:71]
v_cvt_pk_bf16_f32 v193, v170, v171
v_exp_f32 v172, v172
v_exp_f32 v173, v173
v_exp_f32 v174, v174
v_cvt_pk_bf16_f32 v194, v172, v173
v_exp_f32 v175, v175
v_mfma_f32_32x32x16_bf16 v[152:167], v[108:111], a[228:231], v[152:167]
v_cvt_pk_bf16_f32 v195, v174, v175
v_exp_f32 v176, v176
v_exp_f32 v177, v177
v_exp_f32 v178, v178
v_cvt_pk_bf16_f32 v196, v176, v177
v_exp_f32 v179, v179
v_mfma_f32_32x32x16_bf16 v[72:87], v[96:99], v[192:195], v[72:87]
v_cvt_pk_bf16_f32 v197, v178, v179
v_exp_f32 v180, v180
v_exp_f32 v181, v181
v_exp_f32 v182, v182
v_exp_f32 v183, v183
v_cvt_pk_bf16_f32 v198, v180, v181
v_cvt_pk_bf16_f32 v199, v182, v183
v_mfma_f32_32x32x16_bf16 v[168:183], v[104:107], a[232:235], 0
v_exp_f32 v152, v152
v_exp_f32 v153, v153
v_exp_f32 v154, v154
v_cvt_pk_bf16_f32 v184, v152, v153
v_exp_f32 v155, v155
v_mfma_f32_32x32x16_bf16 v[72:87], v[100:103], v[196:199], v[72:87]
s_xor_b32 s24, s24, s25
buffer_load_dwordx4 v[88:91], v201, s[4:7], s24 offen offset:0
buffer_load_dwordx4 v[92:95], v201, s[4:7], s24 offen offset:1024
buffer_load_dwordx4 v[96:99], v201, s[4:7], s24 offen offset:2048
buffer_load_dwordx4 v[100:103], v201, s[4:7], s24 offen offset:3072
v_cvt_pk_bf16_f32 v185, v154, v155
v_exp_f32 v156, v156
v_exp_f32 v157, v157
v_exp_f32 v158, v158
v_cvt_pk_bf16_f32 v186, v156, v157
v_exp_f32 v159, v159
v_mfma_f32_32x32x16_bf16 v[168:183], v[108:111], a[236:239], v[168:183]
v_cvt_pk_bf16_f32 v187, v158, v159
v_exp_f32 v160, v160
v_exp_f32 v161, v161
v_exp_f32 v162, v162
v_cvt_pk_bf16_f32 v188, v160, v161
v_exp_f32 v163, v163
v_mfma_f32_32x32x16_bf16 v[24:39], v[112:115], v[184:187], v[24:39]
v_cvt_pk_bf16_f32 v189, v162, v163
v_exp_f32 v164, v164
v_exp_f32 v165, v165
v_exp_f32 v166, v166
v_exp_f32 v167, v167
v_cvt_pk_bf16_f32 v190, v164, v165
v_cvt_pk_bf16_f32 v191, v166, v167
v_mfma_f32_32x32x16_bf16 v[152:167], v[104:107], a[240:243], 0
v_exp_f32 v168, v168
v_exp_f32 v169, v169
v_exp_f32 v170, v170
v_cvt_pk_bf16_f32 v192, v168, v169
v_exp_f32 v171, v171
v_mfma_f32_32x32x16_bf16 v[24:39], v[116:119], v[188:191], v[24:39]
buffer_load_dwordx4 v1, s[4:7], s30 offen offset:0 lds
v_cvt_pk_bf16_f32 v193, v170, v171
v_exp_f32 v172, v172
v_exp_f32 v173, v173
v_exp_f32 v174, v174
v_cvt_pk_bf16_f32 v194, v172, v173
v_exp_f32 v175, v175
v_mfma_f32_32x32x16_bf16 v[152:167], v[108:111], a[244:247], v[152:167]
v_cvt_pk_bf16_f32 v195, v174, v175
v_exp_f32 v176, v176
v_exp_f32 v177, v177
v_exp_f32 v178, v178
v_cvt_pk_bf16_f32 v196, v176, v177
v_exp_f32 v179, v179
v_mfma_f32_32x32x16_bf16 v[40:55], v[112:115], v[192:195], v[40:55]
v_cvt_pk_bf16_f32 v197, v178, v179
v_exp_f32 v180, v180
v_exp_f32 v181, v181
v_exp_f32 v182, v182
v_exp_f32 v183, v183
v_cvt_pk_bf16_f32 v198, v180, v181
v_cvt_pk_bf16_f32 v199, v182, v183
v_mfma_f32_32x32x16_bf16 v[168:183], v[104:107], a[248:251], 0
v_exp_f32 v152, v152
v_exp_f32 v153, v153
v_exp_f32 v154, v154
v_cvt_pk_bf16_f32 v184, v152, v153
v_exp_f32 v155, v155
v_mfma_f32_32x32x16_bf16 v[40:55], v[116:119], v[196:199], v[40:55]
buffer_load_dwordx4 v1, s[4:7], s30 offen offset:1024 lds
s_add_u32 s30, s30, s38
s_add_u32 m0, m0, 2048
v_cvt_pk_bf16_f32 v185, v154, v155
v_exp_f32 v156, v156
v_exp_f32 v157, v157
v_exp_f32 v158, v158
v_cvt_pk_bf16_f32 v186, v156, v157
v_exp_f32 v159, v159
v_mfma_f32_32x32x16_bf16 v[168:183], v[108:111], a[252:255], v[168:183]
v_cvt_pk_bf16_f32 v187, v158, v159
v_exp_f32 v160, v160
v_exp_f32 v161, v161
v_exp_f32 v162, v162
v_cvt_pk_bf16_f32 v188, v160, v161
v_exp_f32 v163, v163
v_mfma_f32_32x32x16_bf16 v[56:71], v[112:115], v[184:187], v[56:71]
v_cvt_pk_bf16_f32 v189, v162, v163
v_exp_f32 v164, v164
v_exp_f32 v165, v165
v_exp_f32 v166, v166
v_exp_f32 v167, v167
v_cvt_pk_bf16_f32 v190, v164, v165
v_cvt_pk_bf16_f32 v191, v166, v167
s_waitcnt vmcnt(12)
v_mfma_f32_32x32x16_bf16 v[152:167], v[120:123], a[224:227], 0
v_exp_f32 v168, v168
v_exp_f32 v169, v169
v_exp_f32 v170, v170
v_cvt_pk_bf16_f32 v192, v168, v169
v_exp_f32 v171, v171
v_mfma_f32_32x32x16_bf16 v[56:71], v[116:119], v[188:191], v[56:71]
v_cvt_pk_bf16_f32 v193, v170, v171
v_exp_f32 v172, v172
v_exp_f32 v173, v173
v_exp_f32 v174, v174
v_cvt_pk_bf16_f32 v194, v172, v173
v_exp_f32 v175, v175
v_mfma_f32_32x32x16_bf16 v[152:167], v[124:127], a[228:231], v[152:167]
v_cvt_pk_bf16_f32 v195, v174, v175
v_exp_f32 v176, v176
v_exp_f32 v177, v177
v_exp_f32 v178, v178
v_cvt_pk_bf16_f32 v196, v176, v177
v_exp_f32 v179, v179
v_mfma_f32_32x32x16_bf16 v[72:87], v[112:115], v[192:195], v[72:87]
v_cvt_pk_bf16_f32 v197, v178, v179
v_exp_f32 v180, v180
v_exp_f32 v181, v181
v_exp_f32 v182, v182
v_exp_f32 v183, v183
v_cvt_pk_bf16_f32 v198, v180, v181
v_cvt_pk_bf16_f32 v199, v182, v183
v_mfma_f32_32x32x16_bf16 v[168:183], v[120:123], a[232:235], 0
v_exp_f32 v152, v152
v_exp_f32 v153, v153
v_exp_f32 v154, v154
v_cvt_pk_bf16_f32 v184, v152, v153
v_exp_f32 v155, v155
v_mfma_f32_32x32x16_bf16 v[72:87], v[116:119], v[196:199], v[72:87]
s_xor_b32 s24, s24, 16384
buffer_load_dwordx4 v[104:107], v201, s[4:7], s24 offen offset:0
buffer_load_dwordx4 v[108:111], v201, s[4:7], s24 offen offset:1024
buffer_load_dwordx4 v[112:115], v201, s[4:7], s24 offen offset:2048
buffer_load_dwordx4 v[116:119], v201, s[4:7], s24 offen offset:3072
v_cvt_pk_bf16_f32 v185, v154, v155
v_exp_f32 v156, v156
v_exp_f32 v157, v157
v_exp_f32 v158, v158
v_cvt_pk_bf16_f32 v186, v156, v157
v_exp_f32 v159, v159
v_mfma_f32_32x32x16_bf16 v[168:183], v[124:127], a[236:239], v[168:183]
v_cvt_pk_bf16_f32 v187, v158, v159
v_exp_f32 v160, v160
v_exp_f32 v161, v161
v_exp_f32 v162, v162
v_cvt_pk_bf16_f32 v188, v160, v161
v_exp_f32 v163, v163
v_mfma_f32_32x32x16_bf16 v[24:39], v[128:131], v[184:187], v[24:39]
v_cvt_pk_bf16_f32 v189, v162, v163
v_exp_f32 v164, v164
v_exp_f32 v165, v165
v_exp_f32 v166, v166
v_exp_f32 v167, v167
v_cvt_pk_bf16_f32 v190, v164, v165
v_cvt_pk_bf16_f32 v191, v166, v167
v_mfma_f32_32x32x16_bf16 v[152:167], v[120:123], a[240:243], 0
v_exp_f32 v168, v168
v_exp_f32 v169, v169
v_exp_f32 v170, v170
v_cvt_pk_bf16_f32 v192, v168, v169
v_exp_f32 v171, v171
v_mfma_f32_32x32x16_bf16 v[24:39], v[132:135], v[188:191], v[24:39]
buffer_load_dwordx4 v1, s[4:7], s30 offen offset:0 lds
v_cvt_pk_bf16_f32 v193, v170, v171
v_exp_f32 v172, v172
v_exp_f32 v173, v173
v_exp_f32 v174, v174
v_cvt_pk_bf16_f32 v194, v172, v173
v_exp_f32 v175, v175
v_mfma_f32_32x32x16_bf16 v[152:167], v[124:127], a[244:247], v[152:167]
v_cvt_pk_bf16_f32 v195, v174, v175
v_exp_f32 v176, v176
v_exp_f32 v177, v177
v_exp_f32 v178, v178
v_cvt_pk_bf16_f32 v196, v176, v177
v_exp_f32 v179, v179
v_mfma_f32_32x32x16_bf16 v[40:55], v[128:131], v[192:195], v[40:55]
v_cvt_pk_bf16_f32 v197, v178, v179
v_exp_f32 v180, v180
v_exp_f32 v181, v181
v_exp_f32 v182, v182
v_exp_f32 v183, v183
v_cvt_pk_bf16_f32 v198, v180, v181
v_cvt_pk_bf16_f32 v199, v182, v183
v_mfma_f32_32x32x16_bf16 v[168:183], v[120:123], a[248:251], 0
v_exp_f32 v152, v152
v_exp_f32 v153, v153
v_exp_f32 v154, v154
v_cvt_pk_bf16_f32 v184, v152, v153
v_exp_f32 v155, v155
v_mfma_f32_32x32x16_bf16 v[40:55], v[132:135], v[196:199], v[40:55]
buffer_load_dwordx4 v1, s[4:7], s30 offen offset:1024 lds
s_add_u32 s30, s30, s38
s_add_u32 m0, m0, 2048
v_cvt_pk_bf16_f32 v185, v154, v155
v_exp_f32 v156, v156
v_exp_f32 v157, v157
v_exp_f32 v158, v158
v_cvt_pk_bf16_f32 v186, v156, v157
v_exp_f32 v159, v159
v_mfma_f32_32x32x16_bf16 v[168:183], v[124:127], a[252:255], v[168:183]
v_cvt_pk_bf16_f32 v187, v158, v159
v_exp_f32 v160, v160
v_exp_f32 v161, v161
v_exp_f32 v162, v162
v_cvt_pk_bf16_f32 v188, v160, v161
v_exp_f32 v163, v163
v_mfma_f32_32x32x16_bf16 v[56:71], v[128:131], v[184:187], v[56:71]
v_cvt_pk_bf16_f32 v189, v162, v163
v_exp_f32 v164, v164
v_exp_f32 v165, v165
v_exp_f32 v166, v166
v_exp_f32 v167, v167
v_cvt_pk_bf16_f32 v190, v164, v165
v_cvt_pk_bf16_f32 v191, v166, v167
s_waitcnt vmcnt(12)
v_mfma_f32_32x32x16_bf16 v[152:167], v[136:139], a[224:227], 0
v_exp_f32 v168, v168
v_exp_f32 v169, v169
v_exp_f32 v170, v170
v_cvt_pk_bf16_f32 v192, v168, v169
v_exp_f32 v171, v171
v_mfma_f32_32x32x16_bf16 v[56:71], v[132:135], v[188:191], v[56:71]
v_cvt_pk_bf16_f32 v193, v170, v171
v_exp_f32 v172, v172
v_exp_f32 v173, v173
v_exp_f32 v174, v174
v_cvt_pk_bf16_f32 v194, v172, v173
v_exp_f32 v175, v175
v_mfma_f32_32x32x16_bf16 v[152:167], v[140:143], a[228:231], v[152:167]
v_cvt_pk_bf16_f32 v195, v174, v175
v_exp_f32 v176, v176
v_exp_f32 v177, v177
v_exp_f32 v178, v178
v_cvt_pk_bf16_f32 v196, v176, v177
v_exp_f32 v179, v179
v_mfma_f32_32x32x16_bf16 v[72:87], v[128:131], v[192:195], v[72:87]
v_cvt_pk_bf16_f32 v197, v178, v179
v_exp_f32 v180, v180
v_exp_f32 v181, v181
v_exp_f32 v182, v182
v_exp_f32 v183, v183
v_cvt_pk_bf16_f32 v198, v180, v181
v_cvt_pk_bf16_f32 v199, v182, v183
v_mfma_f32_32x32x16_bf16 v[168:183], v[136:139], a[232:235], 0
v_exp_f32 v152, v152
v_exp_f32 v153, v153
v_exp_f32 v154, v154
v_cvt_pk_bf16_f32 v184, v152, v153
v_exp_f32 v155, v155
v_mfma_f32_32x32x16_bf16 v[72:87], v[132:135], v[196:199], v[72:87]
s_cbranch_vccz Lsmp_49
buffer_load_dword v208, v213, s[4:7], s20 offen sc1
buffer_load_dword v209, v213, s[4:7], s21 offen sc1
buffer_load_dword v210, v213, s[4:7], s22 offen sc1
buffer_load_dword v211, v212, s[4:7], s23 offen sc1
Lsmp_49:
s_xor_b32 s24, s24, 32768
buffer_load_dwordx4 v[120:123], v201, s[4:7], s24 offen offset:0
buffer_load_dwordx4 v[124:127], v201, s[4:7], s24 offen offset:1024
buffer_load_dwordx4 v[128:131], v201, s[4:7], s24 offen offset:2048
buffer_load_dwordx4 v[132:135], v201, s[4:7], s24 offen offset:3072
v_cvt_pk_bf16_f32 v185, v154, v155
v_exp_f32 v156, v156
v_exp_f32 v157, v157
v_exp_f32 v158, v158
v_cvt_pk_bf16_f32 v186, v156, v157
v_exp_f32 v159, v159
v_mfma_f32_32x32x16_bf16 v[168:183], v[140:143], a[236:239], v[168:183]
v_cvt_pk_bf16_f32 v187, v158, v159
v_exp_f32 v160, v160
v_exp_f32 v161, v161
v_exp_f32 v162, v162
v_cvt_pk_bf16_f32 v188, v160, v161
v_exp_f32 v163, v163
v_mfma_f32_32x32x16_bf16 v[24:39], v[144:147], v[184:187], v[24:39]
v_cvt_pk_bf16_f32 v189, v162, v163
v_exp_f32 v164, v164
v_exp_f32 v165, v165
v_exp_f32 v166, v166
v_exp_f32 v167, v167
v_cvt_pk_bf16_f32 v190, v164, v165
v_cvt_pk_bf16_f32 v191, v166, v167
v_mfma_f32_32x32x16_bf16 v[152:167], v[136:139], a[240:243], 0
v_exp_f32 v168, v168
v_exp_f32 v169, v169
v_exp_f32 v170, v170
v_cvt_pk_bf16_f32 v192, v168, v169
v_exp_f32 v171, v171
v_mfma_f32_32x32x16_bf16 v[24:39], v[148:151], v[188:191], v[24:39]
buffer_load_dwordx4 v1, s[4:7], s30 offen offset:0 lds
v_cvt_pk_bf16_f32 v193, v170, v171
v_exp_f32 v172, v172
v_exp_f32 v173, v173
v_exp_f32 v174, v174
v_cvt_pk_bf16_f32 v194, v172, v173
v_exp_f32 v175, v175
v_mfma_f32_32x32x16_bf16 v[152:167], v[140:143], a[244:247], v[152:167]
v_cvt_pk_bf16_f32 v195, v174, v175
v_exp_f32 v176, v176
v_exp_f32 v177, v177
v_exp_f32 v178, v178
v_cvt_pk_bf16_f32 v196, v176, v177
v_exp_f32 v179, v179
v_mfma_f32_32x32x16_bf16 v[40:55], v[144:147], v[192:195], v[40:55]
v_cvt_pk_bf16_f32 v197, v178, v179
v_exp_f32 v180, v180
v_exp_f32 v181, v181
v_exp_f32 v182, v182
v_exp_f32 v183, v183
v_cvt_pk_bf16_f32 v198, v180, v181
v_cvt_pk_bf16_f32 v199, v182, v183
v_mfma_f32_32x32x16_bf16 v[168:183], v[136:139], a[248:251], 0
v_exp_f32 v152, v152
v_exp_f32 v153, v153
v_exp_f32 v154, v154
v_cvt_pk_bf16_f32 v184, v152, v153
v_exp_f32 v155, v155
v_mfma_f32_32x32x16_bf16 v[40:55], v[148:151], v[196:199], v[40:55]
buffer_load_dwordx4 v1, s[4:7], s30 offen offset:1024 lds
s_add_u32 s30, s30, s38
s_add_u32 m0, m0, 2048
v_cvt_pk_bf16_f32 v185, v154, v155
v_exp_f32 v156, v156
v_exp_f32 v157, v157
v_exp_f32 v158, v158
v_cvt_pk_bf16_f32 v186, v156, v157
v_exp_f32 v159, v159
v_mfma_f32_32x32x16_bf16 v[168:183], v[140:143], a[252:255], v[168:183]
v_cvt_pk_bf16_f32 v187, v158, v159
v_exp_f32 v160, v160
v_exp_f32 v161, v161
v_exp_f32 v162, v162
v_cvt_pk_bf16_f32 v188, v160, v161
v_exp_f32 v163, v163
v_mfma_f32_32x32x16_bf16 v[56:71], v[144:147], v[184:187], v[56:71]
v_cvt_pk_bf16_f32 v189, v162, v163
v_exp_f32 v164, v164
v_exp_f32 v165, v165
v_exp_f32 v166, v166
v_exp_f32 v167, v167
v_cvt_pk_bf16_f32 v190, v164, v165
v_cvt_pk_bf16_f32 v191, v166, v167
s_waitcnt vmcnt(12)
v_mfma_f32_32x32x16_bf16 v[152:167], v[88:91], a[224:227], 0
v_exp_f32 v168, v168
v_exp_f32 v169, v169
v_exp_f32 v170, v170
v_cvt_pk_bf16_f32 v192, v168, v169
v_exp_f32 v171, v171
v_mfma_f32_32x32x16_bf16 v[56:71], v[148:151], v[188:191], v[56:71]
v_cvt_pk_bf16_f32 v193, v170, v171
v_exp_f32 v172, v172
v_exp_f32 v173, v173
v_exp_f32 v174, v174
v_cvt_pk_bf16_f32 v194, v172, v173
v_exp_f32 v175, v175
v_mfma_f32_32x32x16_bf16 v[152:167], v[92:95], a[228:231], v[152:167]
v_cvt_pk_bf16_f32 v195, v174, v175
v_exp_f32 v176, v176
v_exp_f32 v177, v177
v_exp_f32 v178, v178
v_cvt_pk_bf16_f32 v196, v176, v177
v_exp_f32 v179, v179
v_mfma_f32_32x32x16_bf16 v[72:87], v[144:147], v[192:195], v[72:87]
v_cvt_pk_bf16_f32 v197, v178, v179
v_exp_f32 v180, v180
v_exp_f32 v181, v181
v_exp_f32 v182, v182
v_exp_f32 v183, v183
v_cvt_pk_bf16_f32 v198, v180, v181
v_cvt_pk_bf16_f32 v199, v182, v183
s_xor_b32 s25, s25, 196608
s_mov_b32 s38, 2048
s_mov_b64 vcc, 0
s_add_u32 s29, s29, 1
s_cmp_lg_u32 s29, 1
s_cbranch_scc1 Le2_53
s_mov_b32 s30, s39
s_mov_b32 m0, s31
s_cmp_lg_u32 s15, 0
s_cbranch_scc1 Lnx_50
s_mov_b32 s44, 0
s_waitcnt vmcnt(6)
s_branch Lp0c_57
Lp0_56:
buffer_load_dword v208, v213, s[4:7], s20 offen sc1
buffer_load_dword v209, v213, s[4:7], s21 offen sc1
buffer_load_dword v210, v213, s[4:7], s22 offen sc1
buffer_load_dword v211, v212, s[4:7], s23 offen sc1
s_waitcnt vmcnt(0)
Lp0c_57:
v_xor_b32 v208, s16, v208
v_xor_b32 v209, s16, v209
v_xor_b32 v210, s16, v210
v_xor_b32 v211, s16, v211
v_or3_b32 v208, v208, v209, v210
v_or_b32 v208, v208, v211
v_cmp_ne_u32 vcc, 0, v208
s_add_u32 s44, s44, 1
s_cbranch_vccz Lc0_55
s_cmp_lt_u32 s44, 0x400000
s_cbranch_scc1 Lp0_56
s_branch interleave_layers__softmax_full_mha__dense_activation_silu__prompt_kernel_abort
Lc0_55:
v_lshlrev_b32 v213, 2, v0
v_mov_b32 v212, v213
s_lshl_b32 s20, s13, 8
s_add_u32 s20, s20, 81920
s_min_u32 s23, s13, 13
s_add_u32 s26, s23, 14
s_cmp_lt_u32 s23, 2
s_cselect_b32 s23, s26, s23
s_lshl_b32 s23, s23, 8
s_add_u32 s23, s23, 81920
s_add_u32 s26, s18, 14
s_cmp_lt_u32 s18, 2
s_cselect_b32 s21, s26, s18
s_lshl_b32 s21, s21, 8
s_add_u32 s21, s21, 81920
s_add_u32 s22, s18, 7
s_lshl_b32 s22, s22, 8
s_add_u32 s22, s22, 81920
s_mov_b64 vcc, 1
s_branch Lnx_50
Le2_53:
s_cmp_lg_u32 s15, 0
s_cbranch_scc1 Lnx_50
s_cmp_lg_u32 s29, 2
s_cbranch_scc1 Le3_54
s_mov_b32 s44, 0
s_waitcnt vmcnt(6)
s_branch Lp0c_60
Lp0_59:
buffer_load_dword v208, v213, s[4:7], s20 offen sc1
buffer_load_dword v209, v213, s[4:7], s21 offen sc1
buffer_load_dword v210, v213, s[4:7], s22 offen sc1
buffer_load_dword v211, v212, s[4:7], s23 offen sc1
s_waitcnt vmcnt(0)
Lp0c_60:
v_xor_b32 v208, s16, v208
v_xor_b32 v209, s16, v209
v_xor_b32 v210, s16, v210
v_xor_b32 v211, s16, v211
v_or3_b32 v208, v208, v209, v210
v_or_b32 v208, v208, v211
v_cmp_ne_u32 vcc, 0, v208
s_add_u32 s44, s44, 1
s_cbranch_vccz Lc1_58
s_cmp_lt_u32 s44, 0x400000
s_cbranch_scc1 Lp0_59
s_branch interleave_layers__softmax_full_mha__dense_activation_silu__prompt_kernel_abort
Lc1_58:
s_min_u32 s26, s13, 13
s_lshl_b32 s26, s26, 2
s_add_u32 s26, s26, s14
s_add_u32 s26, s26, 48
s_mul_i32 s26, s26, 3584
s_add_u32 s26, s26, 262144
v_mul_u32_u24 v214, 1792, v2
v_lshlrev_b32 v215, 2, v3
v_add_u32 v214, v214, v215
buffer_load_dword v216, v214, s[4:7], s26 offen offset:0
buffer_load_dword v217, v214, s[4:7], s26 offen offset:128
buffer_load_dword v218, v214, s[4:7], s26 offen offset:256
buffer_load_dword v219, v214, s[4:7], s26 offen offset:384
buffer_load_dword v220, v214, s[4:7], s26 offen offset:512
buffer_load_dword v221, v214, s[4:7], s26 offen offset:640
buffer_load_dword v222, v214, s[4:7], s26 offen offset:768
buffer_load_dword v223, v214, s[4:7], s26 offen offset:896
buffer_load_dword v224, v214, s[4:7], s26 offen offset:1024
buffer_load_dword v225, v214, s[4:7], s26 offen offset:1152
buffer_load_dword v226, v214, s[4:7], s26 offen offset:1280
buffer_load_dword v227, v214, s[4:7], s26 offen offset:1408
buffer_load_dword v228, v214, s[4:7], s26 offen offset:1536
buffer_load_dword v229, v214, s[4:7], s26 offen offset:1664
s_min_u32 s27, s14, 2
s_mul_i32 s26, s13, 3
s_add_u32 s26, s26, s27
s_mul_i32 s26, s26, 3584
s_add_u32 s26, s26, 262144
buffer_load_dword v230, v214, s[4:7], s26 offen offset:0
buffer_load_dword v231, v214, s[4:7], s26 offen offset:128
buffer_load_dword v232, v214, s[4:7], s26 offen offset:256
buffer_load_dword v233, v214, s[4:7], s26 offen offset:384
buffer_load_dword v234, v214, s[4:7], s26 offen offset:512
buffer_load_dword v235, v214, s[4:7], s26 offen offset:640
buffer_load_dword v236, v214, s[4:7], s26 offen offset:768
buffer_load_dword v237, v214, s[4:7], s26 offen offset:896
buffer_load_dword v238, v214, s[4:7], s26 offen offset:1024
buffer_load_dword v239, v214, s[4:7], s26 offen offset:1152
buffer_load_dword v240, v214, s[4:7], s26 offen offset:1280
buffer_load_dword v241, v214, s[4:7], s26 offen offset:1408
buffer_load_dword v242, v214, s[4:7], s26 offen offset:1536
buffer_load_dword v243, v214, s[4:7], s26 offen offset:1664
s_branch Lnx_50
Le3_54:
s_waitcnt vmcnt(12)
v_add_f32 v216, v216, v217
v_add_f32 v216, v216, v218
v_add_f32 v216, v216, v219
v_add_f32 v216, v216, v220
v_add_f32 v216, v216, v221
v_add_f32 v216, v216, v222
v_add_f32 v216, v216, v223
v_add_f32 v216, v216, v224
v_add_f32 v216, v216, v225
v_add_f32 v216, v216, v226
v_add_f32 v216, v216, v227
v_add_f32 v216, v216, v228
v_add_f32 v216, v216, v229
v_mov_b32 v217, v216
s_nop 1
v_permlane32_swap_b32 v216, v217
v_add_f32 v216, v216, v217
v_add_f32 v230, v230, v231
v_add_f32 v230, v230, v232
v_add_f32 v230, v230, v233
v_add_f32 v230, v230, v234
v_add_f32 v230, v230, v235
v_add_f32 v230, v230, v236
v_add_f32 v230, v230, v237
v_add_f32 v230, v230, v238
v_add_f32 v230, v230, v239
v_add_f32 v230, v230, v240
v_add_f32 v230, v230, v241
v_add_f32 v230, v230, v242
v_add_f32 v230, v230, v243
v_mov_b32 v231, v230
s_nop 1
v_permlane32_swap_b32 v230, v231
v_add_f32 v230, v230, v231
s_min_u32 s27, s14, 2
s_lshl_b32 s27, s27, 7
s_add_u32 s27, s27, 159744
v_add_u32 v217, s27, v215
ds_write_b32 v217, v230
s_lshl_b32 s26, s14, 7
s_add_u32 s26, s26, 160256
v_add_u32 v215, s26, v215
ds_write_b32 v215, v216
s_waitcnt lgkmcnt(0)
Lnx_50:
s_cmp_lt_u32 s29, 3
s_cbranch_scc1 Latt_48
s_mov_b32 s30, s32
s_mov_b32 m0, s33
v_mfma_f32_32x32x16_bf16 v[168:183], v[88:91], a[232:235], 0
v_exp_f32 v152, v152
v_exp_f32 v153, v153
v_exp_f32 v154, v154
v_cvt_pk_bf16_f32 v184, v152, v153
v_exp_f32 v155, v155
v_mfma_f32_32x32x16_bf16 v[72:87], v[148:151], v[196:199], v[72:87]
s_xor_b32 s24, s24, 16384
buffer_load_dwordx4 v[136:139], v201, s[4:7], s24 offen offset:0
buffer_load_dwordx4 v[140:143], v201, s[4:7], s24 offen offset:1024
buffer_load_dwordx4 v[144:147], v201, s[4:7], s24 offen offset:2048
buffer_load_dwordx4 v[148:151], v201, s[4:7], s24 offen offset:3072
v_cvt_pk_bf16_f32 v185, v154, v155
v_exp_f32 v156, v156
v_exp_f32 v157, v157
v_exp_f32 v158, v158
v_cvt_pk_bf16_f32 v186, v156, v157
v_exp_f32 v159, v159
v_mfma_f32_32x32x16_bf16 v[168:183], v[92:95], a[236:239], v[168:183]
v_cvt_pk_bf16_f32 v187, v158, v159
v_exp_f32 v160, v160
v_exp_f32 v161, v161
v_exp_f32 v162, v162
v_cvt_pk_bf16_f32 v188, v160, v161
v_exp_f32 v163, v163
v_mfma_f32_32x32x16_bf16 v[24:39], v[96:99], v[184:187], v[24:39]
v_cvt_pk_bf16_f32 v189, v162, v163
v_exp_f32 v164, v164
v_exp_f32 v165, v165
v_exp_f32 v166, v166
v_exp_f32 v167, v167
v_cvt_pk_bf16_f32 v190, v164, v165
v_cvt_pk_bf16_f32 v191, v166, v167
v_mfma_f32_32x32x16_bf16 v[152:167], v[88:91], a[240:243], 0
v_exp_f32 v168, v168
v_exp_f32 v169, v169
v_exp_f32 v170, v170
v_cvt_pk_bf16_f32 v192, v168, v169
v_exp_f32 v171, v171
v_mfma_f32_32x32x16_bf16 v[24:39], v[100:103], v[188:191], v[24:39]
buffer_load_dword v204, v205, s[4:7], s34 offen sc1
buffer_load_dwordx4 v1, s[4:7], s30 offen offset:0 lds
v_cvt_pk_bf16_f32 v193, v170, v171
v_exp_f32 v172, v172
v_exp_f32 v173, v173
v_exp_f32 v174, v174
v_cvt_pk_bf16_f32 v194, v172, v173
v_exp_f32 v175, v175
v_mfma_f32_32x32x16_bf16 v[152:167], v[92:95], a[244:247], v[152:167]
v_cvt_pk_bf16_f32 v195, v174, v175
v_exp_f32 v176, v176
v_exp_f32 v177, v177
v_exp_f32 v178, v178
v_cvt_pk_bf16_f32 v196, v176, v177
v_exp_f32 v179, v179
v_mfma_f32_32x32x16_bf16 v[40:55], v[96:99], v[192:195], v[40:55]
v_cvt_pk_bf16_f32 v197, v178, v179
v_exp_f32 v180, v180
v_exp_f32 v181, v181
v_exp_f32 v182, v182
v_exp_f32 v183, v183
v_cvt_pk_bf16_f32 v198, v180, v181
v_cvt_pk_bf16_f32 v199, v182, v183
v_mfma_f32_32x32x16_bf16 v[168:183], v[88:91], a[248:251], 0
v_exp_f32 v152, v152
v_exp_f32 v153, v153
v_exp_f32 v154, v154
v_cvt_pk_bf16_f32 v184, v152, v153
v_exp_f32 v155, v155
v_mfma_f32_32x32x16_bf16 v[40:55], v[100:103], v[196:199], v[40:55]
buffer_load_dword v204, v205, s[4:7], s35 offen sc1
buffer_load_dwordx4 v1, s[4:7], s30 offen offset:1024 lds
s_add_u32 s30, s30, 2048
s_add_u32 m0, m0, 2048
v_cvt_pk_bf16_f32 v185, v154, v155
v_exp_f32 v156, v156
v_exp_f32 v157, v157
v_exp_f32 v158, v158
v_cvt_pk_bf16_f32 v186, v156, v157
v_exp_f32 v159, v159
v_mfma_f32_32x32x16_bf16 v[168:183], v[92:95], a[252:255], v[168:183]
v_cvt_pk_bf16_f32 v187, v158, v159
v_exp_f32 v160, v160
v_exp_f32 v161, v161
v_exp_f32 v162, v162
v_cvt_pk_bf16_f32 v188, v160, v161
v_exp_f32 v163, v163
v_mfma_f32_32x32x16_bf16 v[56:71], v[96:99], v[184:187], v[56:71]
v_cvt_pk_bf16_f32 v189, v162, v163
v_exp_f32 v164, v164
v_exp_f32 v165, v165
v_exp_f32 v166, v166
v_exp_f32 v167, v167
v_cvt_pk_bf16_f32 v190, v164, v165
v_cvt_pk_bf16_f32 v191, v166, v167
s_waitcnt vmcnt(12)
v_mfma_f32_32x32x16_bf16 v[152:167], v[104:107], a[224:227], 0
v_exp_f32 v168, v168
v_exp_f32 v169, v169
v_exp_f32 v170, v170
v_cvt_pk_bf16_f32 v192, v168, v169
v_exp_f32 v171, v171
v_mfma_f32_32x32x16_bf16 v[56:71], v[100:103], v[188:191], v[56:71]
s_cmp_lg_u32 s15, 0
s_cbranch_scc1 Lxr_61
v_mul_u32_u24 v214, 896, v3
v_lshlrev_b32 v215, 3, v2
v_add_u32 v214, v214, v215
s_mul_i32 s22, s50, 28672
s_lshl_b32 s23, s51, 6
s_add_u32 s22, s22, s23
buffer_load_dwordx2 v[4:5], v214, s[56:59], s22 offen offset:0
Lxr_61:
v_cvt_pk_bf16_f32 v193, v170, v171
v_exp_f32 v172, v172
v_exp_f32 v173, v173
v_exp_f32 v174, v174
v_cvt_pk_bf16_f32 v194, v172, v173
v_exp_f32 v175, v175
v_mfma_f32_32x32x16_bf16 v[152:167], v[108:111], a[228:231], v[152:167]
v_cvt_pk_bf16_f32 v195, v174, v175
v_exp_f32 v176, v176
v_exp_f32 v177, v177
v_exp_f32 v178, v178
v_cvt_pk_bf16_f32 v196, v176, v177
v_exp_f32 v179, v179
v_mfma_f32_32x32x16_bf16 v[72:87], v[96:99], v[192:195], v[72:87]
v_cvt_pk_bf16_f32 v197, v178, v179
v_exp_f32 v180, v180
v_exp_f32 v181, v181
v_exp_f32 v182, v182
v_exp_f32 v183, v183
v_cvt_pk_bf16_f32 v198, v180, v181
v_cvt_pk_bf16_f32 v199, v182, v183
v_mfma_f32_32x32x16_bf16 v[168:183], v[104:107], a[232:235], 0
v_exp_f32 v152, v152
v_exp_f32 v153, v153
v_exp_f32 v154, v154
v_cvt_pk_bf16_f32 v184, v152, v153
v_exp_f32 v155, v155
v_mfma_f32_32x32x16_bf16 v[72:87], v[100:103], v[196:199], v[72:87]
buffer_load_dword v204, v207, s[4:7], s36 offen sc1
v_cvt_pk_bf16_f32 v185, v154, v155
v_exp_f32 v156, v156
v_exp_f32 v157, v157
v_exp_f32 v158, v158
v_cvt_pk_bf16_f32 v186, v156, v157
v_exp_f32 v159, v159
v_mfma_f32_32x32x16_bf16 v[168:183], v[108:111], a[236:239], v[168:183]
v_cvt_pk_bf16_f32 v187, v158, v159
v_exp_f32 v160, v160
v_exp_f32 v161, v161
v_exp_f32 v162, v162
v_cvt_pk_bf16_f32 v188, v160, v161
v_exp_f32 v163, v163
v_mfma_f32_32x32x16_bf16 v[24:39], v[112:115], v[184:187], v[24:39]
v_cvt_pk_bf16_f32 v189, v162, v163
v_exp_f32 v164, v164
v_exp_f32 v165, v165
v_exp_f32 v166, v166
v_exp_f32 v167, v167
v_cvt_pk_bf16_f32 v190, v164, v165
v_cvt_pk_bf16_f32 v191, v166, v167
v_mfma_f32_32x32x16_bf16 v[152:167], v[104:107], a[240:243], 0
v_exp_f32 v168, v168
v_exp_f32 v169, v169
v_exp_f32 v170, v170
v_cvt_pk_bf16_f32 v192, v168, v169
v_exp_f32 v171, v171
v_mfma_f32_32x32x16_bf16 v[24:39], v[116:119], v[188:191], v[24:39]
buffer_load_dword v204, v206, s[4:7], s37 offen sc1
buffer_load_dwordx4 v1, s[4:7], s30 offen offset:0 lds
v_cvt_pk_bf16_f32 v193, v170, v171
v_exp_f32 v172, v172
v_exp_f32 v173, v173
v_exp_f32 v174, v174
v_cvt_pk_bf16_f32 v194, v172, v173
v_exp_f32 v175, v175
v_mfma_f32_32x32x16_bf16 v[152:167], v[108:111], a[244:247], v[152:167]
v_cvt_pk_bf16_f32 v195, v174, v175
v_exp_f32 v176, v176
v_exp_f32 v177, v177
v_exp_f32 v178, v178
v_cvt_pk_bf16_f32 v196, v176, v177
v_exp_f32 v179, v179
v_mfma_f32_32x32x16_bf16 v[40:55], v[112:115], v[192:195], v[40:55]
v_cvt_pk_bf16_f32 v197, v178, v179
v_exp_f32 v180, v180
v_exp_f32 v181, v181
v_exp_f32 v182, v182
v_exp_f32 v183, v183
v_cvt_pk_bf16_f32 v198, v180, v181
v_cvt_pk_bf16_f32 v199, v182, v183
v_mfma_f32_32x32x16_bf16 v[168:183], v[104:107], a[248:251], 0
v_exp_f32 v152, v152
v_exp_f32 v153, v153
v_exp_f32 v154, v154
v_cvt_pk_bf16_f32 v184, v152, v153
v_exp_f32 v155, v155
v_mfma_f32_32x32x16_bf16 v[40:55], v[116:119], v[196:199], v[40:55]
buffer_load_dwordx4 v1, s[4:7], s30 offen offset:1024 lds
s_add_u32 s30, s30, 2048
s_add_u32 m0, m0, 2048
v_cvt_pk_bf16_f32 v185, v154, v155
v_exp_f32 v156, v156
v_exp_f32 v157, v157
v_exp_f32 v158, v158
v_cvt_pk_bf16_f32 v186, v156, v157
v_exp_f32 v159, v159
v_mfma_f32_32x32x16_bf16 v[168:183], v[108:111], a[252:255], v[168:183]
v_cvt_pk_bf16_f32 v187, v158, v159
v_exp_f32 v160, v160
v_exp_f32 v161, v161
v_exp_f32 v162, v162
v_cvt_pk_bf16_f32 v188, v160, v161
v_exp_f32 v163, v163
v_mfma_f32_32x32x16_bf16 v[56:71], v[112:115], v[184:187], v[56:71]
v_cvt_pk_bf16_f32 v189, v162, v163
v_exp_f32 v164, v164
v_exp_f32 v165, v165
v_exp_f32 v166, v166
v_exp_f32 v167, v167
v_cvt_pk_bf16_f32 v190, v164, v165
v_cvt_pk_bf16_f32 v191, v166, v167
s_waitcnt vmcnt(12)
v_mfma_f32_32x32x16_bf16 v[152:167], v[120:123], a[224:227], 0
v_exp_f32 v168, v168
v_exp_f32 v169, v169
v_exp_f32 v170, v170
v_cvt_pk_bf16_f32 v192, v168, v169
v_exp_f32 v171, v171
v_mfma_f32_32x32x16_bf16 v[56:71], v[116:119], v[188:191], v[56:71]
s_cmp_lg_u32 s15, 0
s_cbranch_scc1 Lxr_62
buffer_load_dwordx2 v[6:7], v214, s[56:59], s22 offen offset:16
Lxr_62:
v_cvt_pk_bf16_f32 v193, v170, v171
v_exp_f32 v172, v172
v_exp_f32 v173, v173
v_exp_f32 v174, v174
v_cvt_pk_bf16_f32 v194, v172, v173
v_exp_f32 v175, v175
v_mfma_f32_32x32x16_bf16 v[152:167], v[124:127], a[228:231], v[152:167]
v_cvt_pk_bf16_f32 v195, v174, v175
v_exp_f32 v176, v176
v_exp_f32 v177, v177
v_exp_f32 v178, v178
v_cvt_pk_bf16_f32 v196, v176, v177
v_exp_f32 v179, v179
v_mfma_f32_32x32x16_bf16 v[72:87], v[112:115], v[192:195], v[72:87]
v_cvt_pk_bf16_f32 v197, v178, v179
v_exp_f32 v180, v180
v_exp_f32 v181, v181
v_exp_f32 v182, v182
v_exp_f32 v183, v183
v_cvt_pk_bf16_f32 v198, v180, v181
v_cvt_pk_bf16_f32 v199, v182, v183
v_mfma_f32_32x32x16_bf16 v[168:183], v[120:123], a[232:235], 0
v_exp_f32 v152, v152
v_exp_f32 v153, v153
v_exp_f32 v154, v154
v_cvt_pk_bf16_f32 v184, v152, v153
v_exp_f32 v155, v155
v_mfma_f32_32x32x16_bf16 v[72:87], v[116:119], v[196:199], v[72:87]
v_cvt_pk_bf16_f32 v185, v154, v155
v_exp_f32 v156, v156
v_exp_f32 v157, v157
v_exp_f32 v158, v158
v_cvt_pk_bf16_f32 v186, v156, v157
v_exp_f32 v159, v159
v_mfma_f32_32x32x16_bf16 v[168:183], v[124:127], a[236:239], v[168:183]
v_cvt_pk_bf16_f32 v187, v158, v159
v_exp_f32 v160, v160
v_exp_f32 v161, v161
v_exp_f32 v162, v162
v_cvt_pk_bf16_f32 v188, v160, v161
v_exp_f32 v163, v163
v_mfma_f32_32x32x16_bf16 v[24:39], v[128:131], v[184:187], v[24:39]
v_cvt_pk_bf16_f32 v189, v162, v163
v_exp_f32 v164, v164
v_exp_f32 v165, v165
v_exp_f32 v166, v166
v_exp_f32 v167, v167
v_cvt_pk_bf16_f32 v190, v164, v165
v_cvt_pk_bf16_f32 v191, v166, v167
v_mfma_f32_32x32x16_bf16 v[152:167], v[120:123], a[240:243], 0
v_exp_f32 v168, v168
v_exp_f32 v169, v169
v_exp_f32 v170, v170
v_cvt_pk_bf16_f32 v192, v168, v169
v_exp_f32 v171, v171
v_mfma_f32_32x32x16_bf16 v[24:39], v[132:135], v[188:191], v[24:39]
buffer_load_dwordx4 v1, s[4:7], s30 offen offset:0 lds
v_cvt_pk_bf16_f32 v193, v170, v171
v_exp_f32 v172, v172
v_exp_f32 v173, v173
v_exp_f32 v174, v174
v_cvt_pk_bf16_f32 v194, v172, v173
v_exp_f32 v175, v175
v_mfma_f32_32x32x16_bf16 v[152:167], v[124:127], a[244:247], v[152:167]
v_cvt_pk_bf16_f32 v195, v174, v175
v_exp_f32 v176, v176
v_exp_f32 v177, v177
v_exp_f32 v178, v178
v_cvt_pk_bf16_f32 v196, v176, v177
v_exp_f32 v179, v179
v_mfma_f32_32x32x16_bf16 v[40:55], v[128:131], v[192:195], v[40:55]
v_cvt_pk_bf16_f32 v197, v178, v179
v_exp_f32 v180, v180
v_exp_f32 v181, v181
v_exp_f32 v182, v182
v_exp_f32 v183, v183
v_cvt_pk_bf16_f32 v198, v180, v181
v_cvt_pk_bf16_f32 v199, v182, v183
v_mfma_f32_32x32x16_bf16 v[168:183], v[120:123], a[248:251], 0
v_exp_f32 v152, v152
v_exp_f32 v153, v153
v_exp_f32 v154, v154
v_cvt_pk_bf16_f32 v184, v152, v153
v_exp_f32 v155, v155
v_mfma_f32_32x32x16_bf16 v[40:55], v[132:135], v[196:199], v[40:55]
buffer_load_dwordx4 v1, s[4:7], s30 offen offset:1024 lds
s_add_u32 s30, s30, 2048
s_add_u32 m0, m0, 2048
v_cvt_pk_bf16_f32 v185, v154, v155
v_exp_f32 v156, v156
v_exp_f32 v157, v157
v_exp_f32 v158, v158
v_cvt_pk_bf16_f32 v186, v156, v157
v_exp_f32 v159, v159
v_mfma_f32_32x32x16_bf16 v[168:183], v[124:127], a[252:255], v[168:183]
v_cvt_pk_bf16_f32 v187, v158, v159
v_exp_f32 v160, v160
v_exp_f32 v161, v161
v_exp_f32 v162, v162
v_cvt_pk_bf16_f32 v188, v160, v161
v_exp_f32 v163, v163
v_mfma_f32_32x32x16_bf16 v[56:71], v[128:131], v[184:187], v[56:71]
v_cvt_pk_bf16_f32 v189, v162, v163
v_exp_f32 v164, v164
v_exp_f32 v165, v165
v_exp_f32 v166, v166
v_exp_f32 v167, v167
v_cvt_pk_bf16_f32 v190, v164, v165
v_cvt_pk_bf16_f32 v191, v166, v167
s_waitcnt vmcnt(10)
v_mfma_f32_32x32x16_bf16 v[152:167], v[136:139], a[224:227], 0
v_exp_f32 v168, v168
v_exp_f32 v169, v169
v_exp_f32 v170, v170
v_cvt_pk_bf16_f32 v192, v168, v169
v_exp_f32 v171, v171
v_mfma_f32_32x32x16_bf16 v[56:71], v[132:135], v[188:191], v[56:71]
s_cmp_lg_u32 s15, 0
s_cbranch_scc1 Lxr_63
buffer_load_dwordx2 v[8:9], v214, s[56:59], s22 offen offset:32
Lxr_63:
v_cvt_pk_bf16_f32 v193, v170, v171
v_exp_f32 v172, v172
v_exp_f32 v173, v173
v_exp_f32 v174, v174
v_cvt_pk_bf16_f32 v194, v172, v173
v_exp_f32 v175, v175
v_mfma_f32_32x32x16_bf16 v[152:167], v[140:143], a[228:231], v[152:167]
v_cvt_pk_bf16_f32 v195, v174, v175
v_exp_f32 v176, v176
v_exp_f32 v177, v177
v_exp_f32 v178, v178
v_cvt_pk_bf16_f32 v196, v176, v177
v_exp_f32 v179, v179
v_mfma_f32_32x32x16_bf16 v[72:87], v[128:131], v[192:195], v[72:87]
v_cvt_pk_bf16_f32 v197, v178, v179
v_exp_f32 v180, v180
v_exp_f32 v181, v181
v_exp_f32 v182, v182
v_exp_f32 v183, v183
v_cvt_pk_bf16_f32 v198, v180, v181
v_cvt_pk_bf16_f32 v199, v182, v183
v_mfma_f32_32x32x16_bf16 v[168:183], v[136:139], a[232:235], 0
v_exp_f32 v152, v152
v_exp_f32 v153, v153
v_exp_f32 v154, v154
v_cvt_pk_bf16_f32 v184, v152, v153
v_exp_f32 v155, v155
v_mfma_f32_32x32x16_bf16 v[72:87], v[132:135], v[196:199], v[72:87]
v_cvt_pk_bf16_f32 v185, v154, v155
v_exp_f32 v156, v156
v_exp_f32 v157, v157
v_exp_f32 v158, v158
v_cvt_pk_bf16_f32 v186, v156, v157
v_exp_f32 v159, v159
v_mfma_f32_32x32x16_bf16 v[168:183], v[140:143], a[236:239], v[168:183]
v_cvt_pk_bf16_f32 v187, v158, v159
v_exp_f32 v160, v160
v_exp_f32 v161, v161
v_exp_f32 v162, v162
v_cvt_pk_bf16_f32 v188, v160, v161
v_exp_f32 v163, v163
v_mfma_f32_32x32x16_bf16 v[24:39], v[144:147], v[184:187], v[24:39]
v_cvt_pk_bf16_f32 v189, v162, v163
v_exp_f32 v164, v164
v_exp_f32 v165, v165
v_exp_f32 v166, v166
v_exp_f32 v167, v167
v_cvt_pk_bf16_f32 v190, v164, v165
v_cvt_pk_bf16_f32 v191, v166, v167
v_mfma_f32_32x32x16_bf16 v[152:167], v[136:139], a[240:243], 0
v_exp_f32 v168, v168
v_exp_f32 v169, v169
v_exp_f32 v170, v170
v_cvt_pk_bf16_f32 v192, v168, v169
v_exp_f32 v171, v171
v_mfma_f32_32x32x16_bf16 v[24:39], v[148:151], v[188:191], v[24:39]
buffer_load_dwordx4 v1, s[4:7], s30 offen offset:0 lds
v_cvt_pk_bf16_f32 v193, v170, v171
v_exp_f32 v172, v172
v_exp_f32 v173, v173
v_exp_f32 v174, v174
v_cvt_pk_bf16_f32 v194, v172, v173
v_exp_f32 v175, v175
v_mfma_f32_32x32x16_bf16 v[152:167], v[140:143], a[244:247], v[152:167]
v_cvt_pk_bf16_f32 v195, v174, v175
v_exp_f32 v176, v176
v_exp_f32 v177, v177
v_exp_f32 v178, v178
v_cvt_pk_bf16_f32 v196, v176, v177
v_exp_f32 v179, v179
v_mfma_f32_32x32x16_bf16 v[40:55], v[144:147], v[192:195], v[40:55]
v_cvt_pk_bf16_f32 v197, v178, v179
v_exp_f32 v180, v180
v_exp_f32 v181, v181
v_exp_f32 v182, v182
v_exp_f32 v183, v183
v_cvt_pk_bf16_f32 v198, v180, v181
v_cvt_pk_bf16_f32 v199, v182, v183
v_mfma_f32_32x32x16_bf16 v[168:183], v[136:139], a[248:251], 0
v_exp_f32 v152, v152
v_exp_f32 v153, v153
v_exp_f32 v154, v154
v_cvt_pk_bf16_f32 v184, v152, v153
v_exp_f32 v155, v155
v_mfma_f32_32x32x16_bf16 v[40:55], v[148:151], v[196:199], v[40:55]
buffer_load_dwordx4 v1, s[4:7], s30 offen offset:1024 lds
s_add_u32 s30, s30, 2048
s_add_u32 m0, m0, 2048
v_cvt_pk_bf16_f32 v185, v154, v155
v_exp_f32 v156, v156
v_exp_f32 v157, v157
v_exp_f32 v158, v158
v_cvt_pk_bf16_f32 v186, v156, v157
v_exp_f32 v159, v159
v_mfma_f32_32x32x16_bf16 v[168:183], v[140:143], a[252:255], v[168:183]
v_cvt_pk_bf16_f32 v187, v158, v159
v_exp_f32 v160, v160
v_exp_f32 v161, v161
v_exp_f32 v162, v162
v_cvt_pk_bf16_f32 v188, v160, v161
v_exp_f32 v163, v163
v_mfma_f32_32x32x16_bf16 v[56:71], v[144:147], v[184:187], v[56:71]
v_cvt_pk_bf16_f32 v189, v162, v163
v_exp_f32 v164, v164
v_exp_f32 v165, v165
v_exp_f32 v166, v166
v_exp_f32 v167, v167
v_cvt_pk_bf16_f32 v190, v164, v165
v_cvt_pk_bf16_f32 v191, v166, v167
v_exp_f32 v168, v168
v_exp_f32 v169, v169
v_exp_f32 v170, v170
v_cvt_pk_bf16_f32 v192, v168, v169
v_exp_f32 v171, v171
v_mfma_f32_32x32x16_bf16 v[56:71], v[148:151], v[188:191], v[56:71]
s_cmp_lg_u32 s15, 0
s_cbranch_scc1 Lxr_64
buffer_load_dwordx2 v[10:11], v214, s[56:59], s22 offen offset:48
Lxr_64:
v_cvt_pk_bf16_f32 v193, v170, v171
v_exp_f32 v172, v172
v_exp_f32 v173, v173
v_exp_f32 v174, v174
v_cvt_pk_bf16_f32 v194, v172, v173
v_exp_f32 v175, v175
s_nop 0
v_cvt_pk_bf16_f32 v195, v174, v175
v_exp_f32 v176, v176
v_exp_f32 v177, v177
v_exp_f32 v178, v178
v_cvt_pk_bf16_f32 v196, v176, v177
v_exp_f32 v179, v179
v_mfma_f32_32x32x16_bf16 v[72:87], v[144:147], v[192:195], v[72:87]
v_cvt_pk_bf16_f32 v197, v178, v179
v_exp_f32 v180, v180
v_exp_f32 v181, v181
v_exp_f32 v182, v182
v_exp_f32 v183, v183
v_cvt_pk_bf16_f32 v198, v180, v181
v_cvt_pk_bf16_f32 v199, v182, v183
s_nop 1
v_mfma_f32_32x32x16_bf16 v[72:87], v[148:151], v[196:199], v[72:87]
s_xor_b32 s26, s14, 1
s_mul_i32 s26, s26, 12288
s_add_u32 s26, s26, 94208
v_add_u32 v14, s26, v1
ds_write_b128 v14, v[40:43] offset:0
ds_write_b128 v14, v[44:47] offset:1024
ds_write_b128 v14, v[48:51] offset:2048
ds_write_b128 v14, v[52:55] offset:3072
s_xor_b32 s26, s14, 2
s_mul_i32 s26, s26, 12288
s_add_u32 s26, s26, 98304
v_add_u32 v14, s26, v1
ds_write_b128 v14, v[56:59] offset:0
ds_write_b128 v14, v[60:63] offset:1024
ds_write_b128 v14, v[64:67] offset:2048
ds_write_b128 v14, v[68:71] offset:3072
s_xor_b32 s26, s14, 3
s_mul_i32 s26, s26, 12288
s_add_u32 s26, s26, 102400
v_add_u32 v14, s26, v1
ds_write_b128 v14, v[72:75] offset:0
ds_write_b128 v14, v[76:79] offset:1024
ds_write_b128 v14, v[80:83] offset:2048
ds_write_b128 v14, v[84:87] offset:3072
s_waitcnt lgkmcnt(0)
s_barrier
s_mul_i32 s26, s14, 12288
s_add_u32 s26, s26, 94208
v_add_u32 v14, s26, v1
ds_read_b128 v[88:91], v14 offset:0
ds_read_b128 v[92:95], v14 offset:1024
ds_read_b128 v[96:99], v14 offset:2048
ds_read_b128 v[100:103], v14 offset:3072
ds_read_b128 v[104:107], v14 offset:4096
ds_read_b128 v[108:111], v14 offset:5120
ds_read_b128 v[112:115], v14 offset:6144
ds_read_b128 v[116:119], v14 offset:7168
ds_read_b128 v[120:123], v14 offset:8192
ds_read_b128 v[124:127], v14 offset:9216
ds_read_b128 v[128:131], v14 offset:10240
ds_read_b128 v[132:135], v14 offset:11264
s_waitcnt lgkmcnt(8)
v_pk_add_f32 v[24:25], v[24:25], v[88:89]
v_pk_add_f32 v[26:27], v[26:27], v[90:91]
v_pk_add_f32 v[28:29], v[28:29], v[92:93]
v_pk_add_f32 v[30:31], v[30:31], v[94:95]
v_pk_add_f32 v[32:33], v[32:33], v[96:97]
v_pk_add_f32 v[34:35], v[34:35], v[98:99]
v_pk_add_f32 v[36:37], v[36:37], v[100:101]
v_pk_add_f32 v[38:39], v[38:39], v[102:103]
s_waitcnt lgkmcnt(4)
v_pk_add_f32 v[24:25], v[24:25], v[104:105]
v_pk_add_f32 v[26:27], v[26:27], v[106:107]
v_pk_add_f32 v[28:29], v[28:29], v[108:109]
v_pk_add_f32 v[30:31], v[30:31], v[110:111]
v_pk_add_f32 v[32:33], v[32:33], v[112:113]
v_pk_add_f32 v[34:35], v[34:35], v[114:115]
v_pk_add_f32 v[36:37], v[36:37], v[116:117]
v_pk_add_f32 v[38:39], v[38:39], v[118:119]
s_waitcnt lgkmcnt(0)
v_pk_add_f32 v[24:25], v[24:25], v[120:121]
v_pk_add_f32 v[26:27], v[26:27], v[122:123]
v_pk_add_f32 v[28:29], v[28:29], v[124:125]
v_pk_add_f32 v[30:31], v[30:31], v[126:127]
v_pk_add_f32 v[32:33], v[32:33], v[128:129]
v_pk_add_f32 v[34:35], v[34:35], v[130:131]
v_pk_add_f32 v[36:37], v[36:37], v[132:133]
v_pk_add_f32 v[38:39], v[38:39], v[134:135]
s_cmp_eq_u32 s52, 0
s_cbranch_scc1 Lslow_66
v_mov_b32 v200, v36
v_mov_b32 v201, v36
s_nop 1
v_permlane32_swap_b32 v200, v201
v_max3_f32 v202, |v24|, |v25|, |v26|
v_max3_f32 v202, v202, |v27|, |v28|
v_max3_f32 v202, v202, |v29|, |v30|
v_max3_f32 v202, v202, |v31|, |v32|
v_max3_f32 v202, v202, |v33|, |v34|
v_max3_f32 v202, v202, |v35|, |v36|
v_max3_f32 v202, v202, |v37|, |v38|
v_max_f32_e64 v202, v202, |v39|
v_mov_b32 v203, 0x1f800000
v_cmp_nge_f32 vcc, v201, v203
v_mov_b32 v203, 0x5f800000
v_cmp_nle_f32 s[20:21], v201, v203
v_mov_b32 v203, 0x7f7fffff
v_cmp_nle_f32 s[22:23], v202, v203
s_or_b64 vcc, vcc, s[20:21]
s_or_b64 vcc, vcc, s[22:23]
s_cbranch_vccnz Lfb_67
Lfbok_68:
v_rcp_f32 v202, v201
s_mul_i32 s27, s15, 2097152
s_add_u32 s27, s27, 16777216
s_lshl_b32 s28, s19, 4
s_add_u32 s28, s28, s13
s_lshl_b32 s28, s28, 11
s_add_u32 s27, s27, s28
v_pk_mul_f32 v[24:25], v[202:203], v[24:25] op_sel_hi:[0,1]
v_pk_mul_f32 v[26:27], v[202:203], v[26:27] op_sel_hi:[0,1]
v_pk_mul_f32 v[28:29], v[202:203], v[28:29] op_sel_hi:[0,1]
v_pk_mul_f32 v[30:31], v[202:203], v[30:31] op_sel_hi:[0,1]
v_pk_mul_f32 v[32:33], v[202:203], v[32:33] op_sel_hi:[0,1]
v_pk_mul_f32 v[34:35], v[202:203], v[34:35] op_sel_hi:[0,1]
v_pk_mul_f32 v[36:37], v[202:203], v[36:37] op_sel_hi:[0,1]
v_pk_mul_f32 v[38:39], v[202:203], v[38:39] op_sel_hi:[0,1]
v_cvt_pk_bf16_f32 v184, v24, v25
v_cvt_pk_bf16_f32 v185, v26, v27
v_cvt_pk_bf16_f32 v186, v28, v29
v_cvt_pk_bf16_f32 v187, v30, v31
v_cvt_pk_bf16_f32 v188, v32, v33
v_cvt_pk_bf16_f32 v189, v34, v35
v_cvt_pk_bf16_f32 v190, v36, v37
v_cvt_pk_bf16_f32 v191, v38, v39
v_mov_b32 v17, 0
v_cndmask_b32 v190, v190, v17, s[42:43]
v_cndmask_b32 v191, v191, v17, s[42:43]
buffer_store_dwordx4 v[184:187], v1, s[4:7], s27 offen
buffer_store_dwordx4 v[188:191], v1, s[4:7], s27 offen offset:1024
s_lshl_b32 s28, s15, 6
s_add_u32 s28, s28, s19
s_lshl_b32 s28, s28, 7
s_lshl_b32 s29, s13, 2
s_add_u32 s28, s28, s29
s_add_u32 s28, s28, 16384
s_waitcnt vmcnt(0)
v_mov_b32 v16, s16
v_mov_b32 v17, 0
s_mov_b64 exec, 1
buffer_store_dword v16, v17, s[4:7], s28 offen
s_mov_b64 exec, -1
s_barrier
s_cmp_ge_u32 s13, 14
s_cbranch_scc1 Lskip_65
s_lshl_b32 s28, s15, 6
s_add_u32 s28, s28, s50
s_lshl_b32 s28, s28, 7
s_and_b32 s29, s14, 1
s_lshl_b32 s29, s29, 5
s_add_u32 s28, s28, s29
s_add_u32 s28, s28, 16384
v_and_b32 v12, 7, v0
v_lshlrev_b32 v12, 2, v12
s_mov_b32 s44, 0
buffer_load_dword v16, v12, s[4:7], s28 offen sc1
buffer_load_dword v23, v12, s[4:7], s28 offen sc1
Lpoll_69:
s_waitcnt vmcnt(1)
v_cmp_ne_u32 vcc, s16, v16
s_add_u32 s44, s44, 1
s_cbranch_vccz Lok_70
buffer_load_dword v16, v12, s[4:7], s28 offen sc1
s_waitcnt vmcnt(1)
v_cmp_ne_u32 vcc, s16, v23
s_add_u32 s44, s44, 1
s_cbranch_vccz Lok_70
buffer_load_dword v23, v12, s[4:7], s28 offen sc1
s_cmp_lt_u32 s44, 0x400000
s_cbranch_scc1 Lpoll_69
s_branch interleave_layers__softmax_full_mha__dense_activation_silu__prompt_kernel_abort
Lok_70:
s_mul_i32 s24, s15, 2097152
s_add_u32 s24, s24, 16777216
s_lshl_b32 s26, s50, 15
s_add_u32 s24, s24, s26
s_and_b32 s26, s14, 1
s_lshl_b32 s26, s26, 14
s_add_u32 s24, s24, s26
buffer_load_dwordx4 v[24:27], v1, s[4:7], s24 offen offset:0
buffer_load_dwordx4 v[28:31], v1, s[4:7], s24 offen offset:1024
buffer_load_dwordx4 v[32:35], v1, s[4:7], s24 offen offset:2048
buffer_load_dwordx4 v[36:39], v1, s[4:7], s24 offen offset:3072
s_add_u32 s24, s24, 4096
buffer_load_dwordx4 v[40:43], v1, s[4:7], s24 offen offset:0
buffer_load_dwordx4 v[44:47], v1, s[4:7], s24 offen offset:1024
buffer_load_dwordx4 v[48:51], v1, s[4:7], s24 offen offset:2048
buffer_load_dwordx4 v[52:55], v1, s[4:7], s24 offen offset:3072
s_and_b32 s26, s14, 1
s_mul_i32 s27, s26, 33792
v_add_u32 v12, s27, v1
s_lshl_b32 s27, s26, 15
s_xor_b32 s26, s26, 1
s_lshl_b32 s26, s26, 10
s_add_u32 s27, s27, s26
v_add_u32 v13, s27, v1
ds_read_b128 v[120:123], v12 offset:0
ds_read_b128 v[124:127], v13 offset:0
ds_read_b128 v[128:131], v12 offset:2048
ds_read_b128 v[132:135], v13 offset:2048
s_min_u32 s20, s13, 13
s_mul_i32 s20, s20, 114688
s_mul_i32 s21, s14, 7168
s_add_u32 s20, s20, s21
s_add_u32 s20, s20, 3698688
s_add_u32 s21, s21, 94208
s_add_u32 s24, s24, 4096
buffer_load_dwordx4 v[56:59], v1, s[4:7], s24 offen offset:0
ds_read_b128 v[136:139], v12 offset:4096
ds_read_b128 v[140:143], v13 offset:4096
s_waitcnt vmcnt(8)
s_waitcnt lgkmcnt(4)
v_mfma_f32_32x32x16_bf16 v[88:103], v[120:123], v[24:27], 0
v_mfma_f32_32x32x16_bf16 v[104:119], v[124:127], v[24:27], 0
buffer_load_dwordx4 v[60:63], v1, s[4:7], s24 offen offset:1024
ds_read_b128 v[120:123], v12 offset:6144
ds_read_b128 v[124:127], v13 offset:6144
s_waitcnt vmcnt(8)
s_waitcnt lgkmcnt(4)
v_mfma_f32_32x32x16_bf16 v[88:103], v[128:131], v[28:31], v[88:103]
v_mfma_f32_32x32x16_bf16 v[104:119], v[132:135], v[28:31], v[104:119]
buffer_load_dwordx4 v[64:67], v1, s[4:7], s24 offen offset:2048
ds_read_b128 v[128:131], v12 offset:8192
ds_read_b128 v[132:135], v13 offset:8192
s_waitcnt vmcnt(8)
s_waitcnt lgkmcnt(4)
v_mfma_f32_32x32x16_bf16 v[88:103], v[136:139], v[32:35], v[88:103]
v_mfma_f32_32x32x16_bf16 v[104:119], v[140:143], v[32:35], v[104:119]
buffer_load_dwordx4 v[68:71], v1, s[4:7], s24 offen offset:3072
ds_read_b128 v[136:139], v12 offset:10240
ds_read_b128 v[140:143], v13 offset:10240
s_waitcnt vmcnt(8)
s_waitcnt lgkmcnt(4)
v_mfma_f32_32x32x16_bf16 v[88:103], v[120:123], v[36:39], v[88:103]
v_mfma_f32_32x32x16_bf16 v[104:119], v[124:127], v[36:39], v[104:119]
s_add_u32 s24, s24, 4096
buffer_load_dwordx4 v[72:75], v1, s[4:7], s24 offen offset:0
ds_read_b128 v[120:123], v12 offset:12288
ds_read_b128 v[124:127], v13 offset:12288
s_waitcnt vmcnt(8)
s_waitcnt lgkmcnt(4)
v_mfma_f32_32x32x16_bf16 v[88:103], v[128:131], v[40:43], v[88:103]
v_mfma_f32_32x32x16_bf16 v[104:119], v[132:135], v[40:43], v[104:119]
buffer_load_dwordx4 v[76:79], v1, s[4:7], s24 offen offset:1024
ds_read_b128 v[128:131], v12 offset:14336
ds_read_b128 v[132:135], v13 offset:14336
s_waitcnt vmcnt(8)
s_waitcnt lgkmcnt(4)
v_mfma_f32_32x32x16_bf16 v[88:103], v[136:139], v[44:47], v[88:103]
v_mfma_f32_32x32x16_bf16 v[104:119], v[140:143], v[44:47], v[104:119]
buffer_load_dwordx4 v[80:83], v1, s[4:7], s24 offen offset:2048
ds_read_b128 v[136:139], v12 offset:16384
ds_read_b128 v[140:143], v13 offset:16384
s_waitcnt vmcnt(8)
s_waitcnt lgkmcnt(4)
v_mfma_f32_32x32x16_bf16 v[88:103], v[120:123], v[48:51], v[88:103]
v_mfma_f32_32x32x16_bf16 v[104:119], v[124:127], v[48:51], v[104:119]
buffer_load_dwordx4 v[84:87], v1, s[4:7], s24 offen offset:3072
ds_read_b128 v[120:123], v12 offset:18432
ds_read_b128 v[124:127], v13 offset:18432
s_waitcnt vmcnt(8)
s_waitcnt lgkmcnt(4)
v_mfma_f32_32x32x16_bf16 v[88:103], v[128:131], v[52:55], v[88:103]
v_mfma_f32_32x32x16_bf16 v[104:119], v[132:135], v[52:55], v[104:119]
s_mov_b32 m0, s21
s_nop 0
buffer_load_dwordx4 v1, s[4:7], s20 offen offset:0 lds
ds_read_b128 v[128:131], v12 offset:20480
ds_read_b128 v[132:135], v13 offset:20480
s_waitcnt vmcnt(8)
s_waitcnt lgkmcnt(4)
v_mfma_f32_32x32x16_bf16 v[88:103], v[136:139], v[56:59], v[88:103]
v_mfma_f32_32x32x16_bf16 v[104:119], v[140:143], v[56:59], v[104:119]
buffer_load_dwordx4 v1, s[4:7], s20 offen offset:1024 lds
ds_read_b128 v[136:139], v12 offset:22528
ds_read_b128 v[140:143], v13 offset:22528
s_waitcnt vmcnt(8)
s_waitcnt lgkmcnt(4)
v_mfma_f32_32x32x16_bf16 v[88:103], v[120:123], v[60:63], v[88:103]
v_mfma_f32_32x32x16_bf16 v[104:119], v[124:127], v[60:63], v[104:119]
buffer_load_dwordx4 v1, s[4:7], s20 offen offset:2048 lds
ds_read_b128 v[120:123], v12 offset:24576
ds_read_b128 v[124:127], v13 offset:24576
s_waitcnt vmcnt(8)
s_waitcnt lgkmcnt(4)
v_mfma_f32_32x32x16_bf16 v[88:103], v[128:131], v[64:67], v[88:103]
v_mfma_f32_32x32x16_bf16 v[104:119], v[132:135], v[64:67], v[104:119]
buffer_load_dwordx4 v1, s[4:7], s20 offen offset:3072 lds
s_add_u32 s20, s20, 4096
s_add_u32 s21, s21, 4096
ds_read_b128 v[128:131], v12 offset:26624
ds_read_b128 v[132:135], v13 offset:26624
s_waitcnt vmcnt(8)
s_waitcnt lgkmcnt(4)
v_mfma_f32_32x32x16_bf16 v[88:103], v[136:139], v[68:71], v[88:103]
v_mfma_f32_32x32x16_bf16 v[104:119], v[140:143], v[68:71], v[104:119]
s_mov_b32 m0, s21
s_nop 0
buffer_load_dwordx4 v1, s[4:7], s20 offen offset:0 lds
ds_read_b128 v[136:139], v12 offset:28672
ds_read_b128 v[140:143], v13 offset:28672
s_waitcnt vmcnt(8)
s_waitcnt lgkmcnt(4)
v_mfma_f32_32x32x16_bf16 v[88:103], v[120:123], v[72:75], v[88:103]
v_mfma_f32_32x32x16_bf16 v[104:119], v[124:127], v[72:75], v[104:119]
buffer_load_dwordx4 v1, s[4:7], s20 offen offset:1024 lds
ds_read_b128 v[120:123], v12 offset:30720
ds_read_b128 v[124:127], v13 offset:30720
s_waitcnt vmcnt(8)
s_waitcnt lgkmcnt(4)
v_mfma_f32_32x32x16_bf16 v[88:103], v[128:131], v[76:79], v[88:103]
v_mfma_f32_32x32x16_bf16 v[104:119], v[132:135], v[76:79], v[104:119]
buffer_load_dwordx4 v1, s[4:7], s20 offen offset:2048 lds
s_waitcnt vmcnt(8)
s_waitcnt lgkmcnt(2)
v_mfma_f32_32x32x16_bf16 v[88:103], v[136:139], v[80:83], v[88:103]
v_mfma_f32_32x32x16_bf16 v[104:119], v[140:143], v[80:83], v[104:119]
s_waitcnt vmcnt(7)
s_waitcnt lgkmcnt(0)
v_mfma_f32_32x32x16_bf16 v[88:103], v[120:123], v[84:87], v[88:103]
v_mfma_f32_32x32x16_bf16 v[104:119], v[124:127], v[84:87], v[104:119]
s_xor_b32 s26, s14, 1
s_mul_i32 s26, s26, 4096
s_add_u32 s26, s26, 122880
v_add_u32 v14, s26, v1
s_nop 7
ds_write_b128 v14, v[104:107] offset:0
ds_write_b128 v14, v[108:111] offset:1024
ds_write_b128 v14, v[112:115] offset:2048
ds_write_b128 v14, v[116:119] offset:3072
s_waitcnt lgkmcnt(0)
s_barrier
s_mul_i32 s26, s14, 4096
s_add_u32 s26, s26, 122880
v_add_u32 v14, s26, v1
ds_read_b128 v[24:27], v14 offset:0
ds_read_b128 v[28:31], v14 offset:1024
ds_read_b128 v[32:35], v14 offset:2048
ds_read_b128 v[36:39], v14 offset:3072
s_waitcnt lgkmcnt(0)
v_pk_add_f32 v[88:89], v[88:89], v[24:25]
v_pk_add_f32 v[90:91], v[90:91], v[26:27]
v_pk_add_f32 v[92:93], v[92:93], v[28:29]
v_pk_add_f32 v[94:95], v[94:95], v[30:31]
v_pk_add_f32 v[96:97], v[96:97], v[32:33]
v_pk_add_f32 v[98:99], v[98:99], v[34:35]
v_pk_add_f32 v[100:101], v[100:101], v[36:37]
v_pk_add_f32 v[102:103], v[102:103], v[38:39]
s_min_u32 s20, s13, 13
s_mul_i32 s20, s20, 114688
s_mul_i32 s21, s14, 7168
s_add_u32 s20, s20, s21
s_add_u32 s20, s20, 3727360
s_add_u32 s21, s21, 0
s_mul_i32 s24, s15, 2097152
s_add_u32 s24, s24, 10485760
s_mul_i32 s25, s15, 229376
s_add_u32 s25, s25, 884736
s_mul_i32 s26, s50, 28
s_lshl_b32 s27, s51, 1
s_add_u32 s26, s26, s27
s_lshl_b32 s26, s26, 10
s_add_u32 s24, s24, s26
s_mul_i32 s26, s50, 3584
s_add_u32 s25, s25, s26
s_lshr_b32 s26, s51, 1
s_lshl_b32 s26, s26, 9
s_add_u32 s25, s25, s26
s_and_b32 s26, s51, 1
s_lshl_b32 s26, s26, 3
s_add_u32 s25, s25, s26
s_mov_b32 m0, s21
s_nop 0
buffer_load_dwordx4 v1, s[4:7], s20 offen offset:0 lds
v_lshlrev_b32 v144, 16, v4
v_and_b32 v145, 0xffff0000, v4
v_pk_add_f32 v[88:89], v[88:89], v[144:145]
v_cvt_pk_bf16_f32 v4, v88, v89
buffer_load_dwordx4 v1, s[4:7], s20 offen offset:1024 lds
v_lshlrev_b32 v144, 16, v5
v_and_b32 v145, 0xffff0000, v5
v_pk_add_f32 v[90:91], v[90:91], v[144:145]
v_cvt_pk_bf16_f32 v5, v90, v91
buffer_load_dwordx4 v1, s[4:7], s20 offen offset:2048 lds
v_lshlrev_b32 v144, 16, v6
v_and_b32 v145, 0xffff0000, v6
v_pk_add_f32 v[92:93], v[92:93], v[144:145]
v_cvt_pk_bf16_f32 v6, v92, v93
buffer_load_dwordx4 v1, s[4:7], s20 offen offset:3072 lds
s_add_u32 s20, s20, 4096
s_add_u32 s21, s21, 4096
v_lshlrev_b32 v144, 16, v7
v_and_b32 v145, 0xffff0000, v7
v_pk_add_f32 v[94:95], v[94:95], v[144:145]
v_cvt_pk_bf16_f32 v7, v94, v95
s_mov_b32 m0, s21
s_nop 0
buffer_load_dwordx4 v1, s[4:7], s20 offen offset:0 lds
v_lshlrev_b32 v144, 16, v8
v_and_b32 v145, 0xffff0000, v8
v_pk_add_f32 v[96:97], v[96:97], v[144:145]
v_cvt_pk_bf16_f32 v8, v96, v97
buffer_load_dwordx4 v1, s[4:7], s20 offen offset:1024 lds
v_lshlrev_b32 v144, 16, v9
v_and_b32 v145, 0xffff0000, v9
v_pk_add_f32 v[98:99], v[98:99], v[144:145]
v_cvt_pk_bf16_f32 v9, v98, v99
buffer_load_dwordx4 v1, s[4:7], s20 offen offset:2048 lds
v_lshlrev_b32 v144, 16, v10
v_and_b32 v145, 0xffff0000, v10
v_pk_add_f32 v[100:101], v[100:101], v[144:145]
v_cvt_pk_bf16_f32 v10, v100, v101
v_lshlrev_b32 v144, 16, v11
v_and_b32 v145, 0xffff0000, v11
v_pk_add_f32 v[102:103], v[102:103], v[144:145]
v_cvt_pk_bf16_f32 v11, v102, v103
buffer_store_dwordx4 v[4:7], v1, s[4:7], s24 offen
buffer_store_dwordx4 v[8:11], v1, s[4:7], s24 offen offset:1024
v_pk_add_f32 v[148:149], v[88:89], v[90:91]
v_pk_mul_f32 v[150:151], v[88:89], v[88:89]
v_pk_fma_f32 v[150:151], v[90:91], v[90:91], v[150:151]
v_pk_add_f32 v[148:149], v[148:149], v[92:93]
v_pk_fma_f32 v[150:151], v[92:93], v[92:93], v[150:151]
v_pk_add_f32 v[148:149], v[148:149], v[94:95]
v_pk_fma_f32 v[150:151], v[94:95], v[94:95], v[150:151]
v_pk_add_f32 v[148:149], v[148:149], v[96:97]
v_pk_fma_f32 v[150:151], v[96:97], v[96:97], v[150:151]
v_pk_add_f32 v[148:149], v[148:149], v[98:99]
v_pk_fma_f32 v[150:151], v[98:99], v[98:99], v[150:151]
v_pk_add_f32 v[148:149], v[148:149], v[100:101]
v_pk_fma_f32 v[150:151], v[100:101], v[100:101], v[150:151]
v_pk_add_f32 v[148:149], v[148:149], v[102:103]
v_pk_fma_f32 v[150:151], v[102:103], v[102:103], v[150:151]
v_add_f32 v146, v148, v149
v_add_f32 v147, v150, v151
v_mov_b32 v144, v146
v_mov_b32 v145, v147
s_nop 0
v_permlane32_swap_b32 v146, v144
v_permlane32_swap_b32 v147, v145
v_add_f32 v146, v146, v144
v_add_f32 v147, v147, v145
v_lshlrev_b32 v12, 4, v3
buffer_store_dwordx2 v[146:147], v12, s[4:7], s25 offen
s_lshl_b32 s28, s15, 6
s_add_u32 s28, s28, s50
s_lshl_b32 s28, s28, 7
s_lshl_b32 s29, s51, 2
s_add_u32 s28, s28, s29
s_add_u32 s28, s28, 32768
s_waitcnt vmcnt(0)
v_mov_b32 v16, s16
v_mov_b32 v17, 0
s_mov_b64 exec, 1
buffer_store_dword v16, v17, s[4:7], s28 offen
s_mov_b64 exec, -1
s_barrier
s_lshl_b32 s28, s15, 6
s_add_u32 s28, s28, s19
s_lshl_b32 s28, s28, 7
s_add_u32 s28, s28, 32768
v_min_u32 v12, 13, v3
v_lshlrev_b32 v12, 2, v12
s_mul_i32 s24, s15, 2097152
s_add_u32 s24, s24, 10485760
s_mul_i32 s25, s15, 229376
s_add_u32 s25, s25, 884736
s_mul_i32 s26, s19, 28672
s_add_u32 s24, s24, s26
s_mul_i32 s26, s19, 3584
s_add_u32 s25, s25, s26
s_mov_b32 s44, 0
buffer_load_dword v16, v12, s[4:7], s28 offen sc1
buffer_load_dword v23, v12, s[4:7], s28 offen sc1
Lpoll_71:
s_waitcnt vmcnt(1)
v_cmp_ne_u32 vcc, s16, v16
s_add_u32 s44, s44, 1
s_cbranch_vccz Lok_72
buffer_load_dword v16, v12, s[4:7], s28 offen sc1
s_waitcnt vmcnt(1)
v_cmp_ne_u32 vcc, s16, v23
s_add_u32 s44, s44, 1
s_cbranch_vccz Lok_72
buffer_load_dword v23, v12, s[4:7], s28 offen sc1
s_cmp_lt_u32 s44, 0x400000
s_cbranch_scc1 Lpoll_71
s_branch interleave_layers__softmax_full_mha__dense_activation_silu__prompt_kernel_abort
Lok_72:
buffer_load_dwordx4 v[24:27], v1, s[4:7], s24 offen offset:0
buffer_load_dwordx4 v[28:31], v1, s[4:7], s24 offen offset:1024
buffer_load_dwordx4 v[32:35], v1, s[4:7], s24 offen offset:2048
buffer_load_dwordx4 v[36:39], v1, s[4:7], s24 offen offset:3072
v_lshlrev_b32 v12, 11, v2
v_lshlrev_b32 v13, 4, v3
v_add_u32 v12, v12, v13
v_lshlrev_b32 v13, 30, v2
v_add_u32 v13, v12, v13
buffer_load_dwordx4 v[220:223], v12, s[4:7], s25 offen offset:0
buffer_load_dwordx4 v[224:227], v12, s[4:7], s25 offen offset:512
buffer_load_dwordx4 v[228:231], v12, s[4:7], s25 offen offset:1024
buffer_load_dwordx4 v[232:235], v13, s[4:7], s25 offen offset:1536
s_add_u32 s24, s24, 4096
buffer_load_dwordx4 v[40:43], v1, s[4:7], s24 offen offset:0
buffer_load_dwordx4 v[44:47], v1, s[4:7], s24 offen offset:1024
buffer_load_dwordx4 v[48:51], v1, s[4:7], s24 offen offset:2048
buffer_load_dwordx4 v[52:55], v1, s[4:7], s24 offen offset:3072
s_mul_i32 s27, s15, 8388608
s_add_u32 s27, s27, 33554432
s_mul_i32 s26, s19, 112
s_lshl_b32 s28, s13, 3
s_add_u32 s26, s26, s28
s_lshl_b32 s26, s26, 10
s_add_u32 s27, s27, s26
s_add_u32 s26, s27, 4096
v_add_u32 v12, 65536, v1
v_add_u32 v13, 94208, v1
v_add_u32 v15, 28672, v1
v_lshlrev_b32 v14, 4, v2
v_add_u32 v14, 160256, v14
ds_read_b128 v[168:171], v12 offset:0
ds_read_b128 v[172:175], v13 offset:0
ds_read_b128 v[176:179], v1 offset:0
ds_read_b128 v[180:183], v12 offset:1024
ds_read_b128 v[184:187], v13 offset:1024
ds_read_b128 v[188:191], v1 offset:1024
s_min_u32 s20, s13, 13
s_mul_i32 s20, s20, 114688
s_mul_i32 s21, s14, 7168
s_add_u32 s20, s20, s21
s_add_u32 s20, s20, 3756032
s_add_u32 s21, s21, 28672
s_add_u32 s24, s24, 4096
buffer_load_dwordx4 v[56:59], v1, s[4:7], s24 offen offset:0
s_mov_b32 m0, s21
s_nop 0
buffer_load_dwordx4 v1, s[4:7], s20 offen offset:0 lds
ds_read_b128 v[192:195], v12 offset:2048
ds_read_b128 v[196:199], v13 offset:2048
ds_read_b128 v[200:203], v1 offset:2048
s_waitcnt vmcnt(13)
s_waitcnt lgkmcnt(6)
v_mfma_f32_32x32x16_bf16 v[104:119], v[168:171], v[24:27], 0
v_mfma_f32_32x32x16_bf16 v[120:135], v[172:175], v[24:27], 0
v_mfma_f32_32x32x16_bf16 v[136:151], v[176:179], v[24:27], 0
buffer_load_dwordx4 v[60:63], v1, s[4:7], s24 offen offset:1024
buffer_load_dwordx4 v1, s[4:7], s20 offen offset:1024 lds
ds_read_b128 v[168:171], v12 offset:3072
ds_read_b128 v[172:175], v13 offset:3072
ds_read_b128 v[176:179], v1 offset:3072
s_waitcnt vmcnt(14)
s_waitcnt lgkmcnt(6)
v_mfma_f32_32x32x16_bf16 v[104:119], v[180:183], v[28:31], v[104:119]
v_mfma_f32_32x32x16_bf16 v[120:135], v[184:187], v[28:31], v[120:135]
v_mfma_f32_32x32x16_bf16 v[136:151], v[188:191], v[28:31], v[136:151]
buffer_load_dwordx4 v[64:67], v1, s[4:7], s24 offen offset:2048
buffer_load_dwordx4 v1, s[4:7], s20 offen offset:2048 lds
ds_read_b128 v[180:183], v12 offset:4096
ds_read_b128 v[184:187], v13 offset:4096
ds_read_b128 v[188:191], v1 offset:4096
s_waitcnt vmcnt(15)
s_waitcnt lgkmcnt(6)
v_mfma_f32_32x32x16_bf16 v[104:119], v[192:195], v[32:35], v[104:119]
v_mfma_f32_32x32x16_bf16 v[120:135], v[196:199], v[32:35], v[120:135]
v_mfma_f32_32x32x16_bf16 v[136:151], v[200:203], v[32:35], v[136:151]
buffer_load_dwordx4 v[68:71], v1, s[4:7], s24 offen offset:3072
buffer_load_dwordx4 v1, s[4:7], s20 offen offset:3072 lds
s_add_u32 s20, s20, 4096
s_add_u32 s21, s21, 4096
ds_read_b128 v[192:195], v12 offset:5120
ds_read_b128 v[196:199], v13 offset:5120
ds_read_b128 v[200:203], v1 offset:5120
s_waitcnt vmcnt(16)
s_waitcnt lgkmcnt(6)
v_mfma_f32_32x32x16_bf16 v[104:119], v[168:171], v[36:39], v[104:119]
v_mfma_f32_32x32x16_bf16 v[120:135], v[172:175], v[36:39], v[120:135]
v_mfma_f32_32x32x16_bf16 v[136:151], v[176:179], v[36:39], v[136:151]
s_add_u32 s24, s24, 4096
buffer_load_dwordx4 v[72:75], v1, s[4:7], s24 offen offset:0
s_mov_b32 m0, s21
s_nop 0
buffer_load_dwordx4 v1, s[4:7], s20 offen offset:0 lds
ds_read_b128 v[168:171], v12 offset:6144
ds_read_b128 v[172:175], v13 offset:6144
ds_read_b128 v[176:179], v1 offset:6144
s_waitcnt vmcnt(13)
s_waitcnt lgkmcnt(6)
v_mfma_f32_32x32x16_bf16 v[104:119], v[180:183], v[40:43], v[104:119]
v_add_f32 v220, v220, v222
v_mfma_f32_32x32x16_bf16 v[120:135], v[184:187], v[40:43], v[120:135]
v_add_f32 v221, v221, v223
v_mfma_f32_32x32x16_bf16 v[136:151], v[188:191], v[40:43], v[136:151]
v_add_f32 v220, v220, v224
buffer_load_dwordx4 v[76:79], v1, s[4:7], s24 offen offset:1024
buffer_load_dwordx4 v1, s[4:7], s20 offen offset:1024 lds
ds_read_b128 v[180:183], v12 offset:7168
ds_read_b128 v[184:187], v13 offset:7168
ds_read_b128 v[188:191], v1 offset:7168
s_waitcnt vmcnt(14)
s_waitcnt lgkmcnt(6)
v_mfma_f32_32x32x16_bf16 v[104:119], v[192:195], v[44:47], v[104:119]
v_add_f32 v221, v221, v225
v_mfma_f32_32x32x16_bf16 v[120:135], v[196:199], v[44:47], v[120:135]
v_add_f32 v220, v220, v226
v_mfma_f32_32x32x16_bf16 v[136:151], v[200:203], v[44:47], v[136:151]
v_add_f32 v221, v221, v227
buffer_load_dwordx4 v[80:83], v1, s[4:7], s24 offen offset:2048
buffer_load_dwordx4 v1, s[4:7], s20 offen offset:2048 lds
ds_read_b128 v[192:195], v12 offset:8192
ds_read_b128 v[196:199], v13 offset:8192
ds_read_b128 v[200:203], v1 offset:8192
s_waitcnt vmcnt(15)
s_waitcnt lgkmcnt(6)
v_mfma_f32_32x32x16_bf16 v[104:119], v[168:171], v[48:51], v[104:119]
v_add_f32 v220, v220, v228
v_mfma_f32_32x32x16_bf16 v[120:135], v[172:175], v[48:51], v[120:135]
v_add_f32 v221, v221, v229
v_mfma_f32_32x32x16_bf16 v[136:151], v[176:179], v[48:51], v[136:151]
v_add_f32 v220, v220, v230
buffer_load_dwordx4 v[84:87], v1, s[4:7], s24 offen offset:3072
ds_read_b128 v[168:171], v12 offset:9216
ds_read_b128 v[172:175], v13 offset:9216
ds_read_b128 v[176:179], v1 offset:9216
s_waitcnt vmcnt(15)
s_waitcnt lgkmcnt(6)
v_mfma_f32_32x32x16_bf16 v[104:119], v[180:183], v[52:55], v[104:119]
v_add_f32 v221, v221, v231
v_mfma_f32_32x32x16_bf16 v[120:135], v[184:187], v[52:55], v[120:135]
v_add_f32 v220, v220, v232
v_mfma_f32_32x32x16_bf16 v[136:151], v[188:191], v[52:55], v[136:151]
v_add_f32 v221, v221, v233
s_add_u32 s24, s24, 4096
buffer_load_dwordx4 v[88:91], v1, s[4:7], s24 offen offset:0
ds_read_b128 v[180:183], v12 offset:10240
ds_read_b128 v[184:187], v13 offset:10240
ds_read_b128 v[188:191], v1 offset:10240
s_waitcnt vmcnt(15)
s_waitcnt lgkmcnt(6)
v_mfma_f32_32x32x16_bf16 v[104:119], v[192:195], v[56:59], v[104:119]
v_add_f32 v220, v220, v234
v_mfma_f32_32x32x16_bf16 v[120:135], v[196:199], v[56:59], v[120:135]
v_add_f32 v221, v221, v235
v_mfma_f32_32x32x16_bf16 v[136:151], v[200:203], v[56:59], v[136:151]
v_mov_b32 v222, v220
buffer_load_dwordx4 v[92:95], v1, s[4:7], s24 offen offset:1024
ds_read_b128 v[192:195], v12 offset:11264
ds_read_b128 v[196:199], v13 offset:11264
ds_read_b128 v[200:203], v1 offset:11264
s_waitcnt vmcnt(14)
s_waitcnt lgkmcnt(6)
v_mfma_f32_32x32x16_bf16 v[104:119], v[168:171], v[60:63], v[104:119]
v_mov_b32 v223, v221
v_mfma_f32_32x32x16_bf16 v[120:135], v[172:175], v[60:63], v[120:135]
v_permlane32_swap_b32 v220, v222
v_mfma_f32_32x32x16_bf16 v[136:151], v[176:179], v[60:63], v[136:151]
v_permlane32_swap_b32 v221, v223
buffer_load_dwordx4 v[96:99], v1, s[4:7], s24 offen offset:2048
ds_read_b128 v[168:171], v12 offset:12288
ds_read_b128 v[172:175], v13 offset:12288
ds_read_b128 v[176:179], v1 offset:12288
s_waitcnt vmcnt(13)
s_waitcnt lgkmcnt(6)
v_mfma_f32_32x32x16_bf16 v[104:119], v[180:183], v[64:67], v[104:119]
v_add_f32 v220, v220, v222
v_mfma_f32_32x32x16_bf16 v[120:135], v[184:187], v[64:67], v[120:135]
v_add_f32 v221, v221, v223
v_mfma_f32_32x32x16_bf16 v[136:151], v[188:191], v[64:67], v[136:151]
v_mul_f32 v18, 0xbb124925, v220
buffer_load_dwordx4 v[100:103], v1, s[4:7], s24 offen offset:3072
ds_read_b128 v[180:183], v12 offset:13312
ds_read_b128 v[184:187], v13 offset:13312
ds_read_b128 v[188:191], v1 offset:13312
s_waitcnt vmcnt(12)
s_waitcnt lgkmcnt(6)
v_mfma_f32_32x32x16_bf16 v[104:119], v[192:195], v[68:71], v[104:119]
v_mul_f32 v221, 0x3b124925, v221
v_mfma_f32_32x32x16_bf16 v[120:135], v[196:199], v[68:71], v[120:135]
v_fma_f32 v221, -v18, v18, v221
v_mfma_f32_32x32x16_bf16 v[136:151], v[200:203], v[68:71], v[136:151]
v_max_f32 v221, 0, v221
s_add_u32 s24, s24, 4096
buffer_load_dwordx4 a[224:227], v1, s[4:7], s24 offen offset:0
ds_read_b128 v[192:195], v12 offset:14336
ds_read_b128 v[196:199], v13 offset:14336
ds_read_b128 v[200:203], v1 offset:14336
s_waitcnt vmcnt(11)
s_waitcnt lgkmcnt(6)
v_mfma_f32_32x32x16_bf16 v[104:119], v[168:171], v[72:75], v[104:119]
v_add_f32 v221, 0x3727c5ac, v221
v_mfma_f32_32x32x16_bf16 v[120:135], v[172:175], v[72:75], v[120:135]
v_rsq_f32 v19, v221
v_mfma_f32_32x32x16_bf16 v[136:151], v[176:179], v[72:75], v[136:151]
v_mul_f32 v20, v221, v19
buffer_load_dwordx4 a[228:231], v1, s[4:7], s24 offen offset:1024
ds_read_b128 v[168:171], v12 offset:15360
ds_read_b128 v[172:175], v13 offset:15360
ds_read_b128 v[176:179], v1 offset:15360
s_waitcnt vmcnt(10)
s_waitcnt lgkmcnt(6)
v_mfma_f32_32x32x16_bf16 v[104:119], v[180:183], v[76:79], v[104:119]
v_mul_f32 v22, 0xbfb8aa3b, v19
v_mfma_f32_32x32x16_bf16 v[120:135], v[184:187], v[76:79], v[120:135]
v_mfma_f32_32x32x16_bf16 v[136:151], v[188:191], v[76:79], v[136:151]
buffer_load_dwordx4 a[232:235], v1, s[4:7], s24 offen offset:2048
ds_read_b128 v[180:183], v12 offset:16384
ds_read_b128 v[184:187], v13 offset:16384
ds_read_b128 v[188:191], v1 offset:16384
s_waitcnt vmcnt(9)
s_waitcnt lgkmcnt(6)
v_mfma_f32_32x32x16_bf16 v[104:119], v[192:195], v[80:83], v[104:119]
v_mfma_f32_32x32x16_bf16 v[120:135], v[196:199], v[80:83], v[120:135]
v_mfma_f32_32x32x16_bf16 v[136:151], v[200:203], v[80:83], v[136:151]
buffer_load_dwordx4 a[236:239], v1, s[4:7], s24 offen offset:3072
ds_read_b128 v[192:195], v12 offset:17408
ds_read_b128 v[196:199], v13 offset:17408
ds_read_b128 v[200:203], v1 offset:17408
s_waitcnt vmcnt(8)
s_waitcnt lgkmcnt(6)
v_mfma_f32_32x32x16_bf16 v[104:119], v[168:171], v[84:87], v[104:119]
v_mfma_f32_32x32x16_bf16 v[120:135], v[172:175], v[84:87], v[120:135]
v_mfma_f32_32x32x16_bf16 v[136:151], v[176:179], v[84:87], v[136:151]
s_add_u32 s24, s24, 4096
buffer_load_dwordx4 a[240:243], v1, s[4:7], s24 offen offset:0
ds_read_b128 v[168:171], v12 offset:18432
ds_read_b128 v[172:175], v13 offset:18432
ds_read_b128 v[176:179], v1 offset:18432
s_waitcnt vmcnt(8)
s_waitcnt lgkmcnt(6)
v_mfma_f32_32x32x16_bf16 v[104:119], v[180:183], v[88:91], v[104:119]
v_mfma_f32_32x32x16_bf16 v[120:135], v[184:187], v[88:91], v[120:135]
v_mfma_f32_32x32x16_bf16 v[136:151], v[188:191], v[88:91], v[136:151]
buffer_load_dwordx4 a[244:247], v1, s[4:7], s24 offen offset:1024
ds_read_b128 v[180:183], v12 offset:19456
ds_read_b128 v[184:187], v13 offset:19456
ds_read_b128 v[188:191], v1 offset:19456
s_waitcnt vmcnt(8)
s_waitcnt lgkmcnt(6)
v_mfma_f32_32x32x16_bf16 v[104:119], v[192:195], v[92:95], v[104:119]
v_mfma_f32_32x32x16_bf16 v[120:135], v[196:199], v[92:95], v[120:135]
v_mfma_f32_32x32x16_bf16 v[136:151], v[200:203], v[92:95], v[136:151]
buffer_load_dwordx4 a[248:251], v1, s[4:7], s24 offen offset:2048
ds_read_b128 v[192:195], v12 offset:20480
ds_read_b128 v[196:199], v13 offset:20480
ds_read_b128 v[200:203], v1 offset:20480
s_waitcnt vmcnt(8)
s_waitcnt lgkmcnt(6)
v_mfma_f32_32x32x16_bf16 v[104:119], v[168:171], v[96:99], v[104:119]
v_mfma_f32_32x32x16_bf16 v[120:135], v[172:175], v[96:99], v[120:135]
v_mfma_f32_32x32x16_bf16 v[136:151], v[176:179], v[96:99], v[136:151]
buffer_load_dwordx4 a[252:255], v1, s[4:7], s24 offen offset:3072
ds_read_b128 v[168:171], v12 offset:21504
ds_read_b128 v[172:175], v13 offset:21504
ds_read_b128 v[176:179], v1 offset:21504
s_waitcnt vmcnt(8)
s_waitcnt lgkmcnt(6)
v_mfma_f32_32x32x16_bf16 v[104:119], v[180:183], v[100:103], v[104:119]
v_mfma_f32_32x32x16_bf16 v[120:135], v[184:187], v[100:103], v[120:135]
v_mfma_f32_32x32x16_bf16 v[136:151], v[188:191], v[100:103], v[136:151]
s_cmp_eq_u32 s15, 0
s_cselect_b32 s29, -1, 0
v_lshlrev_b32 v244, 7, v0
v_and_b32 v244, s29, v244
buffer_load_dword v16, v244, s[4:7], s27 offen sc1
ds_read_b128 v[180:183], v12 offset:22528
ds_read_b128 v[184:187], v13 offset:22528
ds_read_b128 v[188:191], v1 offset:22528
s_waitcnt vmcnt(8)
s_waitcnt lgkmcnt(6)
v_mfma_f32_32x32x16_bf16 v[104:119], v[192:195], a[224:227], v[104:119]
v_mfma_f32_32x32x16_bf16 v[120:135], v[196:199], a[224:227], v[120:135]
v_mfma_f32_32x32x16_bf16 v[136:151], v[200:203], a[224:227], v[136:151]
ds_read_b128 v[192:195], v12 offset:23552
ds_read_b128 v[196:199], v13 offset:23552
ds_read_b128 v[200:203], v1 offset:23552
s_waitcnt vmcnt(7)
s_waitcnt lgkmcnt(6)
v_mfma_f32_32x32x16_bf16 v[104:119], v[168:171], a[228:231], v[104:119]
v_mfma_f32_32x32x16_bf16 v[120:135], v[172:175], a[228:231], v[120:135]
v_mfma_f32_32x32x16_bf16 v[136:151], v[176:179], a[228:231], v[136:151]
ds_read_b128 v[168:171], v12 offset:24576
ds_read_b128 v[172:175], v13 offset:24576
ds_read_b128 v[176:179], v1 offset:24576
s_waitcnt vmcnt(6)
s_waitcnt lgkmcnt(6)
v_mfma_f32_32x32x16_bf16 v[104:119], v[180:183], a[232:235], v[104:119]
v_mfma_f32_32x32x16_bf16 v[120:135], v[184:187], a[232:235], v[120:135]
v_mfma_f32_32x32x16_bf16 v[136:151], v[188:191], a[232:235], v[136:151]
ds_read_b128 v[180:183], v12 offset:25600
ds_read_b128 v[184:187], v13 offset:25600
ds_read_b128 v[188:191], v1 offset:25600
s_waitcnt vmcnt(5)
s_waitcnt lgkmcnt(6)
v_mfma_f32_32x32x16_bf16 v[104:119], v[192:195], a[236:239], v[104:119]
v_mfma_f32_32x32x16_bf16 v[120:135], v[196:199], a[236:239], v[120:135]
v_mfma_f32_32x32x16_bf16 v[136:151], v[200:203], a[236:239], v[136:151]
ds_read_b128 v[192:195], v12 offset:26624
ds_read_b128 v[196:199], v13 offset:26624
ds_read_b128 v[200:203], v1 offset:26624
s_waitcnt vmcnt(4)
s_waitcnt lgkmcnt(6)
v_mfma_f32_32x32x16_bf16 v[104:119], v[168:171], a[240:243], v[104:119]
v_mfma_f32_32x32x16_bf16 v[120:135], v[172:175], a[240:243], v[120:135]
v_mfma_f32_32x32x16_bf16 v[136:151], v[176:179], a[240:243], v[136:151]
ds_read_b128 v[168:171], v12 offset:27648
ds_read_b128 v[172:175], v13 offset:27648
ds_read_b128 v[176:179], v1 offset:27648
s_waitcnt vmcnt(3)
s_waitcnt lgkmcnt(6)
v_mfma_f32_32x32x16_bf16 v[104:119], v[180:183], a[244:247], v[104:119]
v_mfma_f32_32x32x16_bf16 v[120:135], v[184:187], a[244:247], v[120:135]
v_mfma_f32_32x32x16_bf16 v[136:151], v[188:191], a[244:247], v[136:151]
s_waitcnt vmcnt(2)
s_waitcnt lgkmcnt(3)
v_mfma_f32_32x32x16_bf16 v[104:119], v[192:195], a[248:251], v[104:119]
v_mfma_f32_32x32x16_bf16 v[120:135], v[196:199], a[248:251], v[120:135]
v_mfma_f32_32x32x16_bf16 v[136:151], v[200:203], a[248:251], v[136:151]
s_waitcnt vmcnt(1)
s_waitcnt lgkmcnt(0)
v_mfma_f32_32x32x16_bf16 v[104:119], v[168:171], a[252:255], v[104:119]
v_mfma_f32_32x32x16_bf16 v[120:135], v[172:175], a[252:255], v[120:135]
v_mfma_f32_32x32x16_bf16 v[136:151], v[176:179], a[252:255], v[136:151]
ds_read_b128 v[204:207], v14 offset:0
ds_read_b128 v[208:211], v14 offset:32
ds_read_b128 v[212:215], v14 offset:64
ds_read_b128 v[216:219], v14 offset:96
ds_read_b128 v[220:223], v14 offset:128
ds_read_b128 v[224:227], v14 offset:160
ds_read_b128 v[228:231], v14 offset:192
ds_read_b128 v[232:235], v14 offset:224
s_barrier
s_cmp_eq_u32 s15, 0
s_cbranch_scc1 Lb0_73
ds_read_b128 v[168:171], v15 offset:0
ds_read_b128 v[172:175], v15 offset:1024
ds_read_b128 v[176:179], v15 offset:2048
ds_read_b128 v[180:183], v15 offset:3072
s_waitcnt lgkmcnt(3)
v_mfma_f32_32x32x16_bf16 v[152:167], v[168:171], v[24:27], 0
v_pk_fma_f32 v[104:105], v[18:19], v[204:205], v[104:105] op_sel_hi:[0,1,1]
v_pk_fma_f32 v[106:107], v[18:19], v[206:207], v[106:107] op_sel_hi:[0,1,1]
v_pk_mul_f32 v[244:245], v[22:23], v[104:105] op_sel_hi:[0,1]
v_pk_mul_f32 v[246:247], v[22:23], v[106:107] op_sel_hi:[0,1]
v_exp_f32 v244, v244
v_exp_f32 v245, v245
ds_read_b128 v[168:171], v15 offset:4096
s_waitcnt lgkmcnt(3)
v_mfma_f32_32x32x16_bf16 v[152:167], v[172:175], v[28:31], v[152:167]
v_exp_f32 v246, v246
v_exp_f32 v247, v247
v_pk_fma_f32 v[244:245], v[244:245], v[20:21], v[20:21] op_sel_hi:[1,0,0]
v_pk_fma_f32 v[246:247], v[246:247], v[20:21], v[20:21] op_sel_hi:[1,0,0]
v_rcp_f32 v244, v244
v_rcp_f32 v245, v245
ds_read_b128 v[172:175], v15 offset:5120
s_waitcnt lgkmcnt(3)
v_mfma_f32_32x32x16_bf16 v[152:167], v[176:179], v[32:35], v[152:167]
v_rcp_f32 v246, v246
v_rcp_f32 v247, v247
v_pk_mul_f32 v[104:105], v[104:105], v[244:245]
v_pk_mul_f32 v[106:107], v[106:107], v[246:247]
v_cvt_pk_bf16_f32 v236, v104, v105
v_cvt_pk_bf16_f32 v237, v106, v107
ds_read_b128 v[176:179], v15 offset:6144
s_waitcnt lgkmcnt(3)
v_mfma_f32_32x32x16_bf16 v[152:167], v[180:183], v[36:39], v[152:167]
v_pk_fma_f32 v[108:109], v[18:19], v[208:209], v[108:109] op_sel_hi:[0,1,1]
v_pk_fma_f32 v[110:111], v[18:19], v[210:211], v[110:111] op_sel_hi:[0,1,1]
v_pk_mul_f32 v[248:249], v[22:23], v[108:109] op_sel_hi:[0,1]
v_pk_mul_f32 v[250:251], v[22:23], v[110:111] op_sel_hi:[0,1]
v_exp_f32 v248, v248
v_exp_f32 v249, v249
ds_read_b128 v[180:183], v15 offset:7168
s_waitcnt lgkmcnt(3)
v_mfma_f32_32x32x16_bf16 v[152:167], v[168:171], v[40:43], v[152:167]
v_exp_f32 v250, v250
v_exp_f32 v251, v251
v_pk_fma_f32 v[248:249], v[248:249], v[20:21], v[20:21] op_sel_hi:[1,0,0]
v_pk_fma_f32 v[250:251], v[250:251], v[20:21], v[20:21] op_sel_hi:[1,0,0]
v_rcp_f32 v248, v248
v_rcp_f32 v249, v249
ds_read_b128 v[168:171], v15 offset:8192
s_waitcnt lgkmcnt(3)
v_mfma_f32_32x32x16_bf16 v[152:167], v[172:175], v[44:47], v[152:167]
v_rcp_f32 v250, v250
v_rcp_f32 v251, v251
v_pk_mul_f32 v[108:109], v[108:109], v[248:249]
v_pk_mul_f32 v[110:111], v[110:111], v[250:251]
v_cvt_pk_bf16_f32 v238, v108, v109
v_cvt_pk_bf16_f32 v239, v110, v111
ds_read_b128 v[172:175], v15 offset:9216
s_waitcnt lgkmcnt(3)
v_mfma_f32_32x32x16_bf16 v[152:167], v[176:179], v[48:51], v[152:167]
v_pk_fma_f32 v[112:113], v[18:19], v[212:213], v[112:113] op_sel_hi:[0,1,1]
v_pk_fma_f32 v[114:115], v[18:19], v[214:215], v[114:115] op_sel_hi:[0,1,1]
v_pk_mul_f32 v[244:245], v[22:23], v[112:113] op_sel_hi:[0,1]
v_pk_mul_f32 v[246:247], v[22:23], v[114:115] op_sel_hi:[0,1]
v_exp_f32 v244, v244
v_exp_f32 v245, v245
ds_read_b128 v[176:179], v15 offset:10240
s_waitcnt lgkmcnt(3)
v_mfma_f32_32x32x16_bf16 v[152:167], v[180:183], v[52:55], v[152:167]
v_exp_f32 v246, v246
v_exp_f32 v247, v247
v_pk_fma_f32 v[244:245], v[244:245], v[20:21], v[20:21] op_sel_hi:[1,0,0]
v_pk_fma_f32 v[246:247], v[246:247], v[20:21], v[20:21] op_sel_hi:[1,0,0]
v_rcp_f32 v244, v244
v_rcp_f32 v245, v245
ds_read_b128 v[180:183], v15 offset:11264
s_waitcnt lgkmcnt(3)
v_mfma_f32_32x32x16_bf16 v[152:167], v[168:171], v[56:59], v[152:167]
v_rcp_f32 v246, v246
v_rcp_f32 v247, v247
v_pk_mul_f32 v[112:113], v[112:113], v[244:245]
v_pk_mul_f32 v[114:115], v[114:115], v[246:247]
v_cvt_pk_bf16_f32 v240, v112, v113
v_cvt_pk_bf16_f32 v241, v114, v115
ds_read_b128 v[168:171], v15 offset:12288
s_waitcnt lgkmcnt(3)
v_mfma_f32_32x32x16_bf16 v[152:167], v[172:175], v[60:63], v[152:167]
v_pk_fma_f32 v[116:117], v[18:19], v[216:217], v[116:117] op_sel_hi:[0,1,1]
v_pk_fma_f32 v[118:119], v[18:19], v[218:219], v[118:119] op_sel_hi:[0,1,1]
v_pk_mul_f32 v[248:249], v[22:23], v[116:117] op_sel_hi:[0,1]
v_pk_mul_f32 v[250:251], v[22:23], v[118:119] op_sel_hi:[0,1]
v_exp_f32 v248, v248
v_exp_f32 v249, v249
ds_read_b128 v[172:175], v15 offset:13312
s_waitcnt lgkmcnt(3)
v_mfma_f32_32x32x16_bf16 v[152:167], v[176:179], v[64:67], v[152:167]
v_exp_f32 v250, v250
v_exp_f32 v251, v251
v_pk_fma_f32 v[248:249], v[248:249], v[20:21], v[20:21] op_sel_hi:[1,0,0]
v_pk_fma_f32 v[250:251], v[250:251], v[20:21], v[20:21] op_sel_hi:[1,0,0]
v_rcp_f32 v248, v248
v_rcp_f32 v249, v249
ds_read_b128 v[176:179], v15 offset:14336
s_waitcnt lgkmcnt(3)
v_mfma_f32_32x32x16_bf16 v[152:167], v[180:183], v[68:71], v[152:167]
v_rcp_f32 v250, v250
v_rcp_f32 v251, v251
v_pk_mul_f32 v[116:117], v[116:117], v[248:249]
v_pk_mul_f32 v[118:119], v[118:119], v[250:251]
v_cvt_pk_bf16_f32 v242, v116, v117
v_cvt_pk_bf16_f32 v243, v118, v119
ds_read_b128 v[180:183], v15 offset:15360
s_waitcnt lgkmcnt(3)
v_mfma_f32_32x32x16_bf16 v[152:167], v[168:171], v[72:75], v[152:167]
buffer_store_dwordx4 v[236:239], v1, s[4:7], s27 offen offset:0 sc1
buffer_store_dwordx4 v[240:243], v1, s[4:7], s27 offen offset:1024 sc1
ds_read_b128 v[204:207], v14 offset:256
ds_read_b128 v[208:211], v14 offset:288
ds_read_b128 v[212:215], v14 offset:320
ds_read_b128 v[216:219], v14 offset:352
v_pk_fma_f32 v[120:121], v[18:19], v[220:221], v[120:121] op_sel_hi:[0,1,1]
v_pk_fma_f32 v[122:123], v[18:19], v[222:223], v[122:123] op_sel_hi:[0,1,1]
v_pk_mul_f32 v[244:245], v[22:23], v[120:121] op_sel_hi:[0,1]
v_pk_mul_f32 v[246:247], v[22:23], v[122:123] op_sel_hi:[0,1]
v_exp_f32 v244, v244
v_exp_f32 v245, v245
ds_read_b128 v[168:171], v15 offset:16384
s_waitcnt lgkmcnt(7)
v_mfma_f32_32x32x16_bf16 v[152:167], v[172:175], v[76:79], v[152:167]
v_exp_f32 v246, v246
v_exp_f32 v247, v247
v_pk_fma_f32 v[244:245], v[244:245], v[20:21], v[20:21] op_sel_hi:[1,0,0]
v_pk_fma_f32 v[246:247], v[246:247], v[20:21], v[20:21] op_sel_hi:[1,0,0]
v_rcp_f32 v244, v244
v_rcp_f32 v245, v245
ds_read_b128 v[172:175], v15 offset:17408
s_waitcnt lgkmcnt(7)
v_mfma_f32_32x32x16_bf16 v[152:167], v[176:179], v[80:83], v[152:167]
v_rcp_f32 v246, v246
v_rcp_f32 v247, v247
v_pk_mul_f32 v[120:121], v[120:121], v[244:245]
v_pk_mul_f32 v[122:123], v[122:123], v[246:247]
v_cvt_pk_bf16_f32 v236, v120, v121
v_cvt_pk_bf16_f32 v237, v122, v123
ds_read_b128 v[176:179], v15 offset:18432
s_waitcnt lgkmcnt(7)
v_mfma_f32_32x32x16_bf16 v[152:167], v[180:183], v[84:87], v[152:167]
v_pk_fma_f32 v[124:125], v[18:19], v[224:225], v[124:125] op_sel_hi:[0,1,1]
v_pk_fma_f32 v[126:127], v[18:19], v[226:227], v[126:127] op_sel_hi:[0,1,1]
v_pk_mul_f32 v[248:249], v[22:23], v[124:125] op_sel_hi:[0,1]
v_pk_mul_f32 v[250:251], v[22:23], v[126:127] op_sel_hi:[0,1]
v_exp_f32 v248, v248
v_exp_f32 v249, v249
ds_read_b128 v[180:183], v15 offset:19456
s_waitcnt lgkmcnt(3)
v_mfma_f32_32x32x16_bf16 v[152:167], v[168:171], v[88:91], v[152:167]
v_exp_f32 v250, v250
v_exp_f32 v251, v251
v_pk_fma_f32 v[248:249], v[248:249], v[20:21], v[20:21] op_sel_hi:[1,0,0]
v_pk_fma_f32 v[250:251], v[250:251], v[20:21], v[20:21] op_sel_hi:[1,0,0]
v_rcp_f32 v248, v248
v_rcp_f32 v249, v249
ds_read_b128 v[168:171], v15 offset:20480
s_waitcnt lgkmcnt(3)
v_mfma_f32_32x32x16_bf16 v[152:167], v[172:175], v[92:95], v[152:167]
v_rcp_f32 v250, v250
v_rcp_f32 v251, v251
v_pk_mul_f32 v[124:125], v[124:125], v[248:249]
v_pk_mul_f32 v[126:127], v[126:127], v[250:251]
v_cvt_pk_bf16_f32 v238, v124, v125
v_cvt_pk_bf16_f32 v239, v126, v127
ds_read_b128 v[172:175], v15 offset:21504
s_waitcnt lgkmcnt(3)
v_mfma_f32_32x32x16_bf16 v[152:167], v[176:179], v[96:99], v[152:167]
v_pk_fma_f32 v[128:129], v[18:19], v[228:229], v[128:129] op_sel_hi:[0,1,1]
v_pk_fma_f32 v[130:131], v[18:19], v[230:231], v[130:131] op_sel_hi:[0,1,1]
v_pk_mul_f32 v[244:245], v[22:23], v[128:129] op_sel_hi:[0,1]
v_pk_mul_f32 v[246:247], v[22:23], v[130:131] op_sel_hi:[0,1]
v_exp_f32 v244, v244
v_exp_f32 v245, v245
ds_read_b128 v[176:179], v15 offset:22528
s_waitcnt lgkmcnt(3)
v_mfma_f32_32x32x16_bf16 v[152:167], v[180:183], v[100:103], v[152:167]
v_exp_f32 v246, v246
v_exp_f32 v247, v247
v_pk_fma_f32 v[244:245], v[244:245], v[20:21], v[20:21] op_sel_hi:[1,0,0]
v_pk_fma_f32 v[246:247], v[246:247], v[20:21], v[20:21] op_sel_hi:[1,0,0]
v_rcp_f32 v244, v244
v_rcp_f32 v245, v245
ds_read_b128 v[180:183], v15 offset:23552
s_waitcnt lgkmcnt(3)
v_mfma_f32_32x32x16_bf16 v[152:167], v[168:171], a[224:227], v[152:167]
v_rcp_f32 v246, v246
v_rcp_f32 v247, v247
v_pk_mul_f32 v[128:129], v[128:129], v[244:245]
v_pk_mul_f32 v[130:131], v[130:131], v[246:247]
v_cvt_pk_bf16_f32 v240, v128, v129
v_cvt_pk_bf16_f32 v241, v130, v131
ds_read_b128 v[168:171], v15 offset:24576
s_waitcnt lgkmcnt(3)
v_mfma_f32_32x32x16_bf16 v[152:167], v[172:175], a[228:231], v[152:167]
v_pk_fma_f32 v[132:133], v[18:19], v[232:233], v[132:133] op_sel_hi:[0,1,1]
v_pk_fma_f32 v[134:135], v[18:19], v[234:235], v[134:135] op_sel_hi:[0,1,1]
v_pk_mul_f32 v[248:249], v[22:23], v[132:133] op_sel_hi:[0,1]
v_pk_mul_f32 v[250:251], v[22:23], v[134:135] op_sel_hi:[0,1]
v_exp_f32 v248, v248
v_exp_f32 v249, v249
ds_read_b128 v[172:175], v15 offset:25600
s_waitcnt lgkmcnt(3)
v_mfma_f32_32x32x16_bf16 v[152:167], v[176:179], a[232:235], v[152:167]
v_exp_f32 v250, v250
v_exp_f32 v251, v251
v_pk_fma_f32 v[248:249], v[248:249], v[20:21], v[20:21] op_sel_hi:[1,0,0]
v_pk_fma_f32 v[250:251], v[250:251], v[20:21], v[20:21] op_sel_hi:[1,0,0]
v_rcp_f32 v248, v248
v_rcp_f32 v249, v249
ds_read_b128 v[176:179], v15 offset:26624
s_waitcnt lgkmcnt(3)
v_mfma_f32_32x32x16_bf16 v[152:167], v[180:183], a[236:239], v[152:167]
v_rcp_f32 v250, v250
v_rcp_f32 v251, v251
v_pk_mul_f32 v[132:133], v[132:133], v[248:249]
v_pk_mul_f32 v[134:135], v[134:135], v[250:251]
v_cvt_pk_bf16_f32 v242, v132, v133
v_cvt_pk_bf16_f32 v243, v134, v135
ds_read_b128 v[180:183], v15 offset:27648
s_waitcnt lgkmcnt(3)
v_mfma_f32_32x32x16_bf16 v[152:167], v[168:171], a[240:243], v[152:167]
buffer_store_dwordx4 v[236:239], v1, s[4:7], s27 offen offset:2048 sc1
buffer_store_dwordx4 v[240:243], v1, s[4:7], s27 offen offset:3072 sc1
ds_read_b128 v[220:223], v14 offset:384
ds_read_b128 v[224:227], v14 offset:416
ds_read_b128 v[228:231], v14 offset:448
ds_read_b128 v[232:235], v14 offset:480
v_pk_fma_f32 v[136:137], v[18:19], v[204:205], v[136:137] op_sel_hi:[0,1,1]
v_pk_fma_f32 v[138:139], v[18:19], v[206:207], v[138:139] op_sel_hi:[0,1,1]
v_pk_mul_f32 v[244:245], v[22:23], v[136:137] op_sel_hi:[0,1]
v_pk_mul_f32 v[246:247], v[22:23], v[138:139] op_sel_hi:[0,1]
v_exp_f32 v244, v244
v_exp_f32 v245, v245
s_waitcnt lgkmcnt(6)
v_mfma_f32_32x32x16_bf16 v[152:167], v[172:175], a[244:247], v[152:167]
v_exp_f32 v246, v246
v_exp_f32 v247, v247
v_pk_fma_f32 v[244:245], v[244:245], v[20:21], v[20:21] op_sel_hi:[1,0,0]
v_pk_fma_f32 v[246:247], v[246:247], v[20:21], v[20:21] op_sel_hi:[1,0,0]
v_rcp_f32 v244, v244
v_rcp_f32 v245, v245
s_waitcnt lgkmcnt(5)
v_mfma_f32_32x32x16_bf16 v[152:167], v[176:179], a[248:251], v[152:167]
v_rcp_f32 v246, v246
v_rcp_f32 v247, v247
v_pk_mul_f32 v[136:137], v[136:137], v[244:245]
v_pk_mul_f32 v[138:139], v[138:139], v[246:247]
v_cvt_pk_bf16_f32 v236, v136, v137
v_cvt_pk_bf16_f32 v237, v138, v139
s_waitcnt lgkmcnt(4)
v_mfma_f32_32x32x16_bf16 v[152:167], v[180:183], a[252:255], v[152:167]
v_pk_fma_f32 v[140:141], v[18:19], v[208:209], v[140:141] op_sel_hi:[0,1,1]
v_pk_fma_f32 v[142:143], v[18:19], v[210:211], v[142:143] op_sel_hi:[0,1,1]
v_pk_mul_f32 v[248:249], v[22:23], v[140:141] op_sel_hi:[0,1]
v_pk_mul_f32 v[250:251], v[22:23], v[142:143] op_sel_hi:[0,1]
v_exp_f32 v248, v248
v_exp_f32 v249, v249
v_exp_f32 v250, v250
v_exp_f32 v251, v251
v_pk_fma_f32 v[248:249], v[248:249], v[20:21], v[20:21] op_sel_hi:[1,0,0]
v_pk_fma_f32 v[250:251], v[250:251], v[20:21], v[20:21] op_sel_hi:[1,0,0]
v_rcp_f32 v248, v248
v_rcp_f32 v249, v249
v_rcp_f32 v250, v250
v_rcp_f32 v251, v251
v_pk_mul_f32 v[140:141], v[140:141], v[248:249]
v_pk_mul_f32 v[142:143], v[142:143], v[250:251]
v_cvt_pk_bf16_f32 v238, v140, v141
v_cvt_pk_bf16_f32 v239, v142, v143
v_pk_fma_f32 v[144:145], v[18:19], v[212:213], v[144:145] op_sel_hi:[0,1,1]
v_pk_fma_f32 v[146:147], v[18:19], v[214:215], v[146:147] op_sel_hi:[0,1,1]
v_pk_mul_f32 v[244:245], v[22:23], v[144:145] op_sel_hi:[0,1]
v_pk_mul_f32 v[246:247], v[22:23], v[146:147] op_sel_hi:[0,1]
v_exp_f32 v244, v244
v_exp_f32 v245, v245
v_exp_f32 v246, v246
v_exp_f32 v247, v247
v_pk_fma_f32 v[244:245], v[244:245], v[20:21], v[20:21] op_sel_hi:[1,0,0]
v_pk_fma_f32 v[246:247], v[246:247], v[20:21], v[20:21] op_sel_hi:[1,0,0]
v_rcp_f32 v244, v244
v_rcp_f32 v245, v245
v_rcp_f32 v246, v246
v_rcp_f32 v247, v247
v_pk_mul_f32 v[144:145], v[144:145], v[244:245]
v_pk_mul_f32 v[146:147], v[146:147], v[246:247]
v_cvt_pk_bf16_f32 v240, v144, v145
v_cvt_pk_bf16_f32 v241, v146, v147
v_pk_fma_f32 v[148:149], v[18:19], v[216:217], v[148:149] op_sel_hi:[0,1,1]
v_pk_fma_f32 v[150:151], v[18:19], v[218:219], v[150:151] op_sel_hi:[0,1,1]
v_pk_mul_f32 v[248:249], v[22:23], v[148:149] op_sel_hi:[0,1]
v_pk_mul_f32 v[250:251], v[22:23], v[150:151] op_sel_hi:[0,1]
v_exp_f32 v248, v248
v_exp_f32 v249, v249
v_exp_f32 v250, v250
v_exp_f32 v251, v251
v_pk_fma_f32 v[248:249], v[248:249], v[20:21], v[20:21] op_sel_hi:[1,0,0]
v_pk_fma_f32 v[250:251], v[250:251], v[20:21], v[20:21] op_sel_hi:[1,0,0]
v_rcp_f32 v248, v248
v_rcp_f32 v249, v249
v_rcp_f32 v250, v250
v_rcp_f32 v251, v251
v_pk_mul_f32 v[148:149], v[148:149], v[248:249]
v_pk_mul_f32 v[150:151], v[150:151], v[250:251]
v_cvt_pk_bf16_f32 v242, v148, v149
v_cvt_pk_bf16_f32 v243, v150, v151
buffer_store_dwordx4 v[236:239], v1, s[4:7], s26 offen offset:0 sc1
buffer_store_dwordx4 v[240:243], v1, s[4:7], s26 offen offset:1024 sc1
s_waitcnt lgkmcnt(0)
v_pk_fma_f32 v[152:153], v[18:19], v[220:221], v[152:153] op_sel_hi:[0,1,1]
v_pk_fma_f32 v[154:155], v[18:19], v[222:223], v[154:155] op_sel_hi:[0,1,1]
v_pk_mul_f32 v[244:245], v[22:23], v[152:153] op_sel_hi:[0,1]
v_pk_mul_f32 v[246:247], v[22:23], v[154:155] op_sel_hi:[0,1]
v_exp_f32 v244, v244
v_exp_f32 v245, v245
v_exp_f32 v246, v246
v_exp_f32 v247, v247
v_pk_fma_f32 v[244:245], v[244:245], v[20:21], v[20:21] op_sel_hi:[1,0,0]
v_pk_fma_f32 v[246:247], v[246:247], v[20:21], v[20:21] op_sel_hi:[1,0,0]
v_rcp_f32 v244, v244
v_rcp_f32 v245, v245
v_rcp_f32 v246, v246
v_rcp_f32 v247, v247
v_pk_mul_f32 v[152:153], v[152:153], v[244:245]
v_pk_mul_f32 v[154:155], v[154:155], v[246:247]
v_cvt_pk_bf16_f32 v236, v152, v153
v_cvt_pk_bf16_f32 v237, v154, v155
v_pk_fma_f32 v[156:157], v[18:19], v[224:225], v[156:157] op_sel_hi:[0,1,1]
v_pk_fma_f32 v[158:159], v[18:19], v[226:227], v[158:159] op_sel_hi:[0,1,1]
v_pk_mul_f32 v[248:249], v[22:23], v[156:157] op_sel_hi:[0,1]
v_pk_mul_f32 v[250:251], v[22:23], v[158:159] op_sel_hi:[0,1]
v_exp_f32 v248, v248
v_exp_f32 v249, v249
v_exp_f32 v250, v250
v_exp_f32 v251, v251
v_pk_fma_f32 v[248:249], v[248:249], v[20:21], v[20:21] op_sel_hi:[1,0,0]
v_pk_fma_f32 v[250:251], v[250:251], v[20:21], v[20:21] op_sel_hi:[1,0,0]
v_rcp_f32 v248, v248
v_rcp_f32 v249, v249
v_rcp_f32 v250, v250
v_rcp_f32 v251, v251
v_pk_mul_f32 v[156:157], v[156:157], v[248:249]
v_pk_mul_f32 v[158:159], v[158:159], v[250:251]
v_cvt_pk_bf16_f32 v238, v156, v157
v_cvt_pk_bf16_f32 v239, v158, v159
v_pk_fma_f32 v[160:161], v[18:19], v[228:229], v[160:161] op_sel_hi:[0,1,1]
v_pk_fma_f32 v[162:163], v[18:19], v[230:231], v[162:163] op_sel_hi:[0,1,1]
v_pk_mul_f32 v[244:245], v[22:23], v[160:161] op_sel_hi:[0,1]
v_pk_mul_f32 v[246:247], v[22:23], v[162:163] op_sel_hi:[0,1]
v_exp_f32 v244, v244
v_exp_f32 v245, v245
v_exp_f32 v246, v246
v_exp_f32 v247, v247
v_pk_fma_f32 v[244:245], v[244:245], v[20:21], v[20:21] op_sel_hi:[1,0,0]
v_pk_fma_f32 v[246:247], v[246:247], v[20:21], v[20:21] op_sel_hi:[1,0,0]
v_rcp_f32 v244, v244
v_rcp_f32 v245, v245
v_rcp_f32 v246, v246
v_rcp_f32 v247, v247
v_pk_mul_f32 v[160:161], v[160:161], v[244:245]
v_pk_mul_f32 v[162:163], v[162:163], v[246:247]
v_cvt_pk_bf16_f32 v240, v160, v161
v_cvt_pk_bf16_f32 v241, v162, v163
v_pk_fma_f32 v[164:165], v[18:19], v[232:233], v[164:165] op_sel_hi:[0,1,1]
v_pk_fma_f32 v[166:167], v[18:19], v[234:235], v[166:167] op_sel_hi:[0,1,1]
v_pk_mul_f32 v[248:249], v[22:23], v[164:165] op_sel_hi:[0,1]
v_pk_mul_f32 v[250:251], v[22:23], v[166:167] op_sel_hi:[0,1]
v_exp_f32 v248, v248
v_exp_f32 v249, v249
v_exp_f32 v250, v250
v_exp_f32 v251, v251
v_pk_fma_f32 v[248:249], v[248:249], v[20:21], v[20:21] op_sel_hi:[1,0,0]
v_pk_fma_f32 v[250:251], v[250:251], v[20:21], v[20:21] op_sel_hi:[1,0,0]
v_rcp_f32 v248, v248
v_rcp_f32 v249, v249
v_rcp_f32 v250, v250
v_rcp_f32 v251, v251
v_pk_mul_f32 v[164:165], v[164:165], v[248:249]
v_pk_mul_f32 v[166:167], v[166:167], v[250:251]
v_cvt_pk_bf16_f32 v242, v164, v165
v_cvt_pk_bf16_f32 v243, v166, v167
buffer_store_dwordx4 v[236:239], v1, s[4:7], s26 offen offset:2048 sc1
buffer_store_dwordx4 v[240:243], v1, s[4:7], s26 offen offset:3072 sc1
s_branch Lb1_74
Lb0_73:
s_lshl_b32 s20, s18, 2
s_add_u32 s20, s20, s14
s_mul_i32 s20, s20, 57344
s_add_u32 s20, s20, 6291456
s_and_b32 s21, s14, 1
s_lshl_b32 s21, s21, 10
v_add_u32 v12, s21, v1
s_xor_b32 s21, s21, 1024
v_add_u32 v13, s21, v1
ds_read_b128 v[168:171], v15 offset:0
ds_read_b128 v[172:175], v15 offset:1024
ds_read_b128 v[176:179], v15 offset:2048
ds_read_b128 v[180:183], v15 offset:3072
buffer_load_dwordx4 a[0:3], v12, s[4:7], s20 offen offset:0
buffer_load_dwordx4 a[4:7], v13, s[4:7], s20 offen offset:0
s_waitcnt lgkmcnt(3)
v_mfma_f32_32x32x16_bf16 v[152:167], v[168:171], v[24:27], 0
v_pk_fma_f32 v[104:105], v[18:19], v[204:205], v[104:105] op_sel_hi:[0,1,1]
v_pk_fma_f32 v[106:107], v[18:19], v[206:207], v[106:107] op_sel_hi:[0,1,1]
v_pk_mul_f32 v[244:245], v[22:23], v[104:105] op_sel_hi:[0,1]
v_pk_mul_f32 v[246:247], v[22:23], v[106:107] op_sel_hi:[0,1]
v_exp_f32 v244, v244
v_exp_f32 v245, v245
ds_read_b128 v[168:171], v15 offset:4096
buffer_load_dwordx4 a[8:11], v12, s[4:7], s20 offen offset:2048
buffer_load_dwordx4 a[12:15], v13, s[4:7], s20 offen offset:2048
s_waitcnt lgkmcnt(3)
v_mfma_f32_32x32x16_bf16 v[152:167], v[172:175], v[28:31], v[152:167]
v_exp_f32 v246, v246
v_exp_f32 v247, v247
v_pk_fma_f32 v[244:245], v[244:245], v[20:21], v[20:21] op_sel_hi:[1,0,0]
v_pk_fma_f32 v[246:247], v[246:247], v[20:21], v[20:21] op_sel_hi:[1,0,0]
v_rcp_f32 v244, v244
v_rcp_f32 v245, v245
ds_read_b128 v[172:175], v15 offset:5120
s_add_u32 s20, s20, 4096
buffer_load_dwordx4 a[16:19], v12, s[4:7], s20 offen offset:0
buffer_load_dwordx4 a[20:23], v13, s[4:7], s20 offen offset:0
s_waitcnt lgkmcnt(3)
v_mfma_f32_32x32x16_bf16 v[152:167], v[176:179], v[32:35], v[152:167]
v_rcp_f32 v246, v246
v_rcp_f32 v247, v247
v_pk_mul_f32 v[104:105], v[104:105], v[244:245]
v_pk_mul_f32 v[106:107], v[106:107], v[246:247]
v_cvt_pk_bf16_f32 v236, v104, v105
v_cvt_pk_bf16_f32 v237, v106, v107
ds_read_b128 v[176:179], v15 offset:6144
buffer_load_dwordx4 a[24:27], v12, s[4:7], s20 offen offset:2048
buffer_load_dwordx4 a[28:31], v13, s[4:7], s20 offen offset:2048
s_waitcnt lgkmcnt(3)
v_mfma_f32_32x32x16_bf16 v[152:167], v[180:183], v[36:39], v[152:167]
v_pk_fma_f32 v[108:109], v[18:19], v[208:209], v[108:109] op_sel_hi:[0,1,1]
v_pk_fma_f32 v[110:111], v[18:19], v[210:211], v[110:111] op_sel_hi:[0,1,1]
v_pk_mul_f32 v[248:249], v[22:23], v[108:109] op_sel_hi:[0,1]
v_pk_mul_f32 v[250:251], v[22:23], v[110:111] op_sel_hi:[0,1]
v_exp_f32 v248, v248
v_exp_f32 v249, v249
ds_read_b128 v[180:183], v15 offset:7168
s_add_u32 s20, s20, 4096
buffer_load_dwordx4 a[32:35], v12, s[4:7], s20 offen offset:0
buffer_load_dwordx4 a[36:39], v13, s[4:7], s20 offen offset:0
s_waitcnt lgkmcnt(3)
v_mfma_f32_32x32x16_bf16 v[152:167], v[168:171], v[40:43], v[152:167]
v_exp_f32 v250, v250
v_exp_f32 v251, v251
v_pk_fma_f32 v[248:249], v[248:249], v[20:21], v[20:21] op_sel_hi:[1,0,0]
v_pk_fma_f32 v[250:251], v[250:251], v[20:21], v[20:21] op_sel_hi:[1,0,0]
v_rcp_f32 v248, v248
v_rcp_f32 v249, v249
ds_read_b128 v[168:171], v15 offset:8192
buffer_load_dwordx4 a[40:43], v12, s[4:7], s20 offen offset:2048
buffer_load_dwordx4 a[44:47], v13, s[4:7], s20 offen offset:2048
s_waitcnt lgkmcnt(3)
v_mfma_f32_32x32x16_bf16 v[152:167], v[172:175], v[44:47], v[152:167]
v_rcp_f32 v250, v250
v_rcp_f32 v251, v251
v_pk_mul_f32 v[108:109], v[108:109], v[248:249]
v_pk_mul_f32 v[110:111], v[110:111], v[250:251]
v_cvt_pk_bf16_f32 v238, v108, v109
v_cvt_pk_bf16_f32 v239, v110, v111
ds_read_b128 v[172:175], v15 offset:9216
s_add_u32 s20, s20, 4096
buffer_load_dwordx4 a[48:51], v12, s[4:7], s20 offen offset:0
buffer_load_dwordx4 a[52:55], v13, s[4:7], s20 offen offset:0
s_waitcnt lgkmcnt(3)
v_mfma_f32_32x32x16_bf16 v[152:167], v[176:179], v[48:51], v[152:167]
v_pk_fma_f32 v[112:113], v[18:19], v[212:213], v[112:113] op_sel_hi:[0,1,1]
v_pk_fma_f32 v[114:115], v[18:19], v[214:215], v[114:115] op_sel_hi:[0,1,1]
v_pk_mul_f32 v[244:245], v[22:23], v[112:113] op_sel_hi:[0,1]
v_pk_mul_f32 v[246:247], v[22:23], v[114:115] op_sel_hi:[0,1]
v_exp_f32 v244, v244
v_exp_f32 v245, v245
ds_read_b128 v[176:179], v15 offset:10240
buffer_load_dwordx4 a[56:59], v12, s[4:7], s20 offen offset:2048
buffer_load_dwordx4 a[60:63], v13, s[4:7], s20 offen offset:2048
s_waitcnt lgkmcnt(3)
v_mfma_f32_32x32x16_bf16 v[152:167], v[180:183], v[52:55], v[152:167]
v_exp_f32 v246, v246
v_exp_f32 v247, v247
v_pk_fma_f32 v[244:245], v[244:245], v[20:21], v[20:21] op_sel_hi:[1,0,0]
v_pk_fma_f32 v[246:247], v[246:247], v[20:21], v[20:21] op_sel_hi:[1,0,0]
v_rcp_f32 v244, v244
v_rcp_f32 v245, v245
ds_read_b128 v[180:183], v15 offset:11264
s_add_u32 s20, s20, 4096
buffer_load_dwordx4 a[64:67], v12, s[4:7], s20 offen offset:0
buffer_load_dwordx4 a[68:71], v13, s[4:7], s20 offen offset:0
s_waitcnt lgkmcnt(3)
v_mfma_f32_32x32x16_bf16 v[152:167], v[168:171], v[56:59], v[152:167]
v_rcp_f32 v246, v246
v_rcp_f32 v247, v247
v_pk_mul_f32 v[112:113], v[112:113], v[244:245]
v_pk_mul_f32 v[114:115], v[114:115], v[246:247]
v_cvt_pk_bf16_f32 v240, v112, v113
v_cvt_pk_bf16_f32 v241, v114, v115
ds_read_b128 v[168:171], v15 offset:12288
buffer_load_dwordx4 a[72:75], v12, s[4:7], s20 offen offset:2048
buffer_load_dwordx4 a[76:79], v13, s[4:7], s20 offen offset:2048
s_waitcnt lgkmcnt(3)
v_mfma_f32_32x32x16_bf16 v[152:167], v[172:175], v[60:63], v[152:167]
v_pk_fma_f32 v[116:117], v[18:19], v[216:217], v[116:117] op_sel_hi:[0,1,1]
v_pk_fma_f32 v[118:119], v[18:19], v[218:219], v[118:119] op_sel_hi:[0,1,1]
v_pk_mul_f32 v[248:249], v[22:23], v[116:117] op_sel_hi:[0,1]
v_pk_mul_f32 v[250:251], v[22:23], v[118:119] op_sel_hi:[0,1]
v_exp_f32 v248, v248
v_exp_f32 v249, v249
ds_read_b128 v[172:175], v15 offset:13312
s_add_u32 s20, s20, 4096
buffer_load_dwordx4 a[80:83], v12, s[4:7], s20 offen offset:0
buffer_load_dwordx4 a[84:87], v13, s[4:7], s20 offen offset:0
s_waitcnt lgkmcnt(3)
v_mfma_f32_32x32x16_bf16 v[152:167], v[176:179], v[64:67], v[152:167]
v_exp_f32 v250, v250
v_exp_f32 v251, v251
v_pk_fma_f32 v[248:249], v[248:249], v[20:21], v[20:21] op_sel_hi:[1,0,0]
v_pk_fma_f32 v[250:251], v[250:251], v[20:21], v[20:21] op_sel_hi:[1,0,0]
v_rcp_f32 v248, v248
v_rcp_f32 v249, v249
ds_read_b128 v[176:179], v15 offset:14336
buffer_load_dwordx4 a[88:91], v12, s[4:7], s20 offen offset:2048
buffer_load_dwordx4 a[92:95], v13, s[4:7], s20 offen offset:2048
s_waitcnt lgkmcnt(3)
v_mfma_f32_32x32x16_bf16 v[152:167], v[180:183], v[68:71], v[152:167]
v_rcp_f32 v250, v250
v_rcp_f32 v251, v251
v_pk_mul_f32 v[116:117], v[116:117], v[248:249]
v_pk_mul_f32 v[118:119], v[118:119], v[250:251]
v_cvt_pk_bf16_f32 v242, v116, v117
v_cvt_pk_bf16_f32 v243, v118, v119
ds_read_b128 v[180:183], v15 offset:15360
s_add_u32 s20, s20, 4096
buffer_load_dwordx4 a[96:99], v12, s[4:7], s20 offen offset:0
buffer_load_dwordx4 a[100:103], v13, s[4:7], s20 offen offset:0
s_waitcnt lgkmcnt(3)
v_mfma_f32_32x32x16_bf16 v[152:167], v[168:171], v[72:75], v[152:167]
buffer_store_dwordx4 v[236:239], v1, s[4:7], s27 offen offset:0
buffer_store_dwordx4 v[240:243], v1, s[4:7], s27 offen offset:1024
ds_read_b128 v[204:207], v14 offset:256
ds_read_b128 v[208:211], v14 offset:288
ds_read_b128 v[212:215], v14 offset:320
ds_read_b128 v[216:219], v14 offset:352
v_pk_fma_f32 v[120:121], v[18:19], v[220:221], v[120:121] op_sel_hi:[0,1,1]
v_pk_fma_f32 v[122:123], v[18:19], v[222:223], v[122:123] op_sel_hi:[0,1,1]
v_pk_mul_f32 v[244:245], v[22:23], v[120:121] op_sel_hi:[0,1]
v_pk_mul_f32 v[246:247], v[22:23], v[122:123] op_sel_hi:[0,1]
v_exp_f32 v244, v244
v_exp_f32 v245, v245
ds_read_b128 v[168:171], v15 offset:16384
buffer_load_dwordx4 a[104:107], v12, s[4:7], s20 offen offset:2048
buffer_load_dwordx4 a[108:111], v13, s[4:7], s20 offen offset:2048
s_waitcnt lgkmcnt(7)
v_mfma_f32_32x32x16_bf16 v[152:167], v[172:175], v[76:79], v[152:167]
v_exp_f32 v246, v246
v_exp_f32 v247, v247
v_pk_fma_f32 v[244:245], v[244:245], v[20:21], v[20:21] op_sel_hi:[1,0,0]
v_pk_fma_f32 v[246:247], v[246:247], v[20:21], v[20:21] op_sel_hi:[1,0,0]
v_rcp_f32 v244, v244
v_rcp_f32 v245, v245
ds_read_b128 v[172:175], v15 offset:17408
s_add_u32 s20, s20, 4096
buffer_load_dwordx4 a[112:115], v12, s[4:7], s20 offen offset:0
buffer_load_dwordx4 a[116:119], v13, s[4:7], s20 offen offset:0
s_waitcnt lgkmcnt(7)
v_mfma_f32_32x32x16_bf16 v[152:167], v[176:179], v[80:83], v[152:167]
v_rcp_f32 v246, v246
v_rcp_f32 v247, v247
v_pk_mul_f32 v[120:121], v[120:121], v[244:245]
v_pk_mul_f32 v[122:123], v[122:123], v[246:247]
v_cvt_pk_bf16_f32 v236, v120, v121
v_cvt_pk_bf16_f32 v237, v122, v123
ds_read_b128 v[176:179], v15 offset:18432
buffer_load_dwordx4 a[120:123], v12, s[4:7], s20 offen offset:2048
buffer_load_dwordx4 a[124:127], v13, s[4:7], s20 offen offset:2048
s_waitcnt lgkmcnt(7)
v_mfma_f32_32x32x16_bf16 v[152:167], v[180:183], v[84:87], v[152:167]
v_pk_fma_f32 v[124:125], v[18:19], v[224:225], v[124:125] op_sel_hi:[0,1,1]
v_pk_fma_f32 v[126:127], v[18:19], v[226:227], v[126:127] op_sel_hi:[0,1,1]
v_pk_mul_f32 v[248:249], v[22:23], v[124:125] op_sel_hi:[0,1]
v_pk_mul_f32 v[250:251], v[22:23], v[126:127] op_sel_hi:[0,1]
v_exp_f32 v248, v248
v_exp_f32 v249, v249
ds_read_b128 v[180:183], v15 offset:19456
s_add_u32 s20, s20, 4096
buffer_load_dwordx4 a[128:131], v12, s[4:7], s20 offen offset:0
buffer_load_dwordx4 a[132:135], v13, s[4:7], s20 offen offset:0
s_waitcnt lgkmcnt(3)
v_mfma_f32_32x32x16_bf16 v[152:167], v[168:171], v[88:91], v[152:167]
v_exp_f32 v250, v250
v_exp_f32 v251, v251
v_pk_fma_f32 v[248:249], v[248:249], v[20:21], v[20:21] op_sel_hi:[1,0,0]
v_pk_fma_f32 v[250:251], v[250:251], v[20:21], v[20:21] op_sel_hi:[1,0,0]
v_rcp_f32 v248, v248
v_rcp_f32 v249, v249
ds_read_b128 v[168:171], v15 offset:20480
buffer_load_dwordx4 a[136:139], v12, s[4:7], s20 offen offset:2048
buffer_load_dwordx4 a[140:143], v13, s[4:7], s20 offen offset:2048
s_waitcnt lgkmcnt(3)
v_mfma_f32_32x32x16_bf16 v[152:167], v[172:175], v[92:95], v[152:167]
v_rcp_f32 v250, v250
v_rcp_f32 v251, v251
v_pk_mul_f32 v[124:125], v[124:125], v[248:249]
v_pk_mul_f32 v[126:127], v[126:127], v[250:251]
v_cvt_pk_bf16_f32 v238, v124, v125
v_cvt_pk_bf16_f32 v239, v126, v127
ds_read_b128 v[172:175], v15 offset:21504
s_add_u32 s20, s20, 4096
buffer_load_dwordx4 a[144:147], v12, s[4:7], s20 offen offset:0
buffer_load_dwordx4 a[148:151], v13, s[4:7], s20 offen offset:0
s_waitcnt lgkmcnt(3)
v_mfma_f32_32x32x16_bf16 v[152:167], v[176:179], v[96:99], v[152:167]
v_pk_fma_f32 v[128:129], v[18:19], v[228:229], v[128:129] op_sel_hi:[0,1,1]
v_pk_fma_f32 v[130:131], v[18:19], v[230:231], v[130:131] op_sel_hi:[0,1,1]
v_pk_mul_f32 v[244:245], v[22:23], v[128:129] op_sel_hi:[0,1]
v_pk_mul_f32 v[246:247], v[22:23], v[130:131] op_sel_hi:[0,1]
v_exp_f32 v244, v244
v_exp_f32 v245, v245
ds_read_b128 v[176:179], v15 offset:22528
buffer_load_dwordx4 a[152:155], v12, s[4:7], s20 offen offset:2048
buffer_load_dwordx4 a[156:159], v13, s[4:7], s20 offen offset:2048
s_waitcnt lgkmcnt(3)
v_mfma_f32_32x32x16_bf16 v[152:167], v[180:183], v[100:103], v[152:167]
v_exp_f32 v246, v246
v_exp_f32 v247, v247
v_pk_fma_f32 v[244:245], v[244:245], v[20:21], v[20:21] op_sel_hi:[1,0,0]
v_pk_fma_f32 v[246:247], v[246:247], v[20:21], v[20:21] op_sel_hi:[1,0,0]
v_rcp_f32 v244, v244
v_rcp_f32 v245, v245
ds_read_b128 v[180:183], v15 offset:23552
s_add_u32 s20, s20, 4096
buffer_load_dwordx4 a[160:163], v12, s[4:7], s20 offen offset:0
buffer_load_dwordx4 a[164:167], v13, s[4:7], s20 offen offset:0
s_waitcnt lgkmcnt(3)
v_mfma_f32_32x32x16_bf16 v[152:167], v[168:171], a[224:227], v[152:167]
v_rcp_f32 v246, v246
v_rcp_f32 v247, v247
v_pk_mul_f32 v[128:129], v[128:129], v[244:245]
v_pk_mul_f32 v[130:131], v[130:131], v[246:247]
v_cvt_pk_bf16_f32 v240, v128, v129
v_cvt_pk_bf16_f32 v241, v130, v131
ds_read_b128 v[168:171], v15 offset:24576
buffer_load_dwordx4 a[168:171], v12, s[4:7], s20 offen offset:2048
buffer_load_dwordx4 a[172:175], v13, s[4:7], s20 offen offset:2048
s_waitcnt lgkmcnt(3)
v_mfma_f32_32x32x16_bf16 v[152:167], v[172:175], a[228:231], v[152:167]
v_pk_fma_f32 v[132:133], v[18:19], v[232:233], v[132:133] op_sel_hi:[0,1,1]
v_pk_fma_f32 v[134:135], v[18:19], v[234:235], v[134:135] op_sel_hi:[0,1,1]
v_pk_mul_f32 v[248:249], v[22:23], v[132:133] op_sel_hi:[0,1]
v_pk_mul_f32 v[250:251], v[22:23], v[134:135] op_sel_hi:[0,1]
v_exp_f32 v248, v248
v_exp_f32 v249, v249
ds_read_b128 v[172:175], v15 offset:25600
s_add_u32 s20, s20, 4096
buffer_load_dwordx4 a[176:179], v12, s[4:7], s20 offen offset:0
buffer_load_dwordx4 a[180:183], v13, s[4:7], s20 offen offset:0
s_waitcnt lgkmcnt(3)
v_mfma_f32_32x32x16_bf16 v[152:167], v[176:179], a[232:235], v[152:167]
v_exp_f32 v250, v250
v_exp_f32 v251, v251
v_pk_fma_f32 v[248:249], v[248:249], v[20:21], v[20:21] op_sel_hi:[1,0,0]
v_pk_fma_f32 v[250:251], v[250:251], v[20:21], v[20:21] op_sel_hi:[1,0,0]
v_rcp_f32 v248, v248
v_rcp_f32 v249, v249
ds_read_b128 v[176:179], v15 offset:26624
buffer_load_dwordx4 a[184:187], v12, s[4:7], s20 offen offset:2048
buffer_load_dwordx4 a[188:191], v13, s[4:7], s20 offen offset:2048
s_waitcnt lgkmcnt(3)
v_mfma_f32_32x32x16_bf16 v[152:167], v[180:183], a[236:239], v[152:167]
v_rcp_f32 v250, v250
v_rcp_f32 v251, v251
v_pk_mul_f32 v[132:133], v[132:133], v[248:249]
v_pk_mul_f32 v[134:135], v[134:135], v[250:251]
v_cvt_pk_bf16_f32 v242, v132, v133
v_cvt_pk_bf16_f32 v243, v134, v135
ds_read_b128 v[180:183], v15 offset:27648
s_add_u32 s20, s20, 4096
buffer_load_dwordx4 a[192:195], v12, s[4:7], s20 offen offset:0
buffer_load_dwordx4 a[196:199], v13, s[4:7], s20 offen offset:0
s_waitcnt lgkmcnt(3)
v_mfma_f32_32x32x16_bf16 v[152:167], v[168:171], a[240:243], v[152:167]
buffer_store_dwordx4 v[236:239], v1, s[4:7], s27 offen offset:2048
buffer_store_dwordx4 v[240:243], v1, s[4:7], s27 offen offset:3072
ds_read_b128 v[220:223], v14 offset:384
ds_read_b128 v[224:227], v14 offset:416
ds_read_b128 v[228:231], v14 offset:448
ds_read_b128 v[232:235], v14 offset:480
v_pk_fma_f32 v[136:137], v[18:19], v[204:205], v[136:137] op_sel_hi:[0,1,1]
v_pk_fma_f32 v[138:139], v[18:19], v[206:207], v[138:139] op_sel_hi:[0,1,1]
v_pk_mul_f32 v[244:245], v[22:23], v[136:137] op_sel_hi:[0,1]
v_pk_mul_f32 v[246:247], v[22:23], v[138:139] op_sel_hi:[0,1]
v_exp_f32 v244, v244
v_exp_f32 v245, v245
buffer_load_dwordx4 a[200:203], v12, s[4:7], s20 offen offset:2048
buffer_load_dwordx4 a[204:207], v13, s[4:7], s20 offen offset:2048
s_waitcnt lgkmcnt(6)
v_mfma_f32_32x32x16_bf16 v[152:167], v[172:175], a[244:247], v[152:167]
v_exp_f32 v246, v246
v_exp_f32 v247, v247
v_pk_fma_f32 v[244:245], v[244:245], v[20:21], v[20:21] op_sel_hi:[1,0,0]
v_pk_fma_f32 v[246:247], v[246:247], v[20:21], v[20:21] op_sel_hi:[1,0,0]
v_rcp_f32 v244, v244
v_rcp_f32 v245, v245
s_add_u32 s20, s20, 4096
buffer_load_dwordx4 a[208:211], v12, s[4:7], s20 offen offset:0
buffer_load_dwordx4 a[212:215], v13, s[4:7], s20 offen offset:0
s_waitcnt lgkmcnt(5)
v_mfma_f32_32x32x16_bf16 v[152:167], v[176:179], a[248:251], v[152:167]
v_rcp_f32 v246, v246
v_rcp_f32 v247, v247
v_pk_mul_f32 v[136:137], v[136:137], v[244:245]
v_pk_mul_f32 v[138:139], v[138:139], v[246:247]
v_cvt_pk_bf16_f32 v236, v136, v137
v_cvt_pk_bf16_f32 v237, v138, v139
buffer_load_dwordx4 a[216:219], v12, s[4:7], s20 offen offset:2048
buffer_load_dwordx4 a[220:223], v13, s[4:7], s20 offen offset:2048
s_waitcnt lgkmcnt(4)
v_mfma_f32_32x32x16_bf16 v[152:167], v[180:183], a[252:255], v[152:167]
v_pk_fma_f32 v[140:141], v[18:19], v[208:209], v[140:141] op_sel_hi:[0,1,1]
v_pk_fma_f32 v[142:143], v[18:19], v[210:211], v[142:143] op_sel_hi:[0,1,1]
v_pk_mul_f32 v[248:249], v[22:23], v[140:141] op_sel_hi:[0,1]
v_pk_mul_f32 v[250:251], v[22:23], v[142:143] op_sel_hi:[0,1]
v_exp_f32 v248, v248
v_exp_f32 v249, v249
v_exp_f32 v250, v250
v_exp_f32 v251, v251
v_pk_fma_f32 v[248:249], v[248:249], v[20:21], v[20:21] op_sel_hi:[1,0,0]
v_pk_fma_f32 v[250:251], v[250:251], v[20:21], v[20:21] op_sel_hi:[1,0,0]
v_rcp_f32 v248, v248
v_rcp_f32 v249, v249
v_rcp_f32 v250, v250
v_rcp_f32 v251, v251
v_pk_mul_f32 v[140:141], v[140:141], v[248:249]
v_pk_mul_f32 v[142:143], v[142:143], v[250:251]
v_cvt_pk_bf16_f32 v238, v140, v141
v_cvt_pk_bf16_f32 v239, v142, v143
v_pk_fma_f32 v[144:145], v[18:19], v[212:213], v[144:145] op_sel_hi:[0,1,1]
v_pk_fma_f32 v[146:147], v[18:19], v[214:215], v[146:147] op_sel_hi:[0,1,1]
v_pk_mul_f32 v[244:245], v[22:23], v[144:145] op_sel_hi:[0,1]
v_pk_mul_f32 v[246:247], v[22:23], v[146:147] op_sel_hi:[0,1]
v_exp_f32 v244, v244
v_exp_f32 v245, v245
v_exp_f32 v246, v246
v_exp_f32 v247, v247
v_pk_fma_f32 v[244:245], v[244:245], v[20:21], v[20:21] op_sel_hi:[1,0,0]
v_pk_fma_f32 v[246:247], v[246:247], v[20:21], v[20:21] op_sel_hi:[1,0,0]
v_rcp_f32 v244, v244
v_rcp_f32 v245, v245
v_rcp_f32 v246, v246
v_rcp_f32 v247, v247
v_pk_mul_f32 v[144:145], v[144:145], v[244:245]
v_pk_mul_f32 v[146:147], v[146:147], v[246:247]
v_cvt_pk_bf16_f32 v240, v144, v145
v_cvt_pk_bf16_f32 v241, v146, v147
v_pk_fma_f32 v[148:149], v[18:19], v[216:217], v[148:149] op_sel_hi:[0,1,1]
v_pk_fma_f32 v[150:151], v[18:19], v[218:219], v[150:151] op_sel_hi:[0,1,1]
v_pk_mul_f32 v[248:249], v[22:23], v[148:149] op_sel_hi:[0,1]
v_pk_mul_f32 v[250:251], v[22:23], v[150:151] op_sel_hi:[0,1]
v_exp_f32 v248, v248
v_exp_f32 v249, v249
v_exp_f32 v250, v250
v_exp_f32 v251, v251
v_pk_fma_f32 v[248:249], v[248:249], v[20:21], v[20:21] op_sel_hi:[1,0,0]
v_pk_fma_f32 v[250:251], v[250:251], v[20:21], v[20:21] op_sel_hi:[1,0,0]
v_rcp_f32 v248, v248
v_rcp_f32 v249, v249
v_rcp_f32 v250, v250
v_rcp_f32 v251, v251
v_pk_mul_f32 v[148:149], v[148:149], v[248:249]
v_pk_mul_f32 v[150:151], v[150:151], v[250:251]
v_cvt_pk_bf16_f32 v242, v148, v149
v_cvt_pk_bf16_f32 v243, v150, v151
buffer_store_dwordx4 v[236:239], v1, s[4:7], s26 offen offset:0
buffer_store_dwordx4 v[240:243], v1, s[4:7], s26 offen offset:1024
s_waitcnt lgkmcnt(0)
v_pk_fma_f32 v[152:153], v[18:19], v[220:221], v[152:153] op_sel_hi:[0,1,1]
v_pk_fma_f32 v[154:155], v[18:19], v[222:223], v[154:155] op_sel_hi:[0,1,1]
v_pk_mul_f32 v[244:245], v[22:23], v[152:153] op_sel_hi:[0,1]
v_pk_mul_f32 v[246:247], v[22:23], v[154:155] op_sel_hi:[0,1]
v_exp_f32 v244, v244
v_exp_f32 v245, v245
v_exp_f32 v246, v246
v_exp_f32 v247, v247
v_pk_fma_f32 v[244:245], v[244:245], v[20:21], v[20:21] op_sel_hi:[1,0,0]
v_pk_fma_f32 v[246:247], v[246:247], v[20:21], v[20:21] op_sel_hi:[1,0,0]
v_rcp_f32 v244, v244
v_rcp_f32 v245, v245
v_rcp_f32 v246, v246
v_rcp_f32 v247, v247
v_pk_mul_f32 v[152:153], v[152:153], v[244:245]
v_pk_mul_f32 v[154:155], v[154:155], v[246:247]
v_cvt_pk_bf16_f32 v236, v152, v153
v_cvt_pk_bf16_f32 v237, v154, v155
v_pk_fma_f32 v[156:157], v[18:19], v[224:225], v[156:157] op_sel_hi:[0,1,1]
v_pk_fma_f32 v[158:159], v[18:19], v[226:227], v[158:159] op_sel_hi:[0,1,1]
v_pk_mul_f32 v[248:249], v[22:23], v[156:157] op_sel_hi:[0,1]
v_pk_mul_f32 v[250:251], v[22:23], v[158:159] op_sel_hi:[0,1]
v_exp_f32 v248, v248
v_exp_f32 v249, v249
v_exp_f32 v250, v250
v_exp_f32 v251, v251
v_pk_fma_f32 v[248:249], v[248:249], v[20:21], v[20:21] op_sel_hi:[1,0,0]
v_pk_fma_f32 v[250:251], v[250:251], v[20:21], v[20:21] op_sel_hi:[1,0,0]
v_rcp_f32 v248, v248
v_rcp_f32 v249, v249
v_rcp_f32 v250, v250
v_rcp_f32 v251, v251
v_pk_mul_f32 v[156:157], v[156:157], v[248:249]
v_pk_mul_f32 v[158:159], v[158:159], v[250:251]
v_cvt_pk_bf16_f32 v238, v156, v157
v_cvt_pk_bf16_f32 v239, v158, v159
v_pk_fma_f32 v[160:161], v[18:19], v[228:229], v[160:161] op_sel_hi:[0,1,1]
v_pk_fma_f32 v[162:163], v[18:19], v[230:231], v[162:163] op_sel_hi:[0,1,1]
v_pk_mul_f32 v[244:245], v[22:23], v[160:161] op_sel_hi:[0,1]
v_pk_mul_f32 v[246:247], v[22:23], v[162:163] op_sel_hi:[0,1]
v_exp_f32 v244, v244
v_exp_f32 v245, v245
v_exp_f32 v246, v246
v_exp_f32 v247, v247
v_pk_fma_f32 v[244:245], v[244:245], v[20:21], v[20:21] op_sel_hi:[1,0,0]
v_pk_fma_f32 v[246:247], v[246:247], v[20:21], v[20:21] op_sel_hi:[1,0,0]
v_rcp_f32 v244, v244
v_rcp_f32 v245, v245
v_rcp_f32 v246, v246
v_rcp_f32 v247, v247
v_pk_mul_f32 v[160:161], v[160:161], v[244:245]
v_pk_mul_f32 v[162:163], v[162:163], v[246:247]
v_cvt_pk_bf16_f32 v240, v160, v161
v_cvt_pk_bf16_f32 v241, v162, v163
v_pk_fma_f32 v[164:165], v[18:19], v[232:233], v[164:165] op_sel_hi:[0,1,1]
v_pk_fma_f32 v[166:167], v[18:19], v[234:235], v[166:167] op_sel_hi:[0,1,1]
v_pk_mul_f32 v[248:249], v[22:23], v[164:165] op_sel_hi:[0,1]
v_pk_mul_f32 v[250:251], v[22:23], v[166:167] op_sel_hi:[0,1]
v_exp_f32 v248, v248
v_exp_f32 v249, v249
v_exp_f32 v250, v250
v_exp_f32 v251, v251
v_pk_fma_f32 v[248:249], v[248:249], v[20:21], v[20:21] op_sel_hi:[1,0,0]
v_pk_fma_f32 v[250:251], v[250:251], v[20:21], v[20:21] op_sel_hi:[1,0,0]
v_rcp_f32 v248, v248
v_rcp_f32 v249, v249
v_rcp_f32 v250, v250
v_rcp_f32 v251, v251
v_pk_mul_f32 v[164:165], v[164:165], v[248:249]
v_pk_mul_f32 v[166:167], v[166:167], v[250:251]
v_cvt_pk_bf16_f32 v242, v164, v165
v_cvt_pk_bf16_f32 v243, v166, v167
buffer_store_dwordx4 v[236:239], v1, s[4:7], s26 offen offset:2048
buffer_store_dwordx4 v[240:243], v1, s[4:7], s26 offen offset:3072
Lb1_74:
s_lshl_b32 s28, s15, 6
s_add_u32 s28, s28, s19
s_lshl_b32 s28, s28, 7
s_lshl_b32 s29, s13, 2
s_add_u32 s28, s28, s29
s_add_u32 s28, s28, 49152
s_waitcnt vmcnt(0)
v_mov_b32 v16, s16
v_mov_b32 v17, 0
s_mov_b64 exec, 1
buffer_store_dword v16, v17, s[4:7], s28 offen
s_mov_b64 exec, -1
s_barrier
s_mul_i32 s26, s14, 7
s_lshr_b32 s26, s26, 1
s_lshl_b32 s26, s26, 2
s_lshl_b32 s28, s15, 6
s_lshl_b32 s29, s12, 2
s_add_u32 s28, s28, s29
s_lshl_b32 s29, s17, 1
s_add_u32 s28, s28, s29
s_lshl_b32 s28, s28, 7
s_add_u32 s28, s28, s26
s_add_u32 s28, s28, 49152
v_and_b32 v12, 3, v0
v_lshlrev_b32 v12, 2, v12
v_bfe_u32 v13, v0, 2, 1
v_lshlrev_b32 v13, 7, v13
v_add_u32 v12, v12, v13
s_mov_b32 s44, 0
buffer_load_dword v16, v12, s[4:7], s28 offen sc1
buffer_load_dword v23, v12, s[4:7], s28 offen sc1
Lpoll_75:
s_waitcnt vmcnt(1)
v_cmp_ne_u32 vcc, s16, v16
s_add_u32 s44, s44, 1
s_cbranch_vccz Lok_76
buffer_load_dword v16, v12, s[4:7], s28 offen sc1
s_waitcnt vmcnt(1)
v_cmp_ne_u32 vcc, s16, v23
s_add_u32 s44, s44, 1
s_cbranch_vccz Lok_76
buffer_load_dword v23, v12, s[4:7], s28 offen sc1
s_cmp_lt_u32 s44, 0x400000
s_cbranch_scc1 Lpoll_75
s_branch interleave_layers__softmax_full_mha__dense_activation_silu__prompt_kernel_abort
Lok_76:
s_mul_i32 s24, s15, 8388608
s_add_u32 s24, s24, 33554432
s_mul_i32 s26, s50, 112
s_mul_i32 s27, s14, 28
s_add_u32 s26, s26, s27
s_lshl_b32 s26, s26, 10
s_add_u32 s25, s24, s26
s_xor_b32 s26, s50, 1
s_mul_i32 s26, s26, 112
s_add_u32 s26, s26, s27
s_lshl_b32 s26, s26, 10
s_add_u32 s24, s24, s26
buffer_load_dwordx4 v[88:91], v1, s[4:7], s25 offen offset:0
buffer_load_dwordx4 v[92:95], v1, s[4:7], s24 offen offset:0
buffer_load_dwordx4 v[96:99], v1, s[4:7], s25 offen offset:1024
buffer_load_dwordx4 v[100:103], v1, s[4:7], s24 offen offset:1024
buffer_load_dwordx4 v[104:107], v1, s[4:7], s25 offen offset:2048
buffer_load_dwordx4 v[108:111], v1, s[4:7], s24 offen offset:2048
buffer_load_dwordx4 v[112:115], v1, s[4:7], s25 offen offset:3072
buffer_load_dwordx4 v[116:119], v1, s[4:7], s24 offen offset:3072
s_add_u32 s24, s24, 4096
s_add_u32 s25, s25, 4096
buffer_load_dwordx4 v[120:123], v1, s[4:7], s25 offen offset:0
buffer_load_dwordx4 v[124:127], v1, s[4:7], s24 offen offset:0
s_waitcnt vmcnt(8)
v_mfma_f32_32x32x16_bf16 v[24:39], a[0:3], v[88:91], 0
v_mfma_f32_32x32x16_bf16 v[40:55], a[4:7], v[88:91], 0
v_mfma_f32_32x32x16_bf16 v[56:71], a[0:3], v[92:95], 0
v_mfma_f32_32x32x16_bf16 v[72:87], a[4:7], v[92:95], 0
buffer_load_dwordx4 v[128:131], v1, s[4:7], s25 offen offset:1024
buffer_load_dwordx4 v[132:135], v1, s[4:7], s24 offen offset:1024
s_waitcnt vmcnt(8)
v_mfma_f32_32x32x16_bf16 v[24:39], a[8:11], v[96:99], v[24:39]
v_mfma_f32_32x32x16_bf16 v[40:55], a[12:15], v[96:99], v[40:55]
v_mfma_f32_32x32x16_bf16 v[56:71], a[8:11], v[100:103], v[56:71]
v_mfma_f32_32x32x16_bf16 v[72:87], a[12:15], v[100:103], v[72:87]
buffer_load_dwordx4 v[136:139], v1, s[4:7], s25 offen offset:2048
buffer_load_dwordx4 v[140:143], v1, s[4:7], s24 offen offset:2048
s_waitcnt vmcnt(8)
v_mfma_f32_32x32x16_bf16 v[24:39], a[16:19], v[104:107], v[24:39]
v_mfma_f32_32x32x16_bf16 v[40:55], a[20:23], v[104:107], v[40:55]
v_mfma_f32_32x32x16_bf16 v[56:71], a[16:19], v[108:111], v[56:71]
v_mfma_f32_32x32x16_bf16 v[72:87], a[20:23], v[108:111], v[72:87]
buffer_load_dwordx4 v[144:147], v1, s[4:7], s25 offen offset:3072
buffer_load_dwordx4 v[148:151], v1, s[4:7], s24 offen offset:3072
s_add_u32 s24, s24, 4096
s_add_u32 s25, s25, 4096
s_waitcnt vmcnt(8)
v_mfma_f32_32x32x16_bf16 v[24:39], a[24:27], v[112:115], v[24:39]
v_mfma_f32_32x32x16_bf16 v[40:55], a[28:31], v[112:115], v[40:55]
v_mfma_f32_32x32x16_bf16 v[56:71], a[24:27], v[116:119], v[56:71]
v_mfma_f32_32x32x16_bf16 v[72:87], a[28:31], v[116:119], v[72:87]
buffer_load_dwordx4 v[152:155], v1, s[4:7], s25 offen offset:0
buffer_load_dwordx4 v[156:159], v1, s[4:7], s24 offen offset:0
s_waitcnt vmcnt(8)
v_mfma_f32_32x32x16_bf16 v[24:39], a[32:35], v[120:123], v[24:39]
v_mfma_f32_32x32x16_bf16 v[40:55], a[36:39], v[120:123], v[40:55]
v_mfma_f32_32x32x16_bf16 v[56:71], a[32:35], v[124:127], v[56:71]
v_mfma_f32_32x32x16_bf16 v[72:87], a[36:39], v[124:127], v[72:87]
buffer_load_dwordx4 v[160:163], v1, s[4:7], s25 offen offset:1024
buffer_load_dwordx4 v[164:167], v1, s[4:7], s24 offen offset:1024
s_waitcnt vmcnt(8)
v_mfma_f32_32x32x16_bf16 v[24:39], a[40:43], v[128:131], v[24:39]
v_mfma_f32_32x32x16_bf16 v[40:55], a[44:47], v[128:131], v[40:55]
v_mfma_f32_32x32x16_bf16 v[56:71], a[40:43], v[132:135], v[56:71]
v_mfma_f32_32x32x16_bf16 v[72:87], a[44:47], v[132:135], v[72:87]
buffer_load_dwordx4 v[168:171], v1, s[4:7], s25 offen offset:2048
buffer_load_dwordx4 v[172:175], v1, s[4:7], s24 offen offset:2048
s_waitcnt vmcnt(8)
v_mfma_f32_32x32x16_bf16 v[24:39], a[48:51], v[136:139], v[24:39]
v_mfma_f32_32x32x16_bf16 v[40:55], a[52:55], v[136:139], v[40:55]
v_mfma_f32_32x32x16_bf16 v[56:71], a[48:51], v[140:143], v[56:71]
v_mfma_f32_32x32x16_bf16 v[72:87], a[52:55], v[140:143], v[72:87]
buffer_load_dwordx4 v[176:179], v1, s[4:7], s25 offen offset:3072
buffer_load_dwordx4 v[180:183], v1, s[4:7], s24 offen offset:3072
s_add_u32 s24, s24, 4096
s_add_u32 s25, s25, 4096
s_waitcnt vmcnt(8)
v_mfma_f32_32x32x16_bf16 v[24:39], a[56:59], v[144:147], v[24:39]
v_mfma_f32_32x32x16_bf16 v[40:55], a[60:63], v[144:147], v[40:55]
v_mfma_f32_32x32x16_bf16 v[56:71], a[56:59], v[148:151], v[56:71]
v_mfma_f32_32x32x16_bf16 v[72:87], a[60:63], v[148:151], v[72:87]
buffer_load_dwordx4 v[184:187], v1, s[4:7], s25 offen offset:0
buffer_load_dwordx4 v[188:191], v1, s[4:7], s24 offen offset:0
s_waitcnt vmcnt(8)
v_mfma_f32_32x32x16_bf16 v[24:39], a[64:67], v[152:155], v[24:39]
v_mfma_f32_32x32x16_bf16 v[40:55], a[68:71], v[152:155], v[40:55]
v_mfma_f32_32x32x16_bf16 v[56:71], a[64:67], v[156:159], v[56:71]
v_mfma_f32_32x32x16_bf16 v[72:87], a[68:71], v[156:159], v[72:87]
buffer_load_dwordx4 v[192:195], v1, s[4:7], s25 offen offset:1024
buffer_load_dwordx4 v[196:199], v1, s[4:7], s24 offen offset:1024
s_waitcnt vmcnt(8)
v_mfma_f32_32x32x16_bf16 v[24:39], a[72:75], v[160:163], v[24:39]
v_mfma_f32_32x32x16_bf16 v[40:55], a[76:79], v[160:163], v[40:55]
v_mfma_f32_32x32x16_bf16 v[56:71], a[72:75], v[164:167], v[56:71]
v_mfma_f32_32x32x16_bf16 v[72:87], a[76:79], v[164:167], v[72:87]
buffer_load_dwordx4 v[200:203], v1, s[4:7], s25 offen offset:2048
buffer_load_dwordx4 v[204:207], v1, s[4:7], s24 offen offset:2048
s_waitcnt vmcnt(8)
v_mfma_f32_32x32x16_bf16 v[24:39], a[80:83], v[168:171], v[24:39]
v_mfma_f32_32x32x16_bf16 v[40:55], a[84:87], v[168:171], v[40:55]
v_mfma_f32_32x32x16_bf16 v[56:71], a[80:83], v[172:175], v[56:71]
v_mfma_f32_32x32x16_bf16 v[72:87], a[84:87], v[172:175], v[72:87]
buffer_load_dwordx4 v[208:211], v1, s[4:7], s25 offen offset:3072
buffer_load_dwordx4 v[212:215], v1, s[4:7], s24 offen offset:3072
s_add_u32 s24, s24, 4096
s_add_u32 s25, s25, 4096
s_waitcnt vmcnt(8)
v_mfma_f32_32x32x16_bf16 v[24:39], a[88:91], v[176:179], v[24:39]
v_mfma_f32_32x32x16_bf16 v[40:55], a[92:95], v[176:179], v[40:55]
v_mfma_f32_32x32x16_bf16 v[56:71], a[88:91], v[180:183], v[56:71]
v_mfma_f32_32x32x16_bf16 v[72:87], a[92:95], v[180:183], v[72:87]
buffer_load_dwordx4 v[88:91], v1, s[4:7], s25 offen offset:0
buffer_load_dwordx4 v[92:95], v1, s[4:7], s24 offen offset:0
s_waitcnt vmcnt(8)
v_mfma_f32_32x32x16_bf16 v[24:39], a[96:99], v[184:187], v[24:39]
v_mfma_f32_32x32x16_bf16 v[40:55], a[100:103], v[184:187], v[40:55]
v_mfma_f32_32x32x16_bf16 v[56:71], a[96:99], v[188:191], v[56:71]
v_mfma_f32_32x32x16_bf16 v[72:87], a[100:103], v[188:191], v[72:87]
buffer_load_dwordx4 v[96:99], v1, s[4:7], s25 offen offset:1024
buffer_load_dwordx4 v[100:103], v1, s[4:7], s24 offen offset:1024
s_waitcnt vmcnt(8)
v_mfma_f32_32x32x16_bf16 v[24:39], a[104:107], v[192:195], v[24:39]
v_mfma_f32_32x32x16_bf16 v[40:55], a[108:111], v[192:195], v[40:55]
v_mfma_f32_32x32x16_bf16 v[56:71], a[104:107], v[196:199], v[56:71]
v_mfma_f32_32x32x16_bf16 v[72:87], a[108:111], v[196:199], v[72:87]
buffer_load_dwordx4 v[104:107], v1, s[4:7], s25 offen offset:2048
buffer_load_dwordx4 v[108:111], v1, s[4:7], s24 offen offset:2048
s_waitcnt vmcnt(8)
v_mfma_f32_32x32x16_bf16 v[24:39], a[112:115], v[200:203], v[24:39]
v_mfma_f32_32x32x16_bf16 v[40:55], a[116:119], v[200:203], v[40:55]
v_mfma_f32_32x32x16_bf16 v[56:71], a[112:115], v[204:207], v[56:71]
v_mfma_f32_32x32x16_bf16 v[72:87], a[116:119], v[204:207], v[72:87]
buffer_load_dwordx4 v[112:115], v1, s[4:7], s25 offen offset:3072
buffer_load_dwordx4 v[116:119], v1, s[4:7], s24 offen offset:3072
s_add_u32 s24, s24, 4096
s_add_u32 s25, s25, 4096
s_waitcnt vmcnt(8)
v_mfma_f32_32x32x16_bf16 v[24:39], a[120:123], v[208:211], v[24:39]
v_mfma_f32_32x32x16_bf16 v[40:55], a[124:127], v[208:211], v[40:55]
v_mfma_f32_32x32x16_bf16 v[56:71], a[120:123], v[212:215], v[56:71]
v_mfma_f32_32x32x16_bf16 v[72:87], a[124:127], v[212:215], v[72:87]
buffer_load_dwordx4 v[120:123], v1, s[4:7], s25 offen offset:0
buffer_load_dwordx4 v[124:127], v1, s[4:7], s24 offen offset:0
s_waitcnt vmcnt(8)
v_mfma_f32_32x32x16_bf16 v[24:39], a[128:131], v[88:91], v[24:39]
v_mfma_f32_32x32x16_bf16 v[40:55], a[132:135], v[88:91], v[40:55]
v_mfma_f32_32x32x16_bf16 v[56:71], a[128:131], v[92:95], v[56:71]
v_mfma_f32_32x32x16_bf16 v[72:87], a[132:135], v[92:95], v[72:87]
buffer_load_dwordx4 v[128:131], v1, s[4:7], s25 offen offset:1024
buffer_load_dwordx4 v[132:135], v1, s[4:7], s24 offen offset:1024
s_waitcnt vmcnt(8)
v_mfma_f32_32x32x16_bf16 v[24:39], a[136:139], v[96:99], v[24:39]
v_mfma_f32_32x32x16_bf16 v[40:55], a[140:143], v[96:99], v[40:55]
v_mfma_f32_32x32x16_bf16 v[56:71], a[136:139], v[100:103], v[56:71]
v_mfma_f32_32x32x16_bf16 v[72:87], a[140:143], v[100:103], v[72:87]
buffer_load_dwordx4 v[136:139], v1, s[4:7], s25 offen offset:2048
buffer_load_dwordx4 v[140:143], v1, s[4:7], s24 offen offset:2048
s_waitcnt vmcnt(8)
v_mfma_f32_32x32x16_bf16 v[24:39], a[144:147], v[104:107], v[24:39]
v_mfma_f32_32x32x16_bf16 v[40:55], a[148:151], v[104:107], v[40:55]
v_mfma_f32_32x32x16_bf16 v[56:71], a[144:147], v[108:111], v[56:71]
v_mfma_f32_32x32x16_bf16 v[72:87], a[148:151], v[108:111], v[72:87]
buffer_load_dwordx4 v[144:147], v1, s[4:7], s25 offen offset:3072
buffer_load_dwordx4 v[148:151], v1, s[4:7], s24 offen offset:3072
s_add_u32 s24, s24, 4096
s_add_u32 s25, s25, 4096
s_waitcnt vmcnt(8)
v_mfma_f32_32x32x16_bf16 v[24:39], a[152:155], v[112:115], v[24:39]
v_mfma_f32_32x32x16_bf16 v[40:55], a[156:159], v[112:115], v[40:55]
v_mfma_f32_32x32x16_bf16 v[56:71], a[152:155], v[116:119], v[56:71]
v_mfma_f32_32x32x16_bf16 v[72:87], a[156:159], v[116:119], v[72:87]
buffer_load_dwordx4 v[152:155], v1, s[4:7], s25 offen offset:0
buffer_load_dwordx4 v[156:159], v1, s[4:7], s24 offen offset:0
s_waitcnt vmcnt(8)
v_mfma_f32_32x32x16_bf16 v[24:39], a[160:163], v[120:123], v[24:39]
v_mfma_f32_32x32x16_bf16 v[40:55], a[164:167], v[120:123], v[40:55]
v_mfma_f32_32x32x16_bf16 v[56:71], a[160:163], v[124:127], v[56:71]
v_mfma_f32_32x32x16_bf16 v[72:87], a[164:167], v[124:127], v[72:87]
buffer_load_dwordx4 v[160:163], v1, s[4:7], s25 offen offset:1024
buffer_load_dwordx4 v[164:167], v1, s[4:7], s24 offen offset:1024
s_waitcnt vmcnt(8)
v_mfma_f32_32x32x16_bf16 v[24:39], a[168:171], v[128:131], v[24:39]
v_mfma_f32_32x32x16_bf16 v[40:55], a[172:175], v[128:131], v[40:55]
v_mfma_f32_32x32x16_bf16 v[56:71], a[168:171], v[132:135], v[56:71]
v_mfma_f32_32x32x16_bf16 v[72:87], a[172:175], v[132:135], v[72:87]
buffer_load_dwordx4 v[168:171], v1, s[4:7], s25 offen offset:2048
buffer_load_dwordx4 v[172:175], v1, s[4:7], s24 offen offset:2048
s_waitcnt vmcnt(8)
v_mfma_f32_32x32x16_bf16 v[24:39], a[176:179], v[136:139], v[24:39]
v_mfma_f32_32x32x16_bf16 v[40:55], a[180:183], v[136:139], v[40:55]
v_mfma_f32_32x32x16_bf16 v[56:71], a[176:179], v[140:143], v[56:71]
v_mfma_f32_32x32x16_bf16 v[72:87], a[180:183], v[140:143], v[72:87]
buffer_load_dwordx4 v[176:179], v1, s[4:7], s25 offen offset:3072
buffer_load_dwordx4 v[180:183], v1, s[4:7], s24 offen offset:3072
s_add_u32 s24, s24, 4096
s_add_u32 s25, s25, 4096
s_waitcnt vmcnt(8)
v_mfma_f32_32x32x16_bf16 v[24:39], a[184:187], v[144:147], v[24:39]
v_mfma_f32_32x32x16_bf16 v[40:55], a[188:191], v[144:147], v[40:55]
v_mfma_f32_32x32x16_bf16 v[56:71], a[184:187], v[148:151], v[56:71]
v_mfma_f32_32x32x16_bf16 v[72:87], a[188:191], v[148:151], v[72:87]
s_cmp_eq_u32 s15, 0
s_cbranch_scc1 Lx20_77
s_waitcnt vmcnt(6)
v_mfma_f32_32x32x16_bf16 v[24:39], a[192:195], v[152:155], v[24:39]
v_mfma_f32_32x32x16_bf16 v[40:55], a[196:199], v[152:155], v[40:55]
v_mfma_f32_32x32x16_bf16 v[56:71], a[192:195], v[156:159], v[56:71]
v_mfma_f32_32x32x16_bf16 v[72:87], a[196:199], v[156:159], v[72:87]
s_waitcnt vmcnt(4)
v_mfma_f32_32x32x16_bf16 v[24:39], a[200:203], v[160:163], v[24:39]
v_mfma_f32_32x32x16_bf16 v[40:55], a[204:207], v[160:163], v[40:55]
v_mfma_f32_32x32x16_bf16 v[56:71], a[200:203], v[164:167], v[56:71]
v_mfma_f32_32x32x16_bf16 v[72:87], a[204:207], v[164:167], v[72:87]
s_waitcnt vmcnt(2)
v_mfma_f32_32x32x16_bf16 v[24:39], a[208:211], v[168:171], v[24:39]
v_mfma_f32_32x32x16_bf16 v[40:55], a[212:215], v[168:171], v[40:55]
v_mfma_f32_32x32x16_bf16 v[56:71], a[208:211], v[172:175], v[56:71]
v_mfma_f32_32x32x16_bf16 v[72:87], a[212:215], v[172:175], v[72:87]
s_waitcnt vmcnt(0)
v_mfma_f32_32x32x16_bf16 v[24:39], a[216:219], v[176:179], v[24:39]
v_mfma_f32_32x32x16_bf16 v[40:55], a[220:223], v[176:179], v[40:55]
v_mfma_f32_32x32x16_bf16 v[56:71], a[216:219], v[180:183], v[56:71]
v_mfma_f32_32x32x16_bf16 v[72:87], a[220:223], v[180:183], v[72:87]
s_branch Lx21_78
Lx20_77:
v_min_u32 v216, 15, v0
v_lshlrev_b32 v216, 7, v216
v_min_u32 v217, 3, v0
v_lshlrev_b32 v217, 7, v217
s_mul_i32 s22, s50, 28
s_lshl_b32 s23, s51, 1
s_add_u32 s22, s22, s23
s_lshl_b32 s22, s22, 10
s_add_u32 s22, s22, 14680064
s_mul_i32 s23, s50, 3584
s_add_u32 s23, s23, 1343488
s_lshr_b32 s21, s51, 1
s_lshl_b32 s21, s21, 9
s_add_u32 s23, s23, s21
buffer_load_dword v16, v216, s[4:7], s22 offen sc1
buffer_load_dword v16, v217, s[4:7], s23 offen sc1
s_waitcnt vmcnt(8)
v_mfma_f32_32x32x16_bf16 v[24:39], a[192:195], v[152:155], v[24:39]
v_mfma_f32_32x32x16_bf16 v[40:55], a[196:199], v[152:155], v[40:55]
v_mfma_f32_32x32x16_bf16 v[56:71], a[192:195], v[156:159], v[56:71]
v_mfma_f32_32x32x16_bf16 v[72:87], a[196:199], v[156:159], v[72:87]
s_waitcnt vmcnt(6)
v_mfma_f32_32x32x16_bf16 v[24:39], a[200:203], v[160:163], v[24:39]
v_mfma_f32_32x32x16_bf16 v[40:55], a[204:207], v[160:163], v[40:55]
v_mfma_f32_32x32x16_bf16 v[56:71], a[200:203], v[164:167], v[56:71]
v_mfma_f32_32x32x16_bf16 v[72:87], a[204:207], v[164:167], v[72:87]
s_waitcnt vmcnt(4)
v_mfma_f32_32x32x16_bf16 v[24:39], a[208:211], v[168:171], v[24:39]
v_mfma_f32_32x32x16_bf16 v[40:55], a[212:215], v[168:171], v[40:55]
v_mfma_f32_32x32x16_bf16 v[56:71], a[208:211], v[172:175], v[56:71]
v_mfma_f32_32x32x16_bf16 v[72:87], a[212:215], v[172:175], v[72:87]
s_waitcnt vmcnt(2)
v_mfma_f32_32x32x16_bf16 v[24:39], a[216:219], v[176:179], v[24:39]
v_mfma_f32_32x32x16_bf16 v[40:55], a[220:223], v[176:179], v[40:55]
v_mfma_f32_32x32x16_bf16 v[56:71], a[216:219], v[180:183], v[56:71]
v_mfma_f32_32x32x16_bf16 v[72:87], a[220:223], v[180:183], v[72:87]
Lx21_78:
s_nop 7
s_nop 3
s_xor_b32 s26, s14, 1
s_mul_i32 s26, s26, 12288
s_add_u32 s26, s26, 86016
v_add_u32 v14, s26, v1
ds_write_b128 v14, v[40:43] offset:0
ds_write_b128 v14, v[44:47] offset:1024
ds_write_b128 v14, v[48:51] offset:2048
ds_write_b128 v14, v[52:55] offset:3072
s_xor_b32 s26, s14, 2
s_mul_i32 s26, s26, 12288
s_add_u32 s26, s26, 90112
v_add_u32 v14, s26, v1
ds_write_b128 v14, v[56:59] offset:0
ds_write_b128 v14, v[60:63] offset:1024
ds_write_b128 v14, v[64:67] offset:2048
ds_write_b128 v14, v[68:71] offset:3072
s_xor_b32 s26, s14, 3
s_mul_i32 s26, s26, 12288
s_add_u32 s26, s26, 94208
v_add_u32 v14, s26, v1
ds_write_b128 v14, v[72:75] offset:0
ds_write_b128 v14, v[76:79] offset:1024
ds_write_b128 v14, v[80:83] offset:2048
ds_write_b128 v14, v[84:87] offset:3072
s_waitcnt lgkmcnt(0)
s_barrier
s_mul_i32 s26, s14, 12288
s_add_u32 s26, s26, 86016
v_add_u32 v14, s26, v1
ds_read_b128 v[88:91], v14 offset:0
ds_read_b128 v[92:95], v14 offset:1024
ds_read_b128 v[96:99], v14 offset:2048
ds_read_b128 v[100:103], v14 offset:3072
ds_read_b128 v[104:107], v14 offset:4096
ds_read_b128 v[108:111], v14 offset:5120
ds_read_b128 v[112:115], v14 offset:6144
ds_read_b128 v[116:119], v14 offset:7168
ds_read_b128 v[120:123], v14 offset:8192
ds_read_b128 v[124:127], v14 offset:9216
ds_read_b128 v[128:131], v14 offset:10240
ds_read_b128 v[132:135], v14 offset:11264
s_waitcnt lgkmcnt(8)
v_pk_add_f32 v[24:25], v[24:25], v[88:89]
v_pk_add_f32 v[26:27], v[26:27], v[90:91]
v_pk_add_f32 v[28:29], v[28:29], v[92:93]
v_pk_add_f32 v[30:31], v[30:31], v[94:95]
v_pk_add_f32 v[32:33], v[32:33], v[96:97]
v_pk_add_f32 v[34:35], v[34:35], v[98:99]
v_pk_add_f32 v[36:37], v[36:37], v[100:101]
v_pk_add_f32 v[38:39], v[38:39], v[102:103]
s_waitcnt lgkmcnt(4)
v_pk_add_f32 v[24:25], v[24:25], v[104:105]
v_pk_add_f32 v[26:27], v[26:27], v[106:107]
v_pk_add_f32 v[28:29], v[28:29], v[108:109]
v_pk_add_f32 v[30:31], v[30:31], v[110:111]
v_pk_add_f32 v[32:33], v[32:33], v[112:113]
v_pk_add_f32 v[34:35], v[34:35], v[114:115]
v_pk_add_f32 v[36:37], v[36:37], v[116:117]
v_pk_add_f32 v[38:39], v[38:39], v[118:119]
s_waitcnt lgkmcnt(0)
v_pk_add_f32 v[24:25], v[24:25], v[120:121]
v_pk_add_f32 v[26:27], v[26:27], v[122:123]
v_pk_add_f32 v[28:29], v[28:29], v[124:125]
v_pk_add_f32 v[30:31], v[30:31], v[126:127]
v_pk_add_f32 v[32:33], v[32:33], v[128:129]
v_pk_add_f32 v[34:35], v[34:35], v[130:131]
v_pk_add_f32 v[36:37], v[36:37], v[132:133]
v_pk_add_f32 v[38:39], v[38:39], v[134:135]
s_cmp_lg_u32 s15, 0
s_cbranch_scc1 Lfin_79
s_mul_i32 s24, s15, 0
s_add_u32 s24, s24, 14680064
s_mul_i32 s25, s15, 0
s_add_u32 s25, s25, 1343488
s_mul_i32 s26, s50, 28
s_lshl_b32 s27, s51, 1
s_add_u32 s26, s26, s27
s_lshl_b32 s26, s26, 10
s_add_u32 s24, s24, s26
s_mul_i32 s26, s50, 3584
s_add_u32 s25, s25, s26
s_lshr_b32 s26, s51, 1
s_lshl_b32 s26, s26, 9
s_add_u32 s25, s25, s26
s_and_b32 s26, s51, 1
s_lshl_b32 s26, s26, 3
s_add_u32 s25, s25, s26
s_mul_i32 s20, s13, 86016
s_mul_i32 s21, s14, 14336
s_add_u32 s20, s20, s21
s_add_u32 s20, s20, 2097152
s_add_u32 s21, s21, 0
s_mov_b32 m0, s21
s_nop 0
buffer_load_dwordx4 v1, s[4:7], s20 offen offset:0 lds
buffer_load_dwordx4 v1, s[4:7], s20 offen offset:1024 lds
s_add_u32 s20, s20, 2048
s_add_u32 s21, s21, 2048
v_lshlrev_b32 v216, 16, v4
v_and_b32 v217, 0xffff0000, v4
v_pk_add_f32 v[24:25], v[24:25], v[216:217]
v_cvt_pk_bf16_f32 v4, v24, v25
s_mov_b32 m0, s21
s_nop 0
buffer_load_dwordx4 v1, s[4:7], s20 offen offset:0 lds
buffer_load_dwordx4 v1, s[4:7], s20 offen offset:1024 lds
s_add_u32 s20, s20, 2048
s_add_u32 s21, s21, 2048
v_lshlrev_b32 v216, 16, v5
v_and_b32 v217, 0xffff0000, v5
v_pk_add_f32 v[26:27], v[26:27], v[216:217]
v_cvt_pk_bf16_f32 v5, v26, v27
s_mov_b32 m0, s21
s_nop 0
buffer_load_dwordx4 v1, s[4:7], s20 offen offset:0 lds
buffer_load_dwordx4 v1, s[4:7], s20 offen offset:1024 lds
s_add_u32 s20, s20, 2048
s_add_u32 s21, s21, 2048
v_lshlrev_b32 v216, 16, v6
v_and_b32 v217, 0xffff0000, v6
v_pk_add_f32 v[28:29], v[28:29], v[216:217]
v_cvt_pk_bf16_f32 v6, v28, v29
s_mov_b32 m0, s21
s_nop 0
buffer_load_dwordx4 v1, s[4:7], s20 offen offset:0 lds
buffer_load_dwordx4 v1, s[4:7], s20 offen offset:1024 lds
s_add_u32 s20, s20, 2048
s_add_u32 s21, s21, 2048
v_lshlrev_b32 v216, 16, v7
v_and_b32 v217, 0xffff0000, v7
v_pk_add_f32 v[30:31], v[30:31], v[216:217]
v_cvt_pk_bf16_f32 v7, v30, v31
s_mov_b32 m0, s21
s_nop 0
buffer_load_dwordx4 v1, s[4:7], s20 offen offset:0 lds
buffer_load_dwordx4 v1, s[4:7], s20 offen offset:1024 lds
s_add_u32 s20, s20, 2048
s_add_u32 s21, s21, 2048
v_lshlrev_b32 v216, 16, v8
v_and_b32 v217, 0xffff0000, v8
v_pk_add_f32 v[32:33], v[32:33], v[216:217]
v_cvt_pk_bf16_f32 v8, v32, v33
s_mov_b32 m0, s21
s_nop 0
buffer_load_dwordx4 v1, s[4:7], s20 offen offset:0 lds
buffer_load_dwordx4 v1, s[4:7], s20 offen offset:1024 lds
s_add_u32 s20, s20, 2048
s_add_u32 s21, s21, 2048
v_lshlrev_b32 v216, 16, v9
v_and_b32 v217, 0xffff0000, v9
v_pk_add_f32 v[34:35], v[34:35], v[216:217]
v_cvt_pk_bf16_f32 v9, v34, v35
s_mov_b32 m0, s21
s_nop 0
buffer_load_dwordx4 v1, s[4:7], s20 offen offset:0 lds
buffer_load_dwordx4 v1, s[4:7], s20 offen offset:1024 lds
s_add_u32 s20, s20, 2048
s_add_u32 s21, s21, 2048
v_lshlrev_b32 v216, 16, v10
v_and_b32 v217, 0xffff0000, v10
v_pk_add_f32 v[36:37], v[36:37], v[216:217]
v_cvt_pk_bf16_f32 v10, v36, v37
v_lshlrev_b32 v216, 16, v11
v_and_b32 v217, 0xffff0000, v11
v_pk_add_f32 v[38:39], v[38:39], v[216:217]
v_cvt_pk_bf16_f32 v11, v38, v39
buffer_store_dwordx4 v[4:7], v1, s[4:7], s24 offen
buffer_store_dwordx4 v[8:11], v1, s[4:7], s24 offen offset:1024
v_pk_add_f32 v[220:221], v[24:25], v[26:27]
v_pk_mul_f32 v[222:223], v[24:25], v[24:25]
v_pk_fma_f32 v[222:223], v[26:27], v[26:27], v[222:223]
v_pk_add_f32 v[220:221], v[220:221], v[28:29]
v_pk_fma_f32 v[222:223], v[28:29], v[28:29], v[222:223]
v_pk_add_f32 v[220:221], v[220:221], v[30:31]
v_pk_fma_f32 v[222:223], v[30:31], v[30:31], v[222:223]
v_pk_add_f32 v[220:221], v[220:221], v[32:33]
v_pk_fma_f32 v[222:223], v[32:33], v[32:33], v[222:223]
v_pk_add_f32 v[220:221], v[220:221], v[34:35]
v_pk_fma_f32 v[222:223], v[34:35], v[34:35], v[222:223]
v_pk_add_f32 v[220:221], v[220:221], v[36:37]
v_pk_fma_f32 v[222:223], v[36:37], v[36:37], v[222:223]
v_pk_add_f32 v[220:221], v[220:221], v[38:39]
v_pk_fma_f32 v[222:223], v[38:39], v[38:39], v[222:223]
v_add_f32 v218, v220, v221
v_add_f32 v219, v222, v223
v_mov_b32 v216, v218
v_mov_b32 v217, v219
s_nop 0
v_permlane32_swap_b32 v218, v216
v_permlane32_swap_b32 v219, v217
v_add_f32 v218, v218, v216
v_add_f32 v219, v219, v217
v_lshlrev_b32 v12, 4, v3
buffer_store_dwordx2 v[218:219], v12, s[4:7], s25 offen
s_lshl_b32 s28, s50, 7
s_lshl_b32 s29, s51, 2
s_add_u32 s28, s28, s29
s_add_u32 s28, s28, 65536
s_waitcnt vmcnt(0)
v_mov_b32 v16, s16
v_mov_b32 v17, 0
s_mov_b64 exec, 1
buffer_store_dword v16, v17, s[4:7], s28 offen
s_mov_b64 exec, -1
s_barrier
s_mov_b32 s15, 1
s_branch interleave_layers__softmax_full_mha__dense_activation_silu__prompt_kernel_layer
Lfin_79:
v_lshlrev_b32 v216, 16, v4
v_and_b32 v217, 0xffff0000, v4
v_pk_add_f32 v[24:25], v[24:25], v[216:217]
v_cvt_pk_bf16_f32 v4, v24, v25
v_lshlrev_b32 v216, 16, v5
v_and_b32 v217, 0xffff0000, v5
v_pk_add_f32 v[26:27], v[26:27], v[216:217]
v_cvt_pk_bf16_f32 v5, v26, v27
v_lshlrev_b32 v216, 16, v6
v_and_b32 v217, 0xffff0000, v6
v_pk_add_f32 v[28:29], v[28:29], v[216:217]
v_cvt_pk_bf16_f32 v6, v28, v29
v_lshlrev_b32 v216, 16, v7
v_and_b32 v217, 0xffff0000, v7
v_pk_add_f32 v[30:31], v[30:31], v[216:217]
v_cvt_pk_bf16_f32 v7, v30, v31
v_lshlrev_b32 v216, 16, v8
v_and_b32 v217, 0xffff0000, v8
v_pk_add_f32 v[32:33], v[32:33], v[216:217]
v_cvt_pk_bf16_f32 v8, v32, v33
v_lshlrev_b32 v216, 16, v9
v_and_b32 v217, 0xffff0000, v9
v_pk_add_f32 v[34:35], v[34:35], v[216:217]
v_cvt_pk_bf16_f32 v9, v34, v35
v_lshlrev_b32 v216, 16, v10
v_and_b32 v217, 0xffff0000, v10
v_pk_add_f32 v[36:37], v[36:37], v[216:217]
v_cvt_pk_bf16_f32 v10, v36, v37
v_lshlrev_b32 v216, 16, v11
v_and_b32 v217, 0xffff0000, v11
v_pk_add_f32 v[38:39], v[38:39], v[216:217]
v_cvt_pk_bf16_f32 v11, v38, v39
v_mul_u32_u24 v12, 896, v3
v_lshlrev_b32 v13, 4, v2
v_add_u32 v12, v12, v13
s_mul_i32 s26, s50, 28672
s_lshl_b32 s27, s51, 6
s_add_u32 s26, s26, s27
v_permlane32_swap_b32 v4, v6
v_permlane32_swap_b32 v5, v7
v_permlane32_swap_b32 v8, v10
v_permlane32_swap_b32 v9, v11
buffer_store_dwordx4 v[4:7], v12, s[8:11], s26 offen offset:0
buffer_store_dwordx4 v[8:11], v12, s[8:11], s26 offen offset:32
s_branch interleave_layers__softmax_full_mha__dense_activation_silu__prompt_kernel_end
Lslow_66:
v_mov_b32 v200, v36
v_mov_b32 v201, v36
s_nop 1
v_permlane32_swap_b32 v200, v201
v_max3_f32 v202, |v24|, |v25|, |v26|
v_max3_f32 v202, v202, |v27|, |v28|
v_max3_f32 v202, v202, |v29|, |v30|
v_max3_f32 v202, v202, |v31|, |v32|
v_max3_f32 v202, v202, |v33|, |v34|
v_max3_f32 v202, v202, |v35|, |v36|
v_max3_f32 v202, v202, |v37|, |v38|
v_max_f32_e64 v202, v202, |v39|
v_mov_b32 v203, 0x1f800000
v_cmp_nge_f32 vcc, v201, v203
v_mov_b32 v203, 0x5f800000
v_cmp_nle_f32 s[20:21], v201, v203
v_mov_b32 v203, 0x7f7fffff
v_cmp_nle_f32 s[22:23], v202, v203
s_or_b64 vcc, vcc, s[20:21]
s_or_b64 vcc, vcc, s[22:23]
s_cbranch_vccnz Lfb_80
Lfbok_81:
v_rcp_f32 v202, v201
s_mul_i32 s27, s15, 2097152
s_add_u32 s27, s27, 16777216
s_lshl_b32 s28, s19, 4
s_add_u32 s28, s28, s13
s_lshl_b32 s28, s28, 11
s_add_u32 s27, s27, s28
v_pk_mul_f32 v[24:25], v[202:203], v[24:25] op_sel_hi:[0,1]
v_pk_mul_f32 v[26:27], v[202:203], v[26:27] op_sel_hi:[0,1]
v_pk_mul_f32 v[28:29], v[202:203], v[28:29] op_sel_hi:[0,1]
v_pk_mul_f32 v[30:31], v[202:203], v[30:31] op_sel_hi:[0,1]
v_pk_mul_f32 v[32:33], v[202:203], v[32:33] op_sel_hi:[0,1]
v_pk_mul_f32 v[34:35], v[202:203], v[34:35] op_sel_hi:[0,1]
v_pk_mul_f32 v[36:37], v[202:203], v[36:37] op_sel_hi:[0,1]
v_pk_mul_f32 v[38:39], v[202:203], v[38:39] op_sel_hi:[0,1]
v_cvt_pk_bf16_f32 v184, v24, v25
v_cvt_pk_bf16_f32 v185, v26, v27
v_cvt_pk_bf16_f32 v186, v28, v29
v_cvt_pk_bf16_f32 v187, v30, v31
v_cvt_pk_bf16_f32 v188, v32, v33
v_cvt_pk_bf16_f32 v189, v34, v35
v_cvt_pk_bf16_f32 v190, v36, v37
v_cvt_pk_bf16_f32 v191, v38, v39
v_mov_b32 v17, 0
v_cndmask_b32 v190, v190, v17, s[42:43]
v_cndmask_b32 v191, v191, v17, s[42:43]
buffer_store_dwordx4 v[184:187], v1, s[4:7], s27 offen sc1
buffer_store_dwordx4 v[188:191], v1, s[4:7], s27 offen offset:1024 sc1
s_lshl_b32 s28, s15, 6
s_add_u32 s28, s28, s19
s_lshl_b32 s28, s28, 7
s_lshl_b32 s29, s13, 2
s_add_u32 s28, s28, s29
s_add_u32 s28, s28, 16384
s_waitcnt vmcnt(0)
v_mov_b32 v16, s16
v_mov_b32 v17, 0
s_mov_b64 exec, 1
buffer_store_dword v16, v17, s[4:7], s28 offen sc1
s_mov_b64 exec, -1
s_barrier
s_cmp_ge_u32 s13, 14
s_cbranch_scc1 Lskip_65
s_lshl_b32 s28, s15, 6
s_add_u32 s28, s28, s50
s_lshl_b32 s28, s28, 7
s_and_b32 s29, s14, 1
s_lshl_b32 s29, s29, 5
s_add_u32 s28, s28, s29
s_add_u32 s28, s28, 16384
v_and_b32 v12, 7, v0
v_lshlrev_b32 v12, 2, v12
s_mov_b32 s44, 0
buffer_load_dword v16, v12, s[4:7], s28 offen sc1
buffer_load_dword v23, v12, s[4:7], s28 offen sc1
Lpoll_82:
s_waitcnt vmcnt(1)
v_cmp_ne_u32 vcc, s16, v16
s_add_u32 s44, s44, 1
s_cbranch_vccz Lok_83
buffer_load_dword v16, v12, s[4:7], s28 offen sc1
s_waitcnt vmcnt(1)
v_cmp_ne_u32 vcc, s16, v23
s_add_u32 s44, s44, 1
s_cbranch_vccz Lok_83
buffer_load_dword v23, v12, s[4:7], s28 offen sc1
s_cmp_lt_u32 s44, 0x400000
s_cbranch_scc1 Lpoll_82
s_branch interleave_layers__softmax_full_mha__dense_activation_silu__prompt_kernel_abort
Lok_83:
s_mul_i32 s24, s15, 2097152
s_add_u32 s24, s24, 16777216
s_lshl_b32 s26, s50, 15
s_add_u32 s24, s24, s26
s_and_b32 s26, s14, 1
s_lshl_b32 s26, s26, 14
s_add_u32 s24, s24, s26
buffer_load_dwordx4 v[24:27], v1, s[4:7], s24 offen offset:0
buffer_load_dwordx4 v[28:31], v1, s[4:7], s24 offen offset:1024
buffer_load_dwordx4 v[32:35], v1, s[4:7], s24 offen offset:2048
buffer_load_dwordx4 v[36:39], v1, s[4:7], s24 offen offset:3072
s_add_u32 s24, s24, 4096
buffer_load_dwordx4 v[40:43], v1, s[4:7], s24 offen offset:0
buffer_load_dwordx4 v[44:47], v1, s[4:7], s24 offen offset:1024
buffer_load_dwordx4 v[48:51], v1, s[4:7], s24 offen offset:2048
buffer_load_dwordx4 v[52:55], v1, s[4:7], s24 offen offset:3072
s_and_b32 s26, s14, 1
s_mul_i32 s27, s26, 33792
v_add_u32 v12, s27, v1
s_lshl_b32 s27, s26, 15
s_xor_b32 s26, s26, 1
s_lshl_b32 s26, s26, 10
s_add_u32 s27, s27, s26
v_add_u32 v13, s27, v1
ds_read_b128 v[120:123], v12 offset:0
ds_read_b128 v[124:127], v13 offset:0
ds_read_b128 v[128:131], v12 offset:2048
ds_read_b128 v[132:135], v13 offset:2048
s_min_u32 s20, s13, 13
s_mul_i32 s20, s20, 114688
s_mul_i32 s21, s14, 7168
s_add_u32 s20, s20, s21
s_add_u32 s20, s20, 3698688
s_add_u32 s21, s21, 94208
s_add_u32 s24, s24, 4096
buffer_load_dwordx4 v[56:59], v1, s[4:7], s24 offen offset:0
ds_read_b128 v[136:139], v12 offset:4096
ds_read_b128 v[140:143], v13 offset:4096
s_waitcnt vmcnt(8)
s_waitcnt lgkmcnt(4)
v_mfma_f32_32x32x16_bf16 v[88:103], v[120:123], v[24:27], 0
v_mfma_f32_32x32x16_bf16 v[104:119], v[124:127], v[24:27], 0
buffer_load_dwordx4 v[60:63], v1, s[4:7], s24 offen offset:1024
ds_read_b128 v[120:123], v12 offset:6144
ds_read_b128 v[124:127], v13 offset:6144
s_waitcnt vmcnt(8)
s_waitcnt lgkmcnt(4)
v_mfma_f32_32x32x16_bf16 v[88:103], v[128:131], v[28:31], v[88:103]
v_mfma_f32_32x32x16_bf16 v[104:119], v[132:135], v[28:31], v[104:119]
buffer_load_dwordx4 v[64:67], v1, s[4:7], s24 offen offset:2048
ds_read_b128 v[128:131], v12 offset:8192
ds_read_b128 v[132:135], v13 offset:8192
s_waitcnt vmcnt(8)
s_waitcnt lgkmcnt(4)
v_mfma_f32_32x32x16_bf16 v[88:103], v[136:139], v[32:35], v[88:103]
v_mfma_f32_32x32x16_bf16 v[104:119], v[140:143], v[32:35], v[104:119]
buffer_load_dwordx4 v[68:71], v1, s[4:7], s24 offen offset:3072
ds_read_b128 v[136:139], v12 offset:10240
ds_read_b128 v[140:143], v13 offset:10240
s_waitcnt vmcnt(8)
s_waitcnt lgkmcnt(4)
v_mfma_f32_32x32x16_bf16 v[88:103], v[120:123], v[36:39], v[88:103]
v_mfma_f32_32x32x16_bf16 v[104:119], v[124:127], v[36:39], v[104:119]
s_add_u32 s24, s24, 4096
buffer_load_dwordx4 v[72:75], v1, s[4:7], s24 offen offset:0
ds_read_b128 v[120:123], v12 offset:12288
ds_read_b128 v[124:127], v13 offset:12288
s_waitcnt vmcnt(8)
s_waitcnt lgkmcnt(4)
v_mfma_f32_32x32x16_bf16 v[88:103], v[128:131], v[40:43], v[88:103]
v_mfma_f32_32x32x16_bf16 v[104:119], v[132:135], v[40:43], v[104:119]
buffer_load_dwordx4 v[76:79], v1, s[4:7], s24 offen offset:1024
ds_read_b128 v[128:131], v12 offset:14336
ds_read_b128 v[132:135], v13 offset:14336
s_waitcnt vmcnt(8)
s_waitcnt lgkmcnt(4)
v_mfma_f32_32x32x16_bf16 v[88:103], v[136:139], v[44:47], v[88:103]
v_mfma_f32_32x32x16_bf16 v[104:119], v[140:143], v[44:47], v[104:119]
buffer_load_dwordx4 v[80:83], v1, s[4:7], s24 offen offset:2048
ds_read_b128 v[136:139], v12 offset:16384
ds_read_b128 v[140:143], v13 offset:16384
s_waitcnt vmcnt(8)
s_waitcnt lgkmcnt(4)
v_mfma_f32_32x32x16_bf16 v[88:103], v[120:123], v[48:51], v[88:103]
v_mfma_f32_32x32x16_bf16 v[104:119], v[124:127], v[48:51], v[104:119]
buffer_load_dwordx4 v[84:87], v1, s[4:7], s24 offen offset:3072
ds_read_b128 v[120:123], v12 offset:18432
ds_read_b128 v[124:127], v13 offset:18432
s_waitcnt vmcnt(8)
s_waitcnt lgkmcnt(4)
v_mfma_f32_32x32x16_bf16 v[88:103], v[128:131], v[52:55], v[88:103]
v_mfma_f32_32x32x16_bf16 v[104:119], v[132:135], v[52:55], v[104:119]
s_mov_b32 m0, s21
s_nop 0
buffer_load_dwordx4 v1, s[4:7], s20 offen offset:0 lds
ds_read_b128 v[128:131], v12 offset:20480
ds_read_b128 v[132:135], v13 offset:20480
s_waitcnt vmcnt(8)
s_waitcnt lgkmcnt(4)
v_mfma_f32_32x32x16_bf16 v[88:103], v[136:139], v[56:59], v[88:103]
v_mfma_f32_32x32x16_bf16 v[104:119], v[140:143], v[56:59], v[104:119]
buffer_load_dwordx4 v1, s[4:7], s20 offen offset:1024 lds
ds_read_b128 v[136:139], v12 offset:22528
ds_read_b128 v[140:143], v13 offset:22528
s_waitcnt vmcnt(8)
s_waitcnt lgkmcnt(4)
v_mfma_f32_32x32x16_bf16 v[88:103], v[120:123], v[60:63], v[88:103]
v_mfma_f32_32x32x16_bf16 v[104:119], v[124:127], v[60:63], v[104:119]
buffer_load_dwordx4 v1, s[4:7], s20 offen offset:2048 lds
ds_read_b128 v[120:123], v12 offset:24576
ds_read_b128 v[124:127], v13 offset:24576
s_waitcnt vmcnt(8)
s_waitcnt lgkmcnt(4)
v_mfma_f32_32x32x16_bf16 v[88:103], v[128:131], v[64:67], v[88:103]
v_mfma_f32_32x32x16_bf16 v[104:119], v[132:135], v[64:67], v[104:119]
buffer_load_dwordx4 v1, s[4:7], s20 offen offset:3072 lds
s_add_u32 s20, s20, 4096
s_add_u32 s21, s21, 4096
ds_read_b128 v[128:131], v12 offset:26624
ds_read_b128 v[132:135], v13 offset:26624
s_waitcnt vmcnt(8)
s_waitcnt lgkmcnt(4)
v_mfma_f32_32x32x16_bf16 v[88:103], v[136:139], v[68:71], v[88:103]
v_mfma_f32_32x32x16_bf16 v[104:119], v[140:143], v[68:71], v[104:119]
s_mov_b32 m0, s21
s_nop 0
buffer_load_dwordx4 v1, s[4:7], s20 offen offset:0 lds
ds_read_b128 v[136:139], v12 offset:28672
ds_read_b128 v[140:143], v13 offset:28672
s_waitcnt vmcnt(8)
s_waitcnt lgkmcnt(4)
v_mfma_f32_32x32x16_bf16 v[88:103], v[120:123], v[72:75], v[88:103]
v_mfma_f32_32x32x16_bf16 v[104:119], v[124:127], v[72:75], v[104:119]
buffer_load_dwordx4 v1, s[4:7], s20 offen offset:1024 lds
ds_read_b128 v[120:123], v12 offset:30720
ds_read_b128 v[124:127], v13 offset:30720
s_waitcnt vmcnt(8)
s_waitcnt lgkmcnt(4)
v_mfma_f32_32x32x16_bf16 v[88:103], v[128:131], v[76:79], v[88:103]
v_mfma_f32_32x32x16_bf16 v[104:119], v[132:135], v[76:79], v[104:119]
buffer_load_dwordx4 v1, s[4:7], s20 offen offset:2048 lds
s_waitcnt vmcnt(8)
s_waitcnt lgkmcnt(2)
v_mfma_f32_32x32x16_bf16 v[88:103], v[136:139], v[80:83], v[88:103]
v_mfma_f32_32x32x16_bf16 v[104:119], v[140:143], v[80:83], v[104:119]
s_waitcnt vmcnt(7)
s_waitcnt lgkmcnt(0)
v_mfma_f32_32x32x16_bf16 v[88:103], v[120:123], v[84:87], v[88:103]
v_mfma_f32_32x32x16_bf16 v[104:119], v[124:127], v[84:87], v[104:119]
s_xor_b32 s26, s14, 1
s_mul_i32 s26, s26, 4096
s_add_u32 s26, s26, 122880
v_add_u32 v14, s26, v1
s_nop 7
ds_write_b128 v14, v[104:107] offset:0
ds_write_b128 v14, v[108:111] offset:1024
ds_write_b128 v14, v[112:115] offset:2048
ds_write_b128 v14, v[116:119] offset:3072
s_waitcnt lgkmcnt(0)
s_barrier
s_mul_i32 s26, s14, 4096
s_add_u32 s26, s26, 122880
v_add_u32 v14, s26, v1
ds_read_b128 v[24:27], v14 offset:0
ds_read_b128 v[28:31], v14 offset:1024
ds_read_b128 v[32:35], v14 offset:2048
ds_read_b128 v[36:39], v14 offset:3072
s_waitcnt lgkmcnt(0)
v_pk_add_f32 v[88:89], v[88:89], v[24:25]
v_pk_add_f32 v[90:91], v[90:91], v[26:27]
v_pk_add_f32 v[92:93], v[92:93], v[28:29]
v_pk_add_f32 v[94:95], v[94:95], v[30:31]
v_pk_add_f32 v[96:97], v[96:97], v[32:33]
v_pk_add_f32 v[98:99], v[98:99], v[34:35]
v_pk_add_f32 v[100:101], v[100:101], v[36:37]
v_pk_add_f32 v[102:103], v[102:103], v[38:39]
s_min_u32 s20, s13, 13
s_mul_i32 s20, s20, 114688
s_mul_i32 s21, s14, 7168
s_add_u32 s20, s20, s21
s_add_u32 s20, s20, 3727360
s_add_u32 s21, s21, 0
s_mul_i32 s24, s15, 2097152
s_add_u32 s24, s24, 10485760
s_mul_i32 s25, s15, 229376
s_add_u32 s25, s25, 884736
s_mul_i32 s26, s50, 28
s_lshl_b32 s27, s51, 1
s_add_u32 s26, s26, s27
s_lshl_b32 s26, s26, 10
s_add_u32 s24, s24, s26
s_mul_i32 s26, s50, 3584
s_add_u32 s25, s25, s26
s_lshr_b32 s26, s51, 1
s_lshl_b32 s26, s26, 9
s_add_u32 s25, s25, s26
s_and_b32 s26, s51, 1
s_lshl_b32 s26, s26, 3
s_add_u32 s25, s25, s26
s_mov_b32 m0, s21
s_nop 0
buffer_load_dwordx4 v1, s[4:7], s20 offen offset:0 lds
v_lshlrev_b32 v144, 16, v4
v_and_b32 v145, 0xffff0000, v4
v_pk_add_f32 v[88:89], v[88:89], v[144:145]
v_cvt_pk_bf16_f32 v4, v88, v89
buffer_load_dwordx4 v1, s[4:7], s20 offen offset:1024 lds
v_lshlrev_b32 v144, 16, v5
v_and_b32 v145, 0xffff0000, v5
v_pk_add_f32 v[90:91], v[90:91], v[144:145]
v_cvt_pk_bf16_f32 v5, v90, v91
buffer_load_dwordx4 v1, s[4:7], s20 offen offset:2048 lds
v_lshlrev_b32 v144, 16, v6
v_and_b32 v145, 0xffff0000, v6
v_pk_add_f32 v[92:93], v[92:93], v[144:145]
v_cvt_pk_bf16_f32 v6, v92, v93
buffer_load_dwordx4 v1, s[4:7], s20 offen offset:3072 lds
s_add_u32 s20, s20, 4096
s_add_u32 s21, s21, 4096
v_lshlrev_b32 v144, 16, v7
v_and_b32 v145, 0xffff0000, v7
v_pk_add_f32 v[94:95], v[94:95], v[144:145]
v_cvt_pk_bf16_f32 v7, v94, v95
s_mov_b32 m0, s21
s_nop 0
buffer_load_dwordx4 v1, s[4:7], s20 offen offset:0 lds
v_lshlrev_b32 v144, 16, v8
v_and_b32 v145, 0xffff0000, v8
v_pk_add_f32 v[96:97], v[96:97], v[144:145]
v_cvt_pk_bf16_f32 v8, v96, v97
buffer_load_dwordx4 v1, s[4:7], s20 offen offset:1024 lds
v_lshlrev_b32 v144, 16, v9
v_and_b32 v145, 0xffff0000, v9
v_pk_add_f32 v[98:99], v[98:99], v[144:145]
v_cvt_pk_bf16_f32 v9, v98, v99
buffer_load_dwordx4 v1, s[4:7], s20 offen offset:2048 lds
v_lshlrev_b32 v144, 16, v10
v_and_b32 v145, 0xffff0000, v10
v_pk_add_f32 v[100:101], v[100:101], v[144:145]
v_cvt_pk_bf16_f32 v10, v100, v101
v_lshlrev_b32 v144, 16, v11
v_and_b32 v145, 0xffff0000, v11
v_pk_add_f32 v[102:103], v[102:103], v[144:145]
v_cvt_pk_bf16_f32 v11, v102, v103
buffer_store_dwordx4 v[4:7], v1, s[4:7], s24 offen sc1
buffer_store_dwordx4 v[8:11], v1, s[4:7], s24 offen offset:1024 sc1
v_pk_add_f32 v[148:149], v[88:89], v[90:91]
v_pk_mul_f32 v[150:151], v[88:89], v[88:89]
v_pk_fma_f32 v[150:151], v[90:91], v[90:91], v[150:151]
v_pk_add_f32 v[148:149], v[148:149], v[92:93]
v_pk_fma_f32 v[150:151], v[92:93], v[92:93], v[150:151]
v_pk_add_f32 v[148:149], v[148:149], v[94:95]
v_pk_fma_f32 v[150:151], v[94:95], v[94:95], v[150:151]
v_pk_add_f32 v[148:149], v[148:149], v[96:97]
v_pk_fma_f32 v[150:151], v[96:97], v[96:97], v[150:151]
v_pk_add_f32 v[148:149], v[148:149], v[98:99]
v_pk_fma_f32 v[150:151], v[98:99], v[98:99], v[150:151]
v_pk_add_f32 v[148:149], v[148:149], v[100:101]
v_pk_fma_f32 v[150:151], v[100:101], v[100:101], v[150:151]
v_pk_add_f32 v[148:149], v[148:149], v[102:103]
v_pk_fma_f32 v[150:151], v[102:103], v[102:103], v[150:151]
v_add_f32 v146, v148, v149
v_add_f32 v147, v150, v151
v_mov_b32 v144, v146
v_mov_b32 v145, v147
s_nop 0
v_permlane32_swap_b32 v146, v144
v_permlane32_swap_b32 v147, v145
v_add_f32 v146, v146, v144
v_add_f32 v147, v147, v145
v_lshlrev_b32 v12, 4, v3
buffer_store_dwordx2 v[146:147], v12, s[4:7], s25 offen sc1
s_lshl_b32 s28, s15, 6
s_add_u32 s28, s28, s50
s_lshl_b32 s28, s28, 7
s_lshl_b32 s29, s51, 2
s_add_u32 s28, s28, s29
s_add_u32 s28, s28, 32768
s_waitcnt vmcnt(0)
v_mov_b32 v16, s16
v_mov_b32 v17, 0
s_mov_b64 exec, 1
buffer_store_dword v16, v17, s[4:7], s28 offen sc1
s_mov_b64 exec, -1
s_barrier
s_lshl_b32 s28, s15, 6
s_add_u32 s28, s28, s19
s_lshl_b32 s28, s28, 7
s_add_u32 s28, s28, 32768
v_min_u32 v12, 13, v3
v_lshlrev_b32 v12, 2, v12
s_mul_i32 s24, s15, 2097152
s_add_u32 s24, s24, 10485760
s_mul_i32 s25, s15, 229376
s_add_u32 s25, s25, 884736
s_mul_i32 s26, s19, 28672
s_add_u32 s24, s24, s26
s_mul_i32 s26, s19, 3584
s_add_u32 s25, s25, s26
s_mov_b32 s44, 0
buffer_load_dword v16, v12, s[4:7], s28 offen sc1
buffer_load_dword v23, v12, s[4:7], s28 offen sc1
Lpoll_84:
s_waitcnt vmcnt(1)
v_cmp_ne_u32 vcc, s16, v16
s_add_u32 s44, s44, 1
s_cbranch_vccz Lok_85
buffer_load_dword v16, v12, s[4:7], s28 offen sc1
s_waitcnt vmcnt(1)
v_cmp_ne_u32 vcc, s16, v23
s_add_u32 s44, s44, 1
s_cbranch_vccz Lok_85
buffer_load_dword v23, v12, s[4:7], s28 offen sc1
s_cmp_lt_u32 s44, 0x400000
s_cbranch_scc1 Lpoll_84
s_branch interleave_layers__softmax_full_mha__dense_activation_silu__prompt_kernel_abort
Lok_85:
buffer_load_dwordx4 v[24:27], v1, s[4:7], s24 offen offset:0
buffer_load_dwordx4 v[28:31], v1, s[4:7], s24 offen offset:1024
buffer_load_dwordx4 v[32:35], v1, s[4:7], s24 offen offset:2048
buffer_load_dwordx4 v[36:39], v1, s[4:7], s24 offen offset:3072
v_lshlrev_b32 v12, 11, v2
v_lshlrev_b32 v13, 4, v3
v_add_u32 v12, v12, v13
v_lshlrev_b32 v13, 30, v2
v_add_u32 v13, v12, v13
buffer_load_dwordx4 v[220:223], v12, s[4:7], s25 offen offset:0
buffer_load_dwordx4 v[224:227], v12, s[4:7], s25 offen offset:512
buffer_load_dwordx4 v[228:231], v12, s[4:7], s25 offen offset:1024
buffer_load_dwordx4 v[232:235], v13, s[4:7], s25 offen offset:1536
s_add_u32 s24, s24, 4096
buffer_load_dwordx4 v[40:43], v1, s[4:7], s24 offen offset:0
buffer_load_dwordx4 v[44:47], v1, s[4:7], s24 offen offset:1024
buffer_load_dwordx4 v[48:51], v1, s[4:7], s24 offen offset:2048
buffer_load_dwordx4 v[52:55], v1, s[4:7], s24 offen offset:3072
s_mul_i32 s27, s15, 8388608
s_add_u32 s27, s27, 33554432
s_mul_i32 s26, s19, 112
s_lshl_b32 s28, s13, 3
s_add_u32 s26, s26, s28
s_lshl_b32 s26, s26, 10
s_add_u32 s27, s27, s26
s_add_u32 s26, s27, 4096
v_add_u32 v12, 65536, v1
v_add_u32 v13, 94208, v1
v_add_u32 v15, 28672, v1
v_lshlrev_b32 v14, 4, v2
v_add_u32 v14, 160256, v14
ds_read_b128 v[168:171], v12 offset:0
ds_read_b128 v[172:175], v13 offset:0
ds_read_b128 v[176:179], v1 offset:0
ds_read_b128 v[180:183], v12 offset:1024
ds_read_b128 v[184:187], v13 offset:1024
ds_read_b128 v[188:191], v1 offset:1024
s_min_u32 s20, s13, 13
s_mul_i32 s20, s20, 114688
s_mul_i32 s21, s14, 7168
s_add_u32 s20, s20, s21
s_add_u32 s20, s20, 3756032
s_add_u32 s21, s21, 28672
s_add_u32 s24, s24, 4096
buffer_load_dwordx4 v[56:59], v1, s[4:7], s24 offen offset:0
s_mov_b32 m0, s21
s_nop 0
buffer_load_dwordx4 v1, s[4:7], s20 offen offset:0 lds
ds_read_b128 v[192:195], v12 offset:2048
ds_read_b128 v[196:199], v13 offset:2048
ds_read_b128 v[200:203], v1 offset:2048
s_waitcnt vmcnt(13)
s_waitcnt lgkmcnt(6)
v_mfma_f32_32x32x16_bf16 v[104:119], v[168:171], v[24:27], 0
v_mfma_f32_32x32x16_bf16 v[120:135], v[172:175], v[24:27], 0
v_mfma_f32_32x32x16_bf16 v[136:151], v[176:179], v[24:27], 0
buffer_load_dwordx4 v[60:63], v1, s[4:7], s24 offen offset:1024
buffer_load_dwordx4 v1, s[4:7], s20 offen offset:1024 lds
ds_read_b128 v[168:171], v12 offset:3072
ds_read_b128 v[172:175], v13 offset:3072
ds_read_b128 v[176:179], v1 offset:3072
s_waitcnt vmcnt(14)
s_waitcnt lgkmcnt(6)
v_mfma_f32_32x32x16_bf16 v[104:119], v[180:183], v[28:31], v[104:119]
v_mfma_f32_32x32x16_bf16 v[120:135], v[184:187], v[28:31], v[120:135]
v_mfma_f32_32x32x16_bf16 v[136:151], v[188:191], v[28:31], v[136:151]
buffer_load_dwordx4 v[64:67], v1, s[4:7], s24 offen offset:2048
buffer_load_dwordx4 v1, s[4:7], s20 offen offset:2048 lds
ds_read_b128 v[180:183], v12 offset:4096
ds_read_b128 v[184:187], v13 offset:4096
ds_read_b128 v[188:191], v1 offset:4096
s_waitcnt vmcnt(15)
s_waitcnt lgkmcnt(6)
v_mfma_f32_32x32x16_bf16 v[104:119], v[192:195], v[32:35], v[104:119]
v_mfma_f32_32x32x16_bf16 v[120:135], v[196:199], v[32:35], v[120:135]
v_mfma_f32_32x32x16_bf16 v[136:151], v[200:203], v[32:35], v[136:151]
buffer_load_dwordx4 v[68:71], v1, s[4:7], s24 offen offset:3072
buffer_load_dwordx4 v1, s[4:7], s20 offen offset:3072 lds
s_add_u32 s20, s20, 4096
s_add_u32 s21, s21, 4096
ds_read_b128 v[192:195], v12 offset:5120
ds_read_b128 v[196:199], v13 offset:5120
ds_read_b128 v[200:203], v1 offset:5120
s_waitcnt vmcnt(16)
s_waitcnt lgkmcnt(6)
v_mfma_f32_32x32x16_bf16 v[104:119], v[168:171], v[36:39], v[104:119]
v_mfma_f32_32x32x16_bf16 v[120:135], v[172:175], v[36:39], v[120:135]
v_mfma_f32_32x32x16_bf16 v[136:151], v[176:179], v[36:39], v[136:151]
s_add_u32 s24, s24, 4096
buffer_load_dwordx4 v[72:75], v1, s[4:7], s24 offen offset:0
s_mov_b32 m0, s21
s_nop 0
buffer_load_dwordx4 v1, s[4:7], s20 offen offset:0 lds
ds_read_b128 v[168:171], v12 offset:6144
ds_read_b128 v[172:175], v13 offset:6144
ds_read_b128 v[176:179], v1 offset:6144
s_waitcnt vmcnt(13)
s_waitcnt lgkmcnt(6)
v_mfma_f32_32x32x16_bf16 v[104:119], v[180:183], v[40:43], v[104:119]
v_add_f32 v220, v220, v222
v_mfma_f32_32x32x16_bf16 v[120:135], v[184:187], v[40:43], v[120:135]
v_add_f32 v221, v221, v223
v_mfma_f32_32x32x16_bf16 v[136:151], v[188:191], v[40:43], v[136:151]
v_add_f32 v220, v220, v224
buffer_load_dwordx4 v[76:79], v1, s[4:7], s24 offen offset:1024
buffer_load_dwordx4 v1, s[4:7], s20 offen offset:1024 lds
ds_read_b128 v[180:183], v12 offset:7168
ds_read_b128 v[184:187], v13 offset:7168
ds_read_b128 v[188:191], v1 offset:7168
s_waitcnt vmcnt(14)
s_waitcnt lgkmcnt(6)
v_mfma_f32_32x32x16_bf16 v[104:119], v[192:195], v[44:47], v[104:119]
v_add_f32 v221, v221, v225
v_mfma_f32_32x32x16_bf16 v[120:135], v[196:199], v[44:47], v[120:135]
v_add_f32 v220, v220, v226
v_mfma_f32_32x32x16_bf16 v[136:151], v[200:203], v[44:47], v[136:151]
v_add_f32 v221, v221, v227
buffer_load_dwordx4 v[80:83], v1, s[4:7], s24 offen offset:2048
buffer_load_dwordx4 v1, s[4:7], s20 offen offset:2048 lds
ds_read_b128 v[192:195], v12 offset:8192
ds_read_b128 v[196:199], v13 offset:8192
ds_read_b128 v[200:203], v1 offset:8192
s_waitcnt vmcnt(15)
s_waitcnt lgkmcnt(6)
v_mfma_f32_32x32x16_bf16 v[104:119], v[168:171], v[48:51], v[104:119]
v_add_f32 v220, v220, v228
v_mfma_f32_32x32x16_bf16 v[120:135], v[172:175], v[48:51], v[120:135]
v_add_f32 v221, v221, v229
v_mfma_f32_32x32x16_bf16 v[136:151], v[176:179], v[48:51], v[136:151]
v_add_f32 v220, v220, v230
buffer_load_dwordx4 v[84:87], v1, s[4:7], s24 offen offset:3072
ds_read_b128 v[168:171], v12 offset:9216
ds_read_b128 v[172:175], v13 offset:9216
ds_read_b128 v[176:179], v1 offset:9216
s_waitcnt vmcnt(15)
s_waitcnt lgkmcnt(6)
v_mfma_f32_32x32x16_bf16 v[104:119], v[180:183], v[52:55], v[104:119]
v_add_f32 v221, v221, v231
v_mfma_f32_32x32x16_bf16 v[120:135], v[184:187], v[52:55], v[120:135]
v_add_f32 v220, v220, v232
v_mfma_f32_32x32x16_bf16 v[136:151], v[188:191], v[52:55], v[136:151]
v_add_f32 v221, v221, v233
s_add_u32 s24, s24, 4096
buffer_load_dwordx4 v[88:91], v1, s[4:7], s24 offen offset:0
ds_read_b128 v[180:183], v12 offset:10240
ds_read_b128 v[184:187], v13 offset:10240
ds_read_b128 v[188:191], v1 offset:10240
s_waitcnt vmcnt(15)
s_waitcnt lgkmcnt(6)
v_mfma_f32_32x32x16_bf16 v[104:119], v[192:195], v[56:59], v[104:119]
v_add_f32 v220, v220, v234
v_mfma_f32_32x32x16_bf16 v[120:135], v[196:199], v[56:59], v[120:135]
v_add_f32 v221, v221, v235
v_mfma_f32_32x32x16_bf16 v[136:151], v[200:203], v[56:59], v[136:151]
v_mov_b32 v222, v220
buffer_load_dwordx4 v[92:95], v1, s[4:7], s24 offen offset:1024
ds_read_b128 v[192:195], v12 offset:11264
ds_read_b128 v[196:199], v13 offset:11264
ds_read_b128 v[200:203], v1 offset:11264
s_waitcnt vmcnt(14)
s_waitcnt lgkmcnt(6)
v_mfma_f32_32x32x16_bf16 v[104:119], v[168:171], v[60:63], v[104:119]
v_mov_b32 v223, v221
v_mfma_f32_32x32x16_bf16 v[120:135], v[172:175], v[60:63], v[120:135]
v_permlane32_swap_b32 v220, v222
v_mfma_f32_32x32x16_bf16 v[136:151], v[176:179], v[60:63], v[136:151]
v_permlane32_swap_b32 v221, v223
buffer_load_dwordx4 v[96:99], v1, s[4:7], s24 offen offset:2048
ds_read_b128 v[168:171], v12 offset:12288
ds_read_b128 v[172:175], v13 offset:12288
ds_read_b128 v[176:179], v1 offset:12288
s_waitcnt vmcnt(13)
s_waitcnt lgkmcnt(6)
v_mfma_f32_32x32x16_bf16 v[104:119], v[180:183], v[64:67], v[104:119]
v_add_f32 v220, v220, v222
v_mfma_f32_32x32x16_bf16 v[120:135], v[184:187], v[64:67], v[120:135]
v_add_f32 v221, v221, v223
v_mfma_f32_32x32x16_bf16 v[136:151], v[188:191], v[64:67], v[136:151]
v_mul_f32 v18, 0xbb124925, v220
buffer_load_dwordx4 v[100:103], v1, s[4:7], s24 offen offset:3072
ds_read_b128 v[180:183], v12 offset:13312
ds_read_b128 v[184:187], v13 offset:13312
ds_read_b128 v[188:191], v1 offset:13312
s_waitcnt vmcnt(12)
s_waitcnt lgkmcnt(6)
v_mfma_f32_32x32x16_bf16 v[104:119], v[192:195], v[68:71], v[104:119]
v_mul_f32 v221, 0x3b124925, v221
v_mfma_f32_32x32x16_bf16 v[120:135], v[196:199], v[68:71], v[120:135]
v_fma_f32 v221, -v18, v18, v221
v_mfma_f32_32x32x16_bf16 v[136:151], v[200:203], v[68:71], v[136:151]
v_max_f32 v221, 0, v221
s_add_u32 s24, s24, 4096
buffer_load_dwordx4 a[224:227], v1, s[4:7], s24 offen offset:0
ds_read_b128 v[192:195], v12 offset:14336
ds_read_b128 v[196:199], v13 offset:14336
ds_read_b128 v[200:203], v1 offset:14336
s_waitcnt vmcnt(11)
s_waitcnt lgkmcnt(6)
v_mfma_f32_32x32x16_bf16 v[104:119], v[168:171], v[72:75], v[104:119]
v_add_f32 v221, 0x3727c5ac, v221
v_mfma_f32_32x32x16_bf16 v[120:135], v[172:175], v[72:75], v[120:135]
v_rsq_f32 v19, v221
v_mfma_f32_32x32x16_bf16 v[136:151], v[176:179], v[72:75], v[136:151]
v_mul_f32 v20, v221, v19
buffer_load_dwordx4 a[228:231], v1, s[4:7], s24 offen offset:1024
ds_read_b128 v[168:171], v12 offset:15360
ds_read_b128 v[172:175], v13 offset:15360
ds_read_b128 v[176:179], v1 offset:15360
s_waitcnt vmcnt(10)
s_waitcnt lgkmcnt(6)
v_mfma_f32_32x32x16_bf16 v[104:119], v[180:183], v[76:79], v[104:119]
v_mul_f32 v22, 0xbfb8aa3b, v19
v_mfma_f32_32x32x16_bf16 v[120:135], v[184:187], v[76:79], v[120:135]
v_mfma_f32_32x32x16_bf16 v[136:151], v[188:191], v[76:79], v[136:151]
buffer_load_dwordx4 a[232:235], v1, s[4:7], s24 offen offset:2048
ds_read_b128 v[180:183], v12 offset:16384
ds_read_b128 v[184:187], v13 offset:16384
ds_read_b128 v[188:191], v1 offset:16384
s_waitcnt vmcnt(9)
s_waitcnt lgkmcnt(6)
v_mfma_f32_32x32x16_bf16 v[104:119], v[192:195], v[80:83], v[104:119]
v_mfma_f32_32x32x16_bf16 v[120:135], v[196:199], v[80:83], v[120:135]
v_mfma_f32_32x32x16_bf16 v[136:151], v[200:203], v[80:83], v[136:151]
buffer_load_dwordx4 a[236:239], v1, s[4:7], s24 offen offset:3072
ds_read_b128 v[192:195], v12 offset:17408
ds_read_b128 v[196:199], v13 offset:17408
ds_read_b128 v[200:203], v1 offset:17408
s_waitcnt vmcnt(8)
s_waitcnt lgkmcnt(6)
v_mfma_f32_32x32x16_bf16 v[104:119], v[168:171], v[84:87], v[104:119]
v_mfma_f32_32x32x16_bf16 v[120:135], v[172:175], v[84:87], v[120:135]
v_mfma_f32_32x32x16_bf16 v[136:151], v[176:179], v[84:87], v[136:151]
s_add_u32 s24, s24, 4096
buffer_load_dwordx4 a[240:243], v1, s[4:7], s24 offen offset:0
ds_read_b128 v[168:171], v12 offset:18432
ds_read_b128 v[172:175], v13 offset:18432
ds_read_b128 v[176:179], v1 offset:18432
s_waitcnt vmcnt(8)
s_waitcnt lgkmcnt(6)
v_mfma_f32_32x32x16_bf16 v[104:119], v[180:183], v[88:91], v[104:119]
v_mfma_f32_32x32x16_bf16 v[120:135], v[184:187], v[88:91], v[120:135]
v_mfma_f32_32x32x16_bf16 v[136:151], v[188:191], v[88:91], v[136:151]
buffer_load_dwordx4 a[244:247], v1, s[4:7], s24 offen offset:1024
ds_read_b128 v[180:183], v12 offset:19456
ds_read_b128 v[184:187], v13 offset:19456
ds_read_b128 v[188:191], v1 offset:19456
s_waitcnt vmcnt(8)
s_waitcnt lgkmcnt(6)
v_mfma_f32_32x32x16_bf16 v[104:119], v[192:195], v[92:95], v[104:119]
v_mfma_f32_32x32x16_bf16 v[120:135], v[196:199], v[92:95], v[120:135]
v_mfma_f32_32x32x16_bf16 v[136:151], v[200:203], v[92:95], v[136:151]
buffer_load_dwordx4 a[248:251], v1, s[4:7], s24 offen offset:2048
ds_read_b128 v[192:195], v12 offset:20480
ds_read_b128 v[196:199], v13 offset:20480
ds_read_b128 v[200:203], v1 offset:20480
s_waitcnt vmcnt(8)
s_waitcnt lgkmcnt(6)
v_mfma_f32_32x32x16_bf16 v[104:119], v[168:171], v[96:99], v[104:119]
v_mfma_f32_32x32x16_bf16 v[120:135], v[172:175], v[96:99], v[120:135]
v_mfma_f32_32x32x16_bf16 v[136:151], v[176:179], v[96:99], v[136:151]
buffer_load_dwordx4 a[252:255], v1, s[4:7], s24 offen offset:3072
ds_read_b128 v[168:171], v12 offset:21504
ds_read_b128 v[172:175], v13 offset:21504
ds_read_b128 v[176:179], v1 offset:21504
s_waitcnt vmcnt(8)
s_waitcnt lgkmcnt(6)
v_mfma_f32_32x32x16_bf16 v[104:119], v[180:183], v[100:103], v[104:119]
v_mfma_f32_32x32x16_bf16 v[120:135], v[184:187], v[100:103], v[120:135]
v_mfma_f32_32x32x16_bf16 v[136:151], v[188:191], v[100:103], v[136:151]
s_cmp_eq_u32 s15, 0
s_cselect_b32 s29, -1, 0
v_lshlrev_b32 v244, 7, v0
v_and_b32 v244, s29, v244
buffer_load_dword v16, v244, s[4:7], s27 offen sc1
ds_read_b128 v[180:183], v12 offset:22528
ds_read_b128 v[184:187], v13 offset:22528
ds_read_b128 v[188:191], v1 offset:22528
s_waitcnt vmcnt(8)
s_waitcnt lgkmcnt(6)
v_mfma_f32_32x32x16_bf16 v[104:119], v[192:195], a[224:227], v[104:119]
v_mfma_f32_32x32x16_bf16 v[120:135], v[196:199], a[224:227], v[120:135]
v_mfma_f32_32x32x16_bf16 v[136:151], v[200:203], a[224:227], v[136:151]
ds_read_b128 v[192:195], v12 offset:23552
ds_read_b128 v[196:199], v13 offset:23552
ds_read_b128 v[200:203], v1 offset:23552
s_waitcnt vmcnt(7)
s_waitcnt lgkmcnt(6)
v_mfma_f32_32x32x16_bf16 v[104:119], v[168:171], a[228:231], v[104:119]
v_mfma_f32_32x32x16_bf16 v[120:135], v[172:175], a[228:231], v[120:135]
v_mfma_f32_32x32x16_bf16 v[136:151], v[176:179], a[228:231], v[136:151]
ds_read_b128 v[168:171], v12 offset:24576
ds_read_b128 v[172:175], v13 offset:24576
ds_read_b128 v[176:179], v1 offset:24576
s_waitcnt vmcnt(6)
s_waitcnt lgkmcnt(6)
v_mfma_f32_32x32x16_bf16 v[104:119], v[180:183], a[232:235], v[104:119]
v_mfma_f32_32x32x16_bf16 v[120:135], v[184:187], a[232:235], v[120:135]
v_mfma_f32_32x32x16_bf16 v[136:151], v[188:191], a[232:235], v[136:151]
ds_read_b128 v[180:183], v12 offset:25600
ds_read_b128 v[184:187], v13 offset:25600
ds_read_b128 v[188:191], v1 offset:25600
s_waitcnt vmcnt(5)
s_waitcnt lgkmcnt(6)
v_mfma_f32_32x32x16_bf16 v[104:119], v[192:195], a[236:239], v[104:119]
v_mfma_f32_32x32x16_bf16 v[120:135], v[196:199], a[236:239], v[120:135]
v_mfma_f32_32x32x16_bf16 v[136:151], v[200:203], a[236:239], v[136:151]
ds_read_b128 v[192:195], v12 offset:26624
ds_read_b128 v[196:199], v13 offset:26624
ds_read_b128 v[200:203], v1 offset:26624
s_waitcnt vmcnt(4)
s_waitcnt lgkmcnt(6)
v_mfma_f32_32x32x16_bf16 v[104:119], v[168:171], a[240:243], v[104:119]
v_mfma_f32_32x32x16_bf16 v[120:135], v[172:175], a[240:243], v[120:135]
v_mfma_f32_32x32x16_bf16 v[136:151], v[176:179], a[240:243], v[136:151]
ds_read_b128 v[168:171], v12 offset:27648
ds_read_b128 v[172:175], v13 offset:27648
ds_read_b128 v[176:179], v1 offset:27648
s_waitcnt vmcnt(3)
s_waitcnt lgkmcnt(6)
v_mfma_f32_32x32x16_bf16 v[104:119], v[180:183], a[244:247], v[104:119]
v_mfma_f32_32x32x16_bf16 v[120:135], v[184:187], a[244:247], v[120:135]
v_mfma_f32_32x32x16_bf16 v[136:151], v[188:191], a[244:247], v[136:151]
s_waitcnt vmcnt(2)
s_waitcnt lgkmcnt(3)
v_mfma_f32_32x32x16_bf16 v[104:119], v[192:195], a[248:251], v[104:119]
v_mfma_f32_32x32x16_bf16 v[120:135], v[196:199], a[248:251], v[120:135]
v_mfma_f32_32x32x16_bf16 v[136:151], v[200:203], a[248:251], v[136:151]
s_waitcnt vmcnt(1)
s_waitcnt lgkmcnt(0)
v_mfma_f32_32x32x16_bf16 v[104:119], v[168:171], a[252:255], v[104:119]
v_mfma_f32_32x32x16_bf16 v[120:135], v[172:175], a[252:255], v[120:135]
v_mfma_f32_32x32x16_bf16 v[136:151], v[176:179], a[252:255], v[136:151]
ds_read_b128 v[204:207], v14 offset:0
ds_read_b128 v[208:211], v14 offset:32
ds_read_b128 v[212:215], v14 offset:64
ds_read_b128 v[216:219], v14 offset:96
ds_read_b128 v[220:223], v14 offset:128
ds_read_b128 v[224:227], v14 offset:160
ds_read_b128 v[228:231], v14 offset:192
ds_read_b128 v[232:235], v14 offset:224
s_barrier
s_cmp_eq_u32 s15, 0
s_cbranch_scc1 Lb0_86
ds_read_b128 v[168:171], v15 offset:0
ds_read_b128 v[172:175], v15 offset:1024
ds_read_b128 v[176:179], v15 offset:2048
ds_read_b128 v[180:183], v15 offset:3072
s_waitcnt lgkmcnt(3)
v_mfma_f32_32x32x16_bf16 v[152:167], v[168:171], v[24:27], 0
v_pk_fma_f32 v[104:105], v[18:19], v[204:205], v[104:105] op_sel_hi:[0,1,1]
v_pk_fma_f32 v[106:107], v[18:19], v[206:207], v[106:107] op_sel_hi:[0,1,1]
v_pk_mul_f32 v[244:245], v[22:23], v[104:105] op_sel_hi:[0,1]
v_pk_mul_f32 v[246:247], v[22:23], v[106:107] op_sel_hi:[0,1]
v_exp_f32 v244, v244
v_exp_f32 v245, v245
ds_read_b128 v[168:171], v15 offset:4096
s_waitcnt lgkmcnt(3)
v_mfma_f32_32x32x16_bf16 v[152:167], v[172:175], v[28:31], v[152:167]
v_exp_f32 v246, v246
v_exp_f32 v247, v247
v_pk_fma_f32 v[244:245], v[244:245], v[20:21], v[20:21] op_sel_hi:[1,0,0]
v_pk_fma_f32 v[246:247], v[246:247], v[20:21], v[20:21] op_sel_hi:[1,0,0]
v_rcp_f32 v244, v244
v_rcp_f32 v245, v245
ds_read_b128 v[172:175], v15 offset:5120
s_waitcnt lgkmcnt(3)
v_mfma_f32_32x32x16_bf16 v[152:167], v[176:179], v[32:35], v[152:167]
v_rcp_f32 v246, v246
v_rcp_f32 v247, v247
v_pk_mul_f32 v[104:105], v[104:105], v[244:245]
v_pk_mul_f32 v[106:107], v[106:107], v[246:247]
v_cvt_pk_bf16_f32 v236, v104, v105
v_cvt_pk_bf16_f32 v237, v106, v107
ds_read_b128 v[176:179], v15 offset:6144
s_waitcnt lgkmcnt(3)
v_mfma_f32_32x32x16_bf16 v[152:167], v[180:183], v[36:39], v[152:167]
v_pk_fma_f32 v[108:109], v[18:19], v[208:209], v[108:109] op_sel_hi:[0,1,1]
v_pk_fma_f32 v[110:111], v[18:19], v[210:211], v[110:111] op_sel_hi:[0,1,1]
v_pk_mul_f32 v[248:249], v[22:23], v[108:109] op_sel_hi:[0,1]
v_pk_mul_f32 v[250:251], v[22:23], v[110:111] op_sel_hi:[0,1]
v_exp_f32 v248, v248
v_exp_f32 v249, v249
ds_read_b128 v[180:183], v15 offset:7168
s_waitcnt lgkmcnt(3)
v_mfma_f32_32x32x16_bf16 v[152:167], v[168:171], v[40:43], v[152:167]
v_exp_f32 v250, v250
v_exp_f32 v251, v251
v_pk_fma_f32 v[248:249], v[248:249], v[20:21], v[20:21] op_sel_hi:[1,0,0]
v_pk_fma_f32 v[250:251], v[250:251], v[20:21], v[20:21] op_sel_hi:[1,0,0]
v_rcp_f32 v248, v248
v_rcp_f32 v249, v249
ds_read_b128 v[168:171], v15 offset:8192
s_waitcnt lgkmcnt(3)
v_mfma_f32_32x32x16_bf16 v[152:167], v[172:175], v[44:47], v[152:167]
v_rcp_f32 v250, v250
v_rcp_f32 v251, v251
v_pk_mul_f32 v[108:109], v[108:109], v[248:249]
v_pk_mul_f32 v[110:111], v[110:111], v[250:251]
v_cvt_pk_bf16_f32 v238, v108, v109
v_cvt_pk_bf16_f32 v239, v110, v111
ds_read_b128 v[172:175], v15 offset:9216
s_waitcnt lgkmcnt(3)
v_mfma_f32_32x32x16_bf16 v[152:167], v[176:179], v[48:51], v[152:167]
v_pk_fma_f32 v[112:113], v[18:19], v[212:213], v[112:113] op_sel_hi:[0,1,1]
v_pk_fma_f32 v[114:115], v[18:19], v[214:215], v[114:115] op_sel_hi:[0,1,1]
v_pk_mul_f32 v[244:245], v[22:23], v[112:113] op_sel_hi:[0,1]
v_pk_mul_f32 v[246:247], v[22:23], v[114:115] op_sel_hi:[0,1]
v_exp_f32 v244, v244
v_exp_f32 v245, v245
ds_read_b128 v[176:179], v15 offset:10240
s_waitcnt lgkmcnt(3)
v_mfma_f32_32x32x16_bf16 v[152:167], v[180:183], v[52:55], v[152:167]
v_exp_f32 v246, v246
v_exp_f32 v247, v247
v_pk_fma_f32 v[244:245], v[244:245], v[20:21], v[20:21] op_sel_hi:[1,0,0]
v_pk_fma_f32 v[246:247], v[246:247], v[20:21], v[20:21] op_sel_hi:[1,0,0]
v_rcp_f32 v244, v244
v_rcp_f32 v245, v245
ds_read_b128 v[180:183], v15 offset:11264
s_waitcnt lgkmcnt(3)
v_mfma_f32_32x32x16_bf16 v[152:167], v[168:171], v[56:59], v[152:167]
v_rcp_f32 v246, v246
v_rcp_f32 v247, v247
v_pk_mul_f32 v[112:113], v[112:113], v[244:245]
v_pk_mul_f32 v[114:115], v[114:115], v[246:247]
v_cvt_pk_bf16_f32 v240, v112, v113
v_cvt_pk_bf16_f32 v241, v114, v115
ds_read_b128 v[168:171], v15 offset:12288
s_waitcnt lgkmcnt(3)
v_mfma_f32_32x32x16_bf16 v[152:167], v[172:175], v[60:63], v[152:167]
v_pk_fma_f32 v[116:117], v[18:19], v[216:217], v[116:117] op_sel_hi:[0,1,1]
v_pk_fma_f32 v[118:119], v[18:19], v[218:219], v[118:119] op_sel_hi:[0,1,1]
v_pk_mul_f32 v[248:249], v[22:23], v[116:117] op_sel_hi:[0,1]
v_pk_mul_f32 v[250:251], v[22:23], v[118:119] op_sel_hi:[0,1]
v_exp_f32 v248, v248
v_exp_f32 v249, v249
ds_read_b128 v[172:175], v15 offset:13312
s_waitcnt lgkmcnt(3)
v_mfma_f32_32x32x16_bf16 v[152:167], v[176:179], v[64:67], v[152:167]
v_exp_f32 v250, v250
v_exp_f32 v251, v251
v_pk_fma_f32 v[248:249], v[248:249], v[20:21], v[20:21] op_sel_hi:[1,0,0]
v_pk_fma_f32 v[250:251], v[250:251], v[20:21], v[20:21] op_sel_hi:[1,0,0]
v_rcp_f32 v248, v248
v_rcp_f32 v249, v249
ds_read_b128 v[176:179], v15 offset:14336
s_waitcnt lgkmcnt(3)
v_mfma_f32_32x32x16_bf16 v[152:167], v[180:183], v[68:71], v[152:167]
v_rcp_f32 v250, v250
v_rcp_f32 v251, v251
v_pk_mul_f32 v[116:117], v[116:117], v[248:249]
v_pk_mul_f32 v[118:119], v[118:119], v[250:251]
v_cvt_pk_bf16_f32 v242, v116, v117
v_cvt_pk_bf16_f32 v243, v118, v119
ds_read_b128 v[180:183], v15 offset:15360
s_waitcnt lgkmcnt(3)
v_mfma_f32_32x32x16_bf16 v[152:167], v[168:171], v[72:75], v[152:167]
buffer_store_dwordx4 v[236:239], v1, s[4:7], s27 offen offset:0 sc1
buffer_store_dwordx4 v[240:243], v1, s[4:7], s27 offen offset:1024 sc1
ds_read_b128 v[204:207], v14 offset:256
ds_read_b128 v[208:211], v14 offset:288
ds_read_b128 v[212:215], v14 offset:320
ds_read_b128 v[216:219], v14 offset:352
v_pk_fma_f32 v[120:121], v[18:19], v[220:221], v[120:121] op_sel_hi:[0,1,1]
v_pk_fma_f32 v[122:123], v[18:19], v[222:223], v[122:123] op_sel_hi:[0,1,1]
v_pk_mul_f32 v[244:245], v[22:23], v[120:121] op_sel_hi:[0,1]
v_pk_mul_f32 v[246:247], v[22:23], v[122:123] op_sel_hi:[0,1]
v_exp_f32 v244, v244
v_exp_f32 v245, v245
ds_read_b128 v[168:171], v15 offset:16384
s_waitcnt lgkmcnt(7)
v_mfma_f32_32x32x16_bf16 v[152:167], v[172:175], v[76:79], v[152:167]
v_exp_f32 v246, v246
v_exp_f32 v247, v247
v_pk_fma_f32 v[244:245], v[244:245], v[20:21], v[20:21] op_sel_hi:[1,0,0]
v_pk_fma_f32 v[246:247], v[246:247], v[20:21], v[20:21] op_sel_hi:[1,0,0]
v_rcp_f32 v244, v244
v_rcp_f32 v245, v245
ds_read_b128 v[172:175], v15 offset:17408
s_waitcnt lgkmcnt(7)
v_mfma_f32_32x32x16_bf16 v[152:167], v[176:179], v[80:83], v[152:167]
v_rcp_f32 v246, v246
v_rcp_f32 v247, v247
v_pk_mul_f32 v[120:121], v[120:121], v[244:245]
v_pk_mul_f32 v[122:123], v[122:123], v[246:247]
v_cvt_pk_bf16_f32 v236, v120, v121
v_cvt_pk_bf16_f32 v237, v122, v123
ds_read_b128 v[176:179], v15 offset:18432
s_waitcnt lgkmcnt(7)
v_mfma_f32_32x32x16_bf16 v[152:167], v[180:183], v[84:87], v[152:167]
v_pk_fma_f32 v[124:125], v[18:19], v[224:225], v[124:125] op_sel_hi:[0,1,1]
v_pk_fma_f32 v[126:127], v[18:19], v[226:227], v[126:127] op_sel_hi:[0,1,1]
v_pk_mul_f32 v[248:249], v[22:23], v[124:125] op_sel_hi:[0,1]
v_pk_mul_f32 v[250:251], v[22:23], v[126:127] op_sel_hi:[0,1]
v_exp_f32 v248, v248
v_exp_f32 v249, v249
ds_read_b128 v[180:183], v15 offset:19456
s_waitcnt lgkmcnt(3)
v_mfma_f32_32x32x16_bf16 v[152:167], v[168:171], v[88:91], v[152:167]
v_exp_f32 v250, v250
v_exp_f32 v251, v251
v_pk_fma_f32 v[248:249], v[248:249], v[20:21], v[20:21] op_sel_hi:[1,0,0]
v_pk_fma_f32 v[250:251], v[250:251], v[20:21], v[20:21] op_sel_hi:[1,0,0]
v_rcp_f32 v248, v248
v_rcp_f32 v249, v249
ds_read_b128 v[168:171], v15 offset:20480
s_waitcnt lgkmcnt(3)
v_mfma_f32_32x32x16_bf16 v[152:167], v[172:175], v[92:95], v[152:167]
v_rcp_f32 v250, v250
v_rcp_f32 v251, v251
v_pk_mul_f32 v[124:125], v[124:125], v[248:249]
v_pk_mul_f32 v[126:127], v[126:127], v[250:251]
v_cvt_pk_bf16_f32 v238, v124, v125
v_cvt_pk_bf16_f32 v239, v126, v127
ds_read_b128 v[172:175], v15 offset:21504
s_waitcnt lgkmcnt(3)
v_mfma_f32_32x32x16_bf16 v[152:167], v[176:179], v[96:99], v[152:167]
v_pk_fma_f32 v[128:129], v[18:19], v[228:229], v[128:129] op_sel_hi:[0,1,1]
v_pk_fma_f32 v[130:131], v[18:19], v[230:231], v[130:131] op_sel_hi:[0,1,1]
v_pk_mul_f32 v[244:245], v[22:23], v[128:129] op_sel_hi:[0,1]
v_pk_mul_f32 v[246:247], v[22:23], v[130:131] op_sel_hi:[0,1]
v_exp_f32 v244, v244
v_exp_f32 v245, v245
ds_read_b128 v[176:179], v15 offset:22528
s_waitcnt lgkmcnt(3)
v_mfma_f32_32x32x16_bf16 v[152:167], v[180:183], v[100:103], v[152:167]
v_exp_f32 v246, v246
v_exp_f32 v247, v247
v_pk_fma_f32 v[244:245], v[244:245], v[20:21], v[20:21] op_sel_hi:[1,0,0]
v_pk_fma_f32 v[246:247], v[246:247], v[20:21], v[20:21] op_sel_hi:[1,0,0]
v_rcp_f32 v244, v244
v_rcp_f32 v245, v245
ds_read_b128 v[180:183], v15 offset:23552
s_waitcnt lgkmcnt(3)
v_mfma_f32_32x32x16_bf16 v[152:167], v[168:171], a[224:227], v[152:167]
v_rcp_f32 v246, v246
v_rcp_f32 v247, v247
v_pk_mul_f32 v[128:129], v[128:129], v[244:245]
v_pk_mul_f32 v[130:131], v[130:131], v[246:247]
v_cvt_pk_bf16_f32 v240, v128, v129
v_cvt_pk_bf16_f32 v241, v130, v131
ds_read_b128 v[168:171], v15 offset:24576
s_waitcnt lgkmcnt(3)
v_mfma_f32_32x32x16_bf16 v[152:167], v[172:175], a[228:231], v[152:167]
v_pk_fma_f32 v[132:133], v[18:19], v[232:233], v[132:133] op_sel_hi:[0,1,1]
v_pk_fma_f32 v[134:135], v[18:19], v[234:235], v[134:135] op_sel_hi:[0,1,1]
v_pk_mul_f32 v[248:249], v[22:23], v[132:133] op_sel_hi:[0,1]
v_pk_mul_f32 v[250:251], v[22:23], v[134:135] op_sel_hi:[0,1]
v_exp_f32 v248, v248
v_exp_f32 v249, v249
ds_read_b128 v[172:175], v15 offset:25600
s_waitcnt lgkmcnt(3)
v_mfma_f32_32x32x16_bf16 v[152:167], v[176:179], a[232:235], v[152:167]
v_exp_f32 v250, v250
v_exp_f32 v251, v251
v_pk_fma_f32 v[248:249], v[248:249], v[20:21], v[20:21] op_sel_hi:[1,0,0]
v_pk_fma_f32 v[250:251], v[250:251], v[20:21], v[20:21] op_sel_hi:[1,0,0]
v_rcp_f32 v248, v248
v_rcp_f32 v249, v249
ds_read_b128 v[176:179], v15 offset:26624
s_waitcnt lgkmcnt(3)
v_mfma_f32_32x32x16_bf16 v[152:167], v[180:183], a[236:239], v[152:167]
v_rcp_f32 v250, v250
v_rcp_f32 v251, v251
v_pk_mul_f32 v[132:133], v[132:133], v[248:249]
v_pk_mul_f32 v[134:135], v[134:135], v[250:251]
v_cvt_pk_bf16_f32 v242, v132, v133
v_cvt_pk_bf16_f32 v243, v134, v135
ds_read_b128 v[180:183], v15 offset:27648
s_waitcnt lgkmcnt(3)
v_mfma_f32_32x32x16_bf16 v[152:167], v[168:171], a[240:243], v[152:167]
buffer_store_dwordx4 v[236:239], v1, s[4:7], s27 offen offset:2048 sc1
buffer_store_dwordx4 v[240:243], v1, s[4:7], s27 offen offset:3072 sc1
ds_read_b128 v[220:223], v14 offset:384
ds_read_b128 v[224:227], v14 offset:416
ds_read_b128 v[228:231], v14 offset:448
ds_read_b128 v[232:235], v14 offset:480
v_pk_fma_f32 v[136:137], v[18:19], v[204:205], v[136:137] op_sel_hi:[0,1,1]
v_pk_fma_f32 v[138:139], v[18:19], v[206:207], v[138:139] op_sel_hi:[0,1,1]
v_pk_mul_f32 v[244:245], v[22:23], v[136:137] op_sel_hi:[0,1]
v_pk_mul_f32 v[246:247], v[22:23], v[138:139] op_sel_hi:[0,1]
v_exp_f32 v244, v244
v_exp_f32 v245, v245
s_waitcnt lgkmcnt(6)
v_mfma_f32_32x32x16_bf16 v[152:167], v[172:175], a[244:247], v[152:167]
v_exp_f32 v246, v246
v_exp_f32 v247, v247
v_pk_fma_f32 v[244:245], v[244:245], v[20:21], v[20:21] op_sel_hi:[1,0,0]
v_pk_fma_f32 v[246:247], v[246:247], v[20:21], v[20:21] op_sel_hi:[1,0,0]
v_rcp_f32 v244, v244
v_rcp_f32 v245, v245
s_waitcnt lgkmcnt(5)
v_mfma_f32_32x32x16_bf16 v[152:167], v[176:179], a[248:251], v[152:167]
v_rcp_f32 v246, v246
v_rcp_f32 v247, v247
v_pk_mul_f32 v[136:137], v[136:137], v[244:245]
v_pk_mul_f32 v[138:139], v[138:139], v[246:247]
v_cvt_pk_bf16_f32 v236, v136, v137
v_cvt_pk_bf16_f32 v237, v138, v139
s_waitcnt lgkmcnt(4)
v_mfma_f32_32x32x16_bf16 v[152:167], v[180:183], a[252:255], v[152:167]
v_pk_fma_f32 v[140:141], v[18:19], v[208:209], v[140:141] op_sel_hi:[0,1,1]
v_pk_fma_f32 v[142:143], v[18:19], v[210:211], v[142:143] op_sel_hi:[0,1,1]
v_pk_mul_f32 v[248:249], v[22:23], v[140:141] op_sel_hi:[0,1]
v_pk_mul_f32 v[250:251], v[22:23], v[142:143] op_sel_hi:[0,1]
v_exp_f32 v248, v248
v_exp_f32 v249, v249
v_exp_f32 v250, v250
v_exp_f32 v251, v251
v_pk_fma_f32 v[248:249], v[248:249], v[20:21], v[20:21] op_sel_hi:[1,0,0]
v_pk_fma_f32 v[250:251], v[250:251], v[20:21], v[20:21] op_sel_hi:[1,0,0]
v_rcp_f32 v248, v248
v_rcp_f32 v249, v249
v_rcp_f32 v250, v250
v_rcp_f32 v251, v251
v_pk_mul_f32 v[140:141], v[140:141], v[248:249]
v_pk_mul_f32 v[142:143], v[142:143], v[250:251]
v_cvt_pk_bf16_f32 v238, v140, v141
v_cvt_pk_bf16_f32 v239, v142, v143
v_pk_fma_f32 v[144:145], v[18:19], v[212:213], v[144:145] op_sel_hi:[0,1,1]
v_pk_fma_f32 v[146:147], v[18:19], v[214:215], v[146:147] op_sel_hi:[0,1,1]
v_pk_mul_f32 v[244:245], v[22:23], v[144:145] op_sel_hi:[0,1]
v_pk_mul_f32 v[246:247], v[22:23], v[146:147] op_sel_hi:[0,1]
v_exp_f32 v244, v244
v_exp_f32 v245, v245
v_exp_f32 v246, v246
v_exp_f32 v247, v247
v_pk_fma_f32 v[244:245], v[244:245], v[20:21], v[20:21] op_sel_hi:[1,0,0]
v_pk_fma_f32 v[246:247], v[246:247], v[20:21], v[20:21] op_sel_hi:[1,0,0]
v_rcp_f32 v244, v244
v_rcp_f32 v245, v245
v_rcp_f32 v246, v246
v_rcp_f32 v247, v247
v_pk_mul_f32 v[144:145], v[144:145], v[244:245]
v_pk_mul_f32 v[146:147], v[146:147], v[246:247]
v_cvt_pk_bf16_f32 v240, v144, v145
v_cvt_pk_bf16_f32 v241, v146, v147
v_pk_fma_f32 v[148:149], v[18:19], v[216:217], v[148:149] op_sel_hi:[0,1,1]
v_pk_fma_f32 v[150:151], v[18:19], v[218:219], v[150:151] op_sel_hi:[0,1,1]
v_pk_mul_f32 v[248:249], v[22:23], v[148:149] op_sel_hi:[0,1]
v_pk_mul_f32 v[250:251], v[22:23], v[150:151] op_sel_hi:[0,1]
v_exp_f32 v248, v248
v_exp_f32 v249, v249
v_exp_f32 v250, v250
v_exp_f32 v251, v251
v_pk_fma_f32 v[248:249], v[248:249], v[20:21], v[20:21] op_sel_hi:[1,0,0]
v_pk_fma_f32 v[250:251], v[250:251], v[20:21], v[20:21] op_sel_hi:[1,0,0]
v_rcp_f32 v248, v248
v_rcp_f32 v249, v249
v_rcp_f32 v250, v250
v_rcp_f32 v251, v251
v_pk_mul_f32 v[148:149], v[148:149], v[248:249]
v_pk_mul_f32 v[150:151], v[150:151], v[250:251]
v_cvt_pk_bf16_f32 v242, v148, v149
v_cvt_pk_bf16_f32 v243, v150, v151
buffer_store_dwordx4 v[236:239], v1, s[4:7], s26 offen offset:0 sc1
buffer_store_dwordx4 v[240:243], v1, s[4:7], s26 offen offset:1024 sc1
s_waitcnt lgkmcnt(0)
v_pk_fma_f32 v[152:153], v[18:19], v[220:221], v[152:153] op_sel_hi:[0,1,1]
v_pk_fma_f32 v[154:155], v[18:19], v[222:223], v[154:155] op_sel_hi:[0,1,1]
v_pk_mul_f32 v[244:245], v[22:23], v[152:153] op_sel_hi:[0,1]
v_pk_mul_f32 v[246:247], v[22:23], v[154:155] op_sel_hi:[0,1]
v_exp_f32 v244, v244
v_exp_f32 v245, v245
v_exp_f32 v246, v246
v_exp_f32 v247, v247
v_pk_fma_f32 v[244:245], v[244:245], v[20:21], v[20:21] op_sel_hi:[1,0,0]
v_pk_fma_f32 v[246:247], v[246:247], v[20:21], v[20:21] op_sel_hi:[1,0,0]
v_rcp_f32 v244, v244
v_rcp_f32 v245, v245
v_rcp_f32 v246, v246
v_rcp_f32 v247, v247
v_pk_mul_f32 v[152:153], v[152:153], v[244:245]
v_pk_mul_f32 v[154:155], v[154:155], v[246:247]
v_cvt_pk_bf16_f32 v236, v152, v153
v_cvt_pk_bf16_f32 v237, v154, v155
v_pk_fma_f32 v[156:157], v[18:19], v[224:225], v[156:157] op_sel_hi:[0,1,1]
v_pk_fma_f32 v[158:159], v[18:19], v[226:227], v[158:159] op_sel_hi:[0,1,1]
v_pk_mul_f32 v[248:249], v[22:23], v[156:157] op_sel_hi:[0,1]
v_pk_mul_f32 v[250:251], v[22:23], v[158:159] op_sel_hi:[0,1]
v_exp_f32 v248, v248
v_exp_f32 v249, v249
v_exp_f32 v250, v250
v_exp_f32 v251, v251
v_pk_fma_f32 v[248:249], v[248:249], v[20:21], v[20:21] op_sel_hi:[1,0,0]
v_pk_fma_f32 v[250:251], v[250:251], v[20:21], v[20:21] op_sel_hi:[1,0,0]
v_rcp_f32 v248, v248
v_rcp_f32 v249, v249
v_rcp_f32 v250, v250
v_rcp_f32 v251, v251
v_pk_mul_f32 v[156:157], v[156:157], v[248:249]
v_pk_mul_f32 v[158:159], v[158:159], v[250:251]
v_cvt_pk_bf16_f32 v238, v156, v157
v_cvt_pk_bf16_f32 v239, v158, v159
v_pk_fma_f32 v[160:161], v[18:19], v[228:229], v[160:161] op_sel_hi:[0,1,1]
v_pk_fma_f32 v[162:163], v[18:19], v[230:231], v[162:163] op_sel_hi:[0,1,1]
v_pk_mul_f32 v[244:245], v[22:23], v[160:161] op_sel_hi:[0,1]
v_pk_mul_f32 v[246:247], v[22:23], v[162:163] op_sel_hi:[0,1]
v_exp_f32 v244, v244
v_exp_f32 v245, v245
v_exp_f32 v246, v246
v_exp_f32 v247, v247
v_pk_fma_f32 v[244:245], v[244:245], v[20:21], v[20:21] op_sel_hi:[1,0,0]
v_pk_fma_f32 v[246:247], v[246:247], v[20:21], v[20:21] op_sel_hi:[1,0,0]
v_rcp_f32 v244, v244
v_rcp_f32 v245, v245
v_rcp_f32 v246, v246
v_rcp_f32 v247, v247
v_pk_mul_f32 v[160:161], v[160:161], v[244:245]
v_pk_mul_f32 v[162:163], v[162:163], v[246:247]
v_cvt_pk_bf16_f32 v240, v160, v161
v_cvt_pk_bf16_f32 v241, v162, v163
v_pk_fma_f32 v[164:165], v[18:19], v[232:233], v[164:165] op_sel_hi:[0,1,1]
v_pk_fma_f32 v[166:167], v[18:19], v[234:235], v[166:167] op_sel_hi:[0,1,1]
v_pk_mul_f32 v[248:249], v[22:23], v[164:165] op_sel_hi:[0,1]
v_pk_mul_f32 v[250:251], v[22:23], v[166:167] op_sel_hi:[0,1]
v_exp_f32 v248, v248
v_exp_f32 v249, v249
v_exp_f32 v250, v250
v_exp_f32 v251, v251
v_pk_fma_f32 v[248:249], v[248:249], v[20:21], v[20:21] op_sel_hi:[1,0,0]
v_pk_fma_f32 v[250:251], v[250:251], v[20:21], v[20:21] op_sel_hi:[1,0,0]
v_rcp_f32 v248, v248
v_rcp_f32 v249, v249
v_rcp_f32 v250, v250
v_rcp_f32 v251, v251
v_pk_mul_f32 v[164:165], v[164:165], v[248:249]
v_pk_mul_f32 v[166:167], v[166:167], v[250:251]
v_cvt_pk_bf16_f32 v242, v164, v165
v_cvt_pk_bf16_f32 v243, v166, v167
buffer_store_dwordx4 v[236:239], v1, s[4:7], s26 offen offset:2048 sc1
buffer_store_dwordx4 v[240:243], v1, s[4:7], s26 offen offset:3072 sc1
s_branch Lb1_87
Lb0_86:
s_lshl_b32 s20, s18, 2
s_add_u32 s20, s20, s14
s_mul_i32 s20, s20, 57344
s_add_u32 s20, s20, 6291456
s_and_b32 s21, s14, 1
s_lshl_b32 s21, s21, 10
v_add_u32 v12, s21, v1
s_xor_b32 s21, s21, 1024
v_add_u32 v13, s21, v1
ds_read_b128 v[168:171], v15 offset:0
ds_read_b128 v[172:175], v15 offset:1024
ds_read_b128 v[176:179], v15 offset:2048
ds_read_b128 v[180:183], v15 offset:3072
buffer_load_dwordx4 a[0:3], v12, s[4:7], s20 offen offset:0
buffer_load_dwordx4 a[4:7], v13, s[4:7], s20 offen offset:0
s_waitcnt lgkmcnt(3)
v_mfma_f32_32x32x16_bf16 v[152:167], v[168:171], v[24:27], 0
v_pk_fma_f32 v[104:105], v[18:19], v[204:205], v[104:105] op_sel_hi:[0,1,1]
v_pk_fma_f32 v[106:107], v[18:19], v[206:207], v[106:107] op_sel_hi:[0,1,1]
v_pk_mul_f32 v[244:245], v[22:23], v[104:105] op_sel_hi:[0,1]
v_pk_mul_f32 v[246:247], v[22:23], v[106:107] op_sel_hi:[0,1]
v_exp_f32 v244, v244
v_exp_f32 v245, v245
ds_read_b128 v[168:171], v15 offset:4096
buffer_load_dwordx4 a[8:11], v12, s[4:7], s20 offen offset:2048
buffer_load_dwordx4 a[12:15], v13, s[4:7], s20 offen offset:2048
s_waitcnt lgkmcnt(3)
v_mfma_f32_32x32x16_bf16 v[152:167], v[172:175], v[28:31], v[152:167]
v_exp_f32 v246, v246
v_exp_f32 v247, v247
v_pk_fma_f32 v[244:245], v[244:245], v[20:21], v[20:21] op_sel_hi:[1,0,0]
v_pk_fma_f32 v[246:247], v[246:247], v[20:21], v[20:21] op_sel_hi:[1,0,0]
v_rcp_f32 v244, v244
v_rcp_f32 v245, v245
ds_read_b128 v[172:175], v15 offset:5120
s_add_u32 s20, s20, 4096
buffer_load_dwordx4 a[16:19], v12, s[4:7], s20 offen offset:0
buffer_load_dwordx4 a[20:23], v13, s[4:7], s20 offen offset:0
s_waitcnt lgkmcnt(3)
v_mfma_f32_32x32x16_bf16 v[152:167], v[176:179], v[32:35], v[152:167]
v_rcp_f32 v246, v246
v_rcp_f32 v247, v247
v_pk_mul_f32 v[104:105], v[104:105], v[244:245]
v_pk_mul_f32 v[106:107], v[106:107], v[246:247]
v_cvt_pk_bf16_f32 v236, v104, v105
v_cvt_pk_bf16_f32 v237, v106, v107
ds_read_b128 v[176:179], v15 offset:6144
buffer_load_dwordx4 a[24:27], v12, s[4:7], s20 offen offset:2048
buffer_load_dwordx4 a[28:31], v13, s[4:7], s20 offen offset:2048
s_waitcnt lgkmcnt(3)
v_mfma_f32_32x32x16_bf16 v[152:167], v[180:183], v[36:39], v[152:167]
v_pk_fma_f32 v[108:109], v[18:19], v[208:209], v[108:109] op_sel_hi:[0,1,1]
v_pk_fma_f32 v[110:111], v[18:19], v[210:211], v[110:111] op_sel_hi:[0,1,1]
v_pk_mul_f32 v[248:249], v[22:23], v[108:109] op_sel_hi:[0,1]
v_pk_mul_f32 v[250:251], v[22:23], v[110:111] op_sel_hi:[0,1]
v_exp_f32 v248, v248
v_exp_f32 v249, v249
ds_read_b128 v[180:183], v15 offset:7168
s_add_u32 s20, s20, 4096
buffer_load_dwordx4 a[32:35], v12, s[4:7], s20 offen offset:0
buffer_load_dwordx4 a[36:39], v13, s[4:7], s20 offen offset:0
s_waitcnt lgkmcnt(3)
v_mfma_f32_32x32x16_bf16 v[152:167], v[168:171], v[40:43], v[152:167]
v_exp_f32 v250, v250
v_exp_f32 v251, v251
v_pk_fma_f32 v[248:249], v[248:249], v[20:21], v[20:21] op_sel_hi:[1,0,0]
v_pk_fma_f32 v[250:251], v[250:251], v[20:21], v[20:21] op_sel_hi:[1,0,0]
v_rcp_f32 v248, v248
v_rcp_f32 v249, v249
ds_read_b128 v[168:171], v15 offset:8192
buffer_load_dwordx4 a[40:43], v12, s[4:7], s20 offen offset:2048
buffer_load_dwordx4 a[44:47], v13, s[4:7], s20 offen offset:2048
s_waitcnt lgkmcnt(3)
v_mfma_f32_32x32x16_bf16 v[152:167], v[172:175], v[44:47], v[152:167]
v_rcp_f32 v250, v250
v_rcp_f32 v251, v251
v_pk_mul_f32 v[108:109], v[108:109], v[248:249]
v_pk_mul_f32 v[110:111], v[110:111], v[250:251]
v_cvt_pk_bf16_f32 v238, v108, v109
v_cvt_pk_bf16_f32 v239, v110, v111
ds_read_b128 v[172:175], v15 offset:9216
s_add_u32 s20, s20, 4096
buffer_load_dwordx4 a[48:51], v12, s[4:7], s20 offen offset:0
buffer_load_dwordx4 a[52:55], v13, s[4:7], s20 offen offset:0
s_waitcnt lgkmcnt(3)
v_mfma_f32_32x32x16_bf16 v[152:167], v[176:179], v[48:51], v[152:167]
v_pk_fma_f32 v[112:113], v[18:19], v[212:213], v[112:113] op_sel_hi:[0,1,1]
v_pk_fma_f32 v[114:115], v[18:19], v[214:215], v[114:115] op_sel_hi:[0,1,1]
v_pk_mul_f32 v[244:245], v[22:23], v[112:113] op_sel_hi:[0,1]
v_pk_mul_f32 v[246:247], v[22:23], v[114:115] op_sel_hi:[0,1]
v_exp_f32 v244, v244
v_exp_f32 v245, v245
ds_read_b128 v[176:179], v15 offset:10240
buffer_load_dwordx4 a[56:59], v12, s[4:7], s20 offen offset:2048
buffer_load_dwordx4 a[60:63], v13, s[4:7], s20 offen offset:2048
s_waitcnt lgkmcnt(3)
v_mfma_f32_32x32x16_bf16 v[152:167], v[180:183], v[52:55], v[152:167]
v_exp_f32 v246, v246
v_exp_f32 v247, v247
v_pk_fma_f32 v[244:245], v[244:245], v[20:21], v[20:21] op_sel_hi:[1,0,0]
v_pk_fma_f32 v[246:247], v[246:247], v[20:21], v[20:21] op_sel_hi:[1,0,0]
v_rcp_f32 v244, v244
v_rcp_f32 v245, v245
ds_read_b128 v[180:183], v15 offset:11264
s_add_u32 s20, s20, 4096
buffer_load_dwordx4 a[64:67], v12, s[4:7], s20 offen offset:0
buffer_load_dwordx4 a[68:71], v13, s[4:7], s20 offen offset:0
s_waitcnt lgkmcnt(3)
v_mfma_f32_32x32x16_bf16 v[152:167], v[168:171], v[56:59], v[152:167]
v_rcp_f32 v246, v246
v_rcp_f32 v247, v247
v_pk_mul_f32 v[112:113], v[112:113], v[244:245]
v_pk_mul_f32 v[114:115], v[114:115], v[246:247]
v_cvt_pk_bf16_f32 v240, v112, v113
v_cvt_pk_bf16_f32 v241, v114, v115
ds_read_b128 v[168:171], v15 offset:12288
buffer_load_dwordx4 a[72:75], v12, s[4:7], s20 offen offset:2048
buffer_load_dwordx4 a[76:79], v13, s[4:7], s20 offen offset:2048
s_waitcnt lgkmcnt(3)
v_mfma_f32_32x32x16_bf16 v[152:167], v[172:175], v[60:63], v[152:167]
v_pk_fma_f32 v[116:117], v[18:19], v[216:217], v[116:117] op_sel_hi:[0,1,1]
v_pk_fma_f32 v[118:119], v[18:19], v[218:219], v[118:119] op_sel_hi:[0,1,1]
v_pk_mul_f32 v[248:249], v[22:23], v[116:117] op_sel_hi:[0,1]
v_pk_mul_f32 v[250:251], v[22:23], v[118:119] op_sel_hi:[0,1]
v_exp_f32 v248, v248
v_exp_f32 v249, v249
ds_read_b128 v[172:175], v15 offset:13312
s_add_u32 s20, s20, 4096
buffer_load_dwordx4 a[80:83], v12, s[4:7], s20 offen offset:0
buffer_load_dwordx4 a[84:87], v13, s[4:7], s20 offen offset:0
s_waitcnt lgkmcnt(3)
v_mfma_f32_32x32x16_bf16 v[152:167], v[176:179], v[64:67], v[152:167]
v_exp_f32 v250, v250
v_exp_f32 v251, v251
v_pk_fma_f32 v[248:249], v[248:249], v[20:21], v[20:21] op_sel_hi:[1,0,0]
v_pk_fma_f32 v[250:251], v[250:251], v[20:21], v[20:21] op_sel_hi:[1,0,0]
v_rcp_f32 v248, v248
v_rcp_f32 v249, v249
ds_read_b128 v[176:179], v15 offset:14336
buffer_load_dwordx4 a[88:91], v12, s[4:7], s20 offen offset:2048
buffer_load_dwordx4 a[92:95], v13, s[4:7], s20 offen offset:2048
s_waitcnt lgkmcnt(3)
v_mfma_f32_32x32x16_bf16 v[152:167], v[180:183], v[68:71], v[152:167]
v_rcp_f32 v250, v250
v_rcp_f32 v251, v251
v_pk_mul_f32 v[116:117], v[116:117], v[248:249]
v_pk_mul_f32 v[118:119], v[118:119], v[250:251]
v_cvt_pk_bf16_f32 v242, v116, v117
v_cvt_pk_bf16_f32 v243, v118, v119
ds_read_b128 v[180:183], v15 offset:15360
s_add_u32 s20, s20, 4096
buffer_load_dwordx4 a[96:99], v12, s[4:7], s20 offen offset:0
buffer_load_dwordx4 a[100:103], v13, s[4:7], s20 offen offset:0
s_waitcnt lgkmcnt(3)
v_mfma_f32_32x32x16_bf16 v[152:167], v[168:171], v[72:75], v[152:167]
buffer_store_dwordx4 v[236:239], v1, s[4:7], s27 offen offset:0 sc1
buffer_store_dwordx4 v[240:243], v1, s[4:7], s27 offen offset:1024 sc1
ds_read_b128 v[204:207], v14 offset:256
ds_read_b128 v[208:211], v14 offset:288
ds_read_b128 v[212:215], v14 offset:320
ds_read_b128 v[216:219], v14 offset:352
v_pk_fma_f32 v[120:121], v[18:19], v[220:221], v[120:121] op_sel_hi:[0,1,1]
v_pk_fma_f32 v[122:123], v[18:19], v[222:223], v[122:123] op_sel_hi:[0,1,1]
v_pk_mul_f32 v[244:245], v[22:23], v[120:121] op_sel_hi:[0,1]
v_pk_mul_f32 v[246:247], v[22:23], v[122:123] op_sel_hi:[0,1]
v_exp_f32 v244, v244
v_exp_f32 v245, v245
ds_read_b128 v[168:171], v15 offset:16384
buffer_load_dwordx4 a[104:107], v12, s[4:7], s20 offen offset:2048
buffer_load_dwordx4 a[108:111], v13, s[4:7], s20 offen offset:2048
s_waitcnt lgkmcnt(7)
v_mfma_f32_32x32x16_bf16 v[152:167], v[172:175], v[76:79], v[152:167]
v_exp_f32 v246, v246
v_exp_f32 v247, v247
v_pk_fma_f32 v[244:245], v[244:245], v[20:21], v[20:21] op_sel_hi:[1,0,0]
v_pk_fma_f32 v[246:247], v[246:247], v[20:21], v[20:21] op_sel_hi:[1,0,0]
v_rcp_f32 v244, v244
v_rcp_f32 v245, v245
ds_read_b128 v[172:175], v15 offset:17408
s_add_u32 s20, s20, 4096
buffer_load_dwordx4 a[112:115], v12, s[4:7], s20 offen offset:0
buffer_load_dwordx4 a[116:119], v13, s[4:7], s20 offen offset:0
s_waitcnt lgkmcnt(7)
v_mfma_f32_32x32x16_bf16 v[152:167], v[176:179], v[80:83], v[152:167]
v_rcp_f32 v246, v246
v_rcp_f32 v247, v247
v_pk_mul_f32 v[120:121], v[120:121], v[244:245]
v_pk_mul_f32 v[122:123], v[122:123], v[246:247]
v_cvt_pk_bf16_f32 v236, v120, v121
v_cvt_pk_bf16_f32 v237, v122, v123
ds_read_b128 v[176:179], v15 offset:18432
buffer_load_dwordx4 a[120:123], v12, s[4:7], s20 offen offset:2048
buffer_load_dwordx4 a[124:127], v13, s[4:7], s20 offen offset:2048
s_waitcnt lgkmcnt(7)
v_mfma_f32_32x32x16_bf16 v[152:167], v[180:183], v[84:87], v[152:167]
v_pk_fma_f32 v[124:125], v[18:19], v[224:225], v[124:125] op_sel_hi:[0,1,1]
v_pk_fma_f32 v[126:127], v[18:19], v[226:227], v[126:127] op_sel_hi:[0,1,1]
v_pk_mul_f32 v[248:249], v[22:23], v[124:125] op_sel_hi:[0,1]
v_pk_mul_f32 v[250:251], v[22:23], v[126:127] op_sel_hi:[0,1]
v_exp_f32 v248, v248
v_exp_f32 v249, v249
ds_read_b128 v[180:183], v15 offset:19456
s_add_u32 s20, s20, 4096
buffer_load_dwordx4 a[128:131], v12, s[4:7], s20 offen offset:0
buffer_load_dwordx4 a[132:135], v13, s[4:7], s20 offen offset:0
s_waitcnt lgkmcnt(3)
v_mfma_f32_32x32x16_bf16 v[152:167], v[168:171], v[88:91], v[152:167]
v_exp_f32 v250, v250
v_exp_f32 v251, v251
v_pk_fma_f32 v[248:249], v[248:249], v[20:21], v[20:21] op_sel_hi:[1,0,0]
v_pk_fma_f32 v[250:251], v[250:251], v[20:21], v[20:21] op_sel_hi:[1,0,0]
v_rcp_f32 v248, v248
v_rcp_f32 v249, v249
ds_read_b128 v[168:171], v15 offset:20480
buffer_load_dwordx4 a[136:139], v12, s[4:7], s20 offen offset:2048
buffer_load_dwordx4 a[140:143], v13, s[4:7], s20 offen offset:2048
s_waitcnt lgkmcnt(3)
v_mfma_f32_32x32x16_bf16 v[152:167], v[172:175], v[92:95], v[152:167]
v_rcp_f32 v250, v250
v_rcp_f32 v251, v251
v_pk_mul_f32 v[124:125], v[124:125], v[248:249]
v_pk_mul_f32 v[126:127], v[126:127], v[250:251]
v_cvt_pk_bf16_f32 v238, v124, v125
v_cvt_pk_bf16_f32 v239, v126, v127
ds_read_b128 v[172:175], v15 offset:21504
s_add_u32 s20, s20, 4096
buffer_load_dwordx4 a[144:147], v12, s[4:7], s20 offen offset:0
buffer_load_dwordx4 a[148:151], v13, s[4:7], s20 offen offset:0
s_waitcnt lgkmcnt(3)
v_mfma_f32_32x32x16_bf16 v[152:167], v[176:179], v[96:99], v[152:167]
v_pk_fma_f32 v[128:129], v[18:19], v[228:229], v[128:129] op_sel_hi:[0,1,1]
v_pk_fma_f32 v[130:131], v[18:19], v[230:231], v[130:131] op_sel_hi:[0,1,1]
v_pk_mul_f32 v[244:245], v[22:23], v[128:129] op_sel_hi:[0,1]
v_pk_mul_f32 v[246:247], v[22:23], v[130:131] op_sel_hi:[0,1]
v_exp_f32 v244, v244
v_exp_f32 v245, v245
ds_read_b128 v[176:179], v15 offset:22528
buffer_load_dwordx4 a[152:155], v12, s[4:7], s20 offen offset:2048
buffer_load_dwordx4 a[156:159], v13, s[4:7], s20 offen offset:2048
s_waitcnt lgkmcnt(3)
v_mfma_f32_32x32x16_bf16 v[152:167], v[180:183], v[100:103], v[152:167]
v_exp_f32 v246, v246
v_exp_f32 v247, v247
v_pk_fma_f32 v[244:245], v[244:245], v[20:21], v[20:21] op_sel_hi:[1,0,0]
v_pk_fma_f32 v[246:247], v[246:247], v[20:21], v[20:21] op_sel_hi:[1,0,0]
v_rcp_f32 v244, v244
v_rcp_f32 v245, v245
ds_read_b128 v[180:183], v15 offset:23552
s_add_u32 s20, s20, 4096
buffer_load_dwordx4 a[160:163], v12, s[4:7], s20 offen offset:0
buffer_load_dwordx4 a[164:167], v13, s[4:7], s20 offen offset:0
s_waitcnt lgkmcnt(3)
v_mfma_f32_32x32x16_bf16 v[152:167], v[168:171], a[224:227], v[152:167]
v_rcp_f32 v246, v246
v_rcp_f32 v247, v247
v_pk_mul_f32 v[128:129], v[128:129], v[244:245]
v_pk_mul_f32 v[130:131], v[130:131], v[246:247]
v_cvt_pk_bf16_f32 v240, v128, v129
v_cvt_pk_bf16_f32 v241, v130, v131
ds_read_b128 v[168:171], v15 offset:24576
buffer_load_dwordx4 a[168:171], v12, s[4:7], s20 offen offset:2048
buffer_load_dwordx4 a[172:175], v13, s[4:7], s20 offen offset:2048
s_waitcnt lgkmcnt(3)
v_mfma_f32_32x32x16_bf16 v[152:167], v[172:175], a[228:231], v[152:167]
v_pk_fma_f32 v[132:133], v[18:19], v[232:233], v[132:133] op_sel_hi:[0,1,1]
v_pk_fma_f32 v[134:135], v[18:19], v[234:235], v[134:135] op_sel_hi:[0,1,1]
v_pk_mul_f32 v[248:249], v[22:23], v[132:133] op_sel_hi:[0,1]
v_pk_mul_f32 v[250:251], v[22:23], v[134:135] op_sel_hi:[0,1]
v_exp_f32 v248, v248
v_exp_f32 v249, v249
ds_read_b128 v[172:175], v15 offset:25600
s_add_u32 s20, s20, 4096
buffer_load_dwordx4 a[176:179], v12, s[4:7], s20 offen offset:0
buffer_load_dwordx4 a[180:183], v13, s[4:7], s20 offen offset:0
s_waitcnt lgkmcnt(3)
v_mfma_f32_32x32x16_bf16 v[152:167], v[176:179], a[232:235], v[152:167]
v_exp_f32 v250, v250
v_exp_f32 v251, v251
v_pk_fma_f32 v[248:249], v[248:249], v[20:21], v[20:21] op_sel_hi:[1,0,0]
v_pk_fma_f32 v[250:251], v[250:251], v[20:21], v[20:21] op_sel_hi:[1,0,0]
v_rcp_f32 v248, v248
v_rcp_f32 v249, v249
ds_read_b128 v[176:179], v15 offset:26624
buffer_load_dwordx4 a[184:187], v12, s[4:7], s20 offen offset:2048
buffer_load_dwordx4 a[188:191], v13, s[4:7], s20 offen offset:2048
s_waitcnt lgkmcnt(3)
v_mfma_f32_32x32x16_bf16 v[152:167], v[180:183], a[236:239], v[152:167]
v_rcp_f32 v250, v250
v_rcp_f32 v251, v251
v_pk_mul_f32 v[132:133], v[132:133], v[248:249]
v_pk_mul_f32 v[134:135], v[134:135], v[250:251]
v_cvt_pk_bf16_f32 v242, v132, v133
v_cvt_pk_bf16_f32 v243, v134, v135
ds_read_b128 v[180:183], v15 offset:27648
s_add_u32 s20, s20, 4096
buffer_load_dwordx4 a[192:195], v12, s[4:7], s20 offen offset:0
buffer_load_dwordx4 a[196:199], v13, s[4:7], s20 offen offset:0
s_waitcnt lgkmcnt(3)
v_mfma_f32_32x32x16_bf16 v[152:167], v[168:171], a[240:243], v[152:167]
buffer_store_dwordx4 v[236:239], v1, s[4:7], s27 offen offset:2048 sc1
buffer_store_dwordx4 v[240:243], v1, s[4:7], s27 offen offset:3072 sc1
ds_read_b128 v[220:223], v14 offset:384
ds_read_b128 v[224:227], v14 offset:416
ds_read_b128 v[228:231], v14 offset:448
ds_read_b128 v[232:235], v14 offset:480
v_pk_fma_f32 v[136:137], v[18:19], v[204:205], v[136:137] op_sel_hi:[0,1,1]
v_pk_fma_f32 v[138:139], v[18:19], v[206:207], v[138:139] op_sel_hi:[0,1,1]
v_pk_mul_f32 v[244:245], v[22:23], v[136:137] op_sel_hi:[0,1]
v_pk_mul_f32 v[246:247], v[22:23], v[138:139] op_sel_hi:[0,1]
v_exp_f32 v244, v244
v_exp_f32 v245, v245
buffer_load_dwordx4 a[200:203], v12, s[4:7], s20 offen offset:2048
buffer_load_dwordx4 a[204:207], v13, s[4:7], s20 offen offset:2048
s_waitcnt lgkmcnt(6)
v_mfma_f32_32x32x16_bf16 v[152:167], v[172:175], a[244:247], v[152:167]
v_exp_f32 v246, v246
v_exp_f32 v247, v247
v_pk_fma_f32 v[244:245], v[244:245], v[20:21], v[20:21] op_sel_hi:[1,0,0]
v_pk_fma_f32 v[246:247], v[246:247], v[20:21], v[20:21] op_sel_hi:[1,0,0]
v_rcp_f32 v244, v244
v_rcp_f32 v245, v245
s_add_u32 s20, s20, 4096
buffer_load_dwordx4 a[208:211], v12, s[4:7], s20 offen offset:0
buffer_load_dwordx4 a[212:215], v13, s[4:7], s20 offen offset:0
s_waitcnt lgkmcnt(5)
v_mfma_f32_32x32x16_bf16 v[152:167], v[176:179], a[248:251], v[152:167]
v_rcp_f32 v246, v246
v_rcp_f32 v247, v247
v_pk_mul_f32 v[136:137], v[136:137], v[244:245]
v_pk_mul_f32 v[138:139], v[138:139], v[246:247]
v_cvt_pk_bf16_f32 v236, v136, v137
v_cvt_pk_bf16_f32 v237, v138, v139
buffer_load_dwordx4 a[216:219], v12, s[4:7], s20 offen offset:2048
buffer_load_dwordx4 a[220:223], v13, s[4:7], s20 offen offset:2048
s_waitcnt lgkmcnt(4)
v_mfma_f32_32x32x16_bf16 v[152:167], v[180:183], a[252:255], v[152:167]
v_pk_fma_f32 v[140:141], v[18:19], v[208:209], v[140:141] op_sel_hi:[0,1,1]
v_pk_fma_f32 v[142:143], v[18:19], v[210:211], v[142:143] op_sel_hi:[0,1,1]
v_pk_mul_f32 v[248:249], v[22:23], v[140:141] op_sel_hi:[0,1]
v_pk_mul_f32 v[250:251], v[22:23], v[142:143] op_sel_hi:[0,1]
v_exp_f32 v248, v248
v_exp_f32 v249, v249
v_exp_f32 v250, v250
v_exp_f32 v251, v251
v_pk_fma_f32 v[248:249], v[248:249], v[20:21], v[20:21] op_sel_hi:[1,0,0]
v_pk_fma_f32 v[250:251], v[250:251], v[20:21], v[20:21] op_sel_hi:[1,0,0]
v_rcp_f32 v248, v248
v_rcp_f32 v249, v249
v_rcp_f32 v250, v250
v_rcp_f32 v251, v251
v_pk_mul_f32 v[140:141], v[140:141], v[248:249]
v_pk_mul_f32 v[142:143], v[142:143], v[250:251]
v_cvt_pk_bf16_f32 v238, v140, v141
v_cvt_pk_bf16_f32 v239, v142, v143
v_pk_fma_f32 v[144:145], v[18:19], v[212:213], v[144:145] op_sel_hi:[0,1,1]
v_pk_fma_f32 v[146:147], v[18:19], v[214:215], v[146:147] op_sel_hi:[0,1,1]
v_pk_mul_f32 v[244:245], v[22:23], v[144:145] op_sel_hi:[0,1]
v_pk_mul_f32 v[246:247], v[22:23], v[146:147] op_sel_hi:[0,1]
v_exp_f32 v244, v244
v_exp_f32 v245, v245
v_exp_f32 v246, v246
v_exp_f32 v247, v247
v_pk_fma_f32 v[244:245], v[244:245], v[20:21], v[20:21] op_sel_hi:[1,0,0]
v_pk_fma_f32 v[246:247], v[246:247], v[20:21], v[20:21] op_sel_hi:[1,0,0]
v_rcp_f32 v244, v244
v_rcp_f32 v245, v245
v_rcp_f32 v246, v246
v_rcp_f32 v247, v247
v_pk_mul_f32 v[144:145], v[144:145], v[244:245]
v_pk_mul_f32 v[146:147], v[146:147], v[246:247]
v_cvt_pk_bf16_f32 v240, v144, v145
v_cvt_pk_bf16_f32 v241, v146, v147
v_pk_fma_f32 v[148:149], v[18:19], v[216:217], v[148:149] op_sel_hi:[0,1,1]
v_pk_fma_f32 v[150:151], v[18:19], v[218:219], v[150:151] op_sel_hi:[0,1,1]
v_pk_mul_f32 v[248:249], v[22:23], v[148:149] op_sel_hi:[0,1]
v_pk_mul_f32 v[250:251], v[22:23], v[150:151] op_sel_hi:[0,1]
v_exp_f32 v248, v248
v_exp_f32 v249, v249
v_exp_f32 v250, v250
v_exp_f32 v251, v251
v_pk_fma_f32 v[248:249], v[248:249], v[20:21], v[20:21] op_sel_hi:[1,0,0]
v_pk_fma_f32 v[250:251], v[250:251], v[20:21], v[20:21] op_sel_hi:[1,0,0]
v_rcp_f32 v248, v248
v_rcp_f32 v249, v249
v_rcp_f32 v250, v250
v_rcp_f32 v251, v251
v_pk_mul_f32 v[148:149], v[148:149], v[248:249]
v_pk_mul_f32 v[150:151], v[150:151], v[250:251]
v_cvt_pk_bf16_f32 v242, v148, v149
v_cvt_pk_bf16_f32 v243, v150, v151
buffer_store_dwordx4 v[236:239], v1, s[4:7], s26 offen offset:0 sc1
buffer_store_dwordx4 v[240:243], v1, s[4:7], s26 offen offset:1024 sc1
s_waitcnt lgkmcnt(0)
v_pk_fma_f32 v[152:153], v[18:19], v[220:221], v[152:153] op_sel_hi:[0,1,1]
v_pk_fma_f32 v[154:155], v[18:19], v[222:223], v[154:155] op_sel_hi:[0,1,1]
v_pk_mul_f32 v[244:245], v[22:23], v[152:153] op_sel_hi:[0,1]
v_pk_mul_f32 v[246:247], v[22:23], v[154:155] op_sel_hi:[0,1]
v_exp_f32 v244, v244
v_exp_f32 v245, v245
v_exp_f32 v246, v246
v_exp_f32 v247, v247
v_pk_fma_f32 v[244:245], v[244:245], v[20:21], v[20:21] op_sel_hi:[1,0,0]
v_pk_fma_f32 v[246:247], v[246:247], v[20:21], v[20:21] op_sel_hi:[1,0,0]
v_rcp_f32 v244, v244
v_rcp_f32 v245, v245
v_rcp_f32 v246, v246
v_rcp_f32 v247, v247
v_pk_mul_f32 v[152:153], v[152:153], v[244:245]
v_pk_mul_f32 v[154:155], v[154:155], v[246:247]
v_cvt_pk_bf16_f32 v236, v152, v153
v_cvt_pk_bf16_f32 v237, v154, v155
v_pk_fma_f32 v[156:157], v[18:19], v[224:225], v[156:157] op_sel_hi:[0,1,1]
v_pk_fma_f32 v[158:159], v[18:19], v[226:227], v[158:159] op_sel_hi:[0,1,1]
v_pk_mul_f32 v[248:249], v[22:23], v[156:157] op_sel_hi:[0,1]
v_pk_mul_f32 v[250:251], v[22:23], v[158:159] op_sel_hi:[0,1]
v_exp_f32 v248, v248
v_exp_f32 v249, v249
v_exp_f32 v250, v250
v_exp_f32 v251, v251
v_pk_fma_f32 v[248:249], v[248:249], v[20:21], v[20:21] op_sel_hi:[1,0,0]
v_pk_fma_f32 v[250:251], v[250:251], v[20:21], v[20:21] op_sel_hi:[1,0,0]
v_rcp_f32 v248, v248
v_rcp_f32 v249, v249
v_rcp_f32 v250, v250
v_rcp_f32 v251, v251
v_pk_mul_f32 v[156:157], v[156:157], v[248:249]
v_pk_mul_f32 v[158:159], v[158:159], v[250:251]
v_cvt_pk_bf16_f32 v238, v156, v157
v_cvt_pk_bf16_f32 v239, v158, v159
v_pk_fma_f32 v[160:161], v[18:19], v[228:229], v[160:161] op_sel_hi:[0,1,1]
v_pk_fma_f32 v[162:163], v[18:19], v[230:231], v[162:163] op_sel_hi:[0,1,1]
v_pk_mul_f32 v[244:245], v[22:23], v[160:161] op_sel_hi:[0,1]
v_pk_mul_f32 v[246:247], v[22:23], v[162:163] op_sel_hi:[0,1]
v_exp_f32 v244, v244
v_exp_f32 v245, v245
v_exp_f32 v246, v246
v_exp_f32 v247, v247
v_pk_fma_f32 v[244:245], v[244:245], v[20:21], v[20:21] op_sel_hi:[1,0,0]
v_pk_fma_f32 v[246:247], v[246:247], v[20:21], v[20:21] op_sel_hi:[1,0,0]
v_rcp_f32 v244, v244
v_rcp_f32 v245, v245
v_rcp_f32 v246, v246
v_rcp_f32 v247, v247
v_pk_mul_f32 v[160:161], v[160:161], v[244:245]
v_pk_mul_f32 v[162:163], v[162:163], v[246:247]
v_cvt_pk_bf16_f32 v240, v160, v161
v_cvt_pk_bf16_f32 v241, v162, v163
v_pk_fma_f32 v[164:165], v[18:19], v[232:233], v[164:165] op_sel_hi:[0,1,1]
v_pk_fma_f32 v[166:167], v[18:19], v[234:235], v[166:167] op_sel_hi:[0,1,1]
v_pk_mul_f32 v[248:249], v[22:23], v[164:165] op_sel_hi:[0,1]
v_pk_mul_f32 v[250:251], v[22:23], v[166:167] op_sel_hi:[0,1]
v_exp_f32 v248, v248
v_exp_f32 v249, v249
v_exp_f32 v250, v250
v_exp_f32 v251, v251
v_pk_fma_f32 v[248:249], v[248:249], v[20:21], v[20:21] op_sel_hi:[1,0,0]
v_pk_fma_f32 v[250:251], v[250:251], v[20:21], v[20:21] op_sel_hi:[1,0,0]
v_rcp_f32 v248, v248
v_rcp_f32 v249, v249
v_rcp_f32 v250, v250
v_rcp_f32 v251, v251
v_pk_mul_f32 v[164:165], v[164:165], v[248:249]
v_pk_mul_f32 v[166:167], v[166:167], v[250:251]
v_cvt_pk_bf16_f32 v242, v164, v165
v_cvt_pk_bf16_f32 v243, v166, v167
buffer_store_dwordx4 v[236:239], v1, s[4:7], s26 offen offset:2048 sc1
buffer_store_dwordx4 v[240:243], v1, s[4:7], s26 offen offset:3072 sc1
Lb1_87:
s_lshl_b32 s28, s15, 6
s_add_u32 s28, s28, s19
s_lshl_b32 s28, s28, 7
s_lshl_b32 s29, s13, 2
s_add_u32 s28, s28, s29
s_add_u32 s28, s28, 49152
s_waitcnt vmcnt(0)
v_mov_b32 v16, s16
v_mov_b32 v17, 0
s_mov_b64 exec, 1
buffer_store_dword v16, v17, s[4:7], s28 offen sc1
s_mov_b64 exec, -1
s_barrier
s_mul_i32 s26, s14, 7
s_lshr_b32 s26, s26, 1
s_lshl_b32 s26, s26, 2
s_lshl_b32 s28, s15, 6
s_lshl_b32 s29, s12, 2
s_add_u32 s28, s28, s29
s_lshl_b32 s29, s17, 1
s_add_u32 s28, s28, s29
s_lshl_b32 s28, s28, 7
s_add_u32 s28, s28, s26
s_add_u32 s28, s28, 49152
v_and_b32 v12, 3, v0
v_lshlrev_b32 v12, 2, v12
v_bfe_u32 v13, v0, 2, 1
v_lshlrev_b32 v13, 7, v13
v_add_u32 v12, v12, v13
s_mov_b32 s44, 0
buffer_load_dword v16, v12, s[4:7], s28 offen sc1
buffer_load_dword v23, v12, s[4:7], s28 offen sc1
Lpoll_88:
s_waitcnt vmcnt(1)
v_cmp_ne_u32 vcc, s16, v16
s_add_u32 s44, s44, 1
s_cbranch_vccz Lok_89
buffer_load_dword v16, v12, s[4:7], s28 offen sc1
s_waitcnt vmcnt(1)
v_cmp_ne_u32 vcc, s16, v23
s_add_u32 s44, s44, 1
s_cbranch_vccz Lok_89
buffer_load_dword v23, v12, s[4:7], s28 offen sc1
s_cmp_lt_u32 s44, 0x400000
s_cbranch_scc1 Lpoll_88
s_branch interleave_layers__softmax_full_mha__dense_activation_silu__prompt_kernel_abort
Lok_89:
s_mul_i32 s24, s15, 8388608
s_add_u32 s24, s24, 33554432
s_mul_i32 s26, s50, 112
s_mul_i32 s27, s14, 28
s_add_u32 s26, s26, s27
s_lshl_b32 s26, s26, 10
s_add_u32 s25, s24, s26
s_xor_b32 s26, s50, 1
s_mul_i32 s26, s26, 112
s_add_u32 s26, s26, s27
s_lshl_b32 s26, s26, 10
s_add_u32 s24, s24, s26
buffer_load_dwordx4 v[88:91], v1, s[4:7], s25 offen offset:0
buffer_load_dwordx4 v[92:95], v1, s[4:7], s24 offen offset:0
buffer_load_dwordx4 v[96:99], v1, s[4:7], s25 offen offset:1024
buffer_load_dwordx4 v[100:103], v1, s[4:7], s24 offen offset:1024
buffer_load_dwordx4 v[104:107], v1, s[4:7], s25 offen offset:2048
buffer_load_dwordx4 v[108:111], v1, s[4:7], s24 offen offset:2048
buffer_load_dwordx4 v[112:115], v1, s[4:7], s25 offen offset:3072
buffer_load_dwordx4 v[116:119], v1, s[4:7], s24 offen offset:3072
s_add_u32 s24, s24, 4096
s_add_u32 s25, s25, 4096
buffer_load_dwordx4 v[120:123], v1, s[4:7], s25 offen offset:0
buffer_load_dwordx4 v[124:127], v1, s[4:7], s24 offen offset:0
s_waitcnt vmcnt(8)
v_mfma_f32_32x32x16_bf16 v[24:39], a[0:3], v[88:91], 0
v_mfma_f32_32x32x16_bf16 v[40:55], a[4:7], v[88:91], 0
v_mfma_f32_32x32x16_bf16 v[56:71], a[0:3], v[92:95], 0
v_mfma_f32_32x32x16_bf16 v[72:87], a[4:7], v[92:95], 0
buffer_load_dwordx4 v[128:131], v1, s[4:7], s25 offen offset:1024
buffer_load_dwordx4 v[132:135], v1, s[4:7], s24 offen offset:1024
s_waitcnt vmcnt(8)
v_mfma_f32_32x32x16_bf16 v[24:39], a[8:11], v[96:99], v[24:39]
v_mfma_f32_32x32x16_bf16 v[40:55], a[12:15], v[96:99], v[40:55]
v_mfma_f32_32x32x16_bf16 v[56:71], a[8:11], v[100:103], v[56:71]
v_mfma_f32_32x32x16_bf16 v[72:87], a[12:15], v[100:103], v[72:87]
buffer_load_dwordx4 v[136:139], v1, s[4:7], s25 offen offset:2048
buffer_load_dwordx4 v[140:143], v1, s[4:7], s24 offen offset:2048
s_waitcnt vmcnt(8)
v_mfma_f32_32x32x16_bf16 v[24:39], a[16:19], v[104:107], v[24:39]
v_mfma_f32_32x32x16_bf16 v[40:55], a[20:23], v[104:107], v[40:55]
v_mfma_f32_32x32x16_bf16 v[56:71], a[16:19], v[108:111], v[56:71]
v_mfma_f32_32x32x16_bf16 v[72:87], a[20:23], v[108:111], v[72:87]
buffer_load_dwordx4 v[144:147], v1, s[4:7], s25 offen offset:3072
buffer_load_dwordx4 v[148:151], v1, s[4:7], s24 offen offset:3072
s_add_u32 s24, s24, 4096
s_add_u32 s25, s25, 4096
s_waitcnt vmcnt(8)
v_mfma_f32_32x32x16_bf16 v[24:39], a[24:27], v[112:115], v[24:39]
v_mfma_f32_32x32x16_bf16 v[40:55], a[28:31], v[112:115], v[40:55]
v_mfma_f32_32x32x16_bf16 v[56:71], a[24:27], v[116:119], v[56:71]
v_mfma_f32_32x32x16_bf16 v[72:87], a[28:31], v[116:119], v[72:87]
buffer_load_dwordx4 v[152:155], v1, s[4:7], s25 offen offset:0
buffer_load_dwordx4 v[156:159], v1, s[4:7], s24 offen offset:0
s_waitcnt vmcnt(8)
v_mfma_f32_32x32x16_bf16 v[24:39], a[32:35], v[120:123], v[24:39]
v_mfma_f32_32x32x16_bf16 v[40:55], a[36:39], v[120:123], v[40:55]
v_mfma_f32_32x32x16_bf16 v[56:71], a[32:35], v[124:127], v[56:71]
v_mfma_f32_32x32x16_bf16 v[72:87], a[36:39], v[124:127], v[72:87]
buffer_load_dwordx4 v[160:163], v1, s[4:7], s25 offen offset:1024
buffer_load_dwordx4 v[164:167], v1, s[4:7], s24 offen offset:1024
s_waitcnt vmcnt(8)
v_mfma_f32_32x32x16_bf16 v[24:39], a[40:43], v[128:131], v[24:39]
v_mfma_f32_32x32x16_bf16 v[40:55], a[44:47], v[128:131], v[40:55]
v_mfma_f32_32x32x16_bf16 v[56:71], a[40:43], v[132:135], v[56:71]
v_mfma_f32_32x32x16_bf16 v[72:87], a[44:47], v[132:135], v[72:87]
buffer_load_dwordx4 v[168:171], v1, s[4:7], s25 offen offset:2048
buffer_load_dwordx4 v[172:175], v1, s[4:7], s24 offen offset:2048
s_waitcnt vmcnt(8)
v_mfma_f32_32x32x16_bf16 v[24:39], a[48:51], v[136:139], v[24:39]
v_mfma_f32_32x32x16_bf16 v[40:55], a[52:55], v[136:139], v[40:55]
v_mfma_f32_32x32x16_bf16 v[56:71], a[48:51], v[140:143], v[56:71]
v_mfma_f32_32x32x16_bf16 v[72:87], a[52:55], v[140:143], v[72:87]
buffer_load_dwordx4 v[176:179], v1, s[4:7], s25 offen offset:3072
buffer_load_dwordx4 v[180:183], v1, s[4:7], s24 offen offset:3072
s_add_u32 s24, s24, 4096
s_add_u32 s25, s25, 4096
s_waitcnt vmcnt(8)
v_mfma_f32_32x32x16_bf16 v[24:39], a[56:59], v[144:147], v[24:39]
v_mfma_f32_32x32x16_bf16 v[40:55], a[60:63], v[144:147], v[40:55]
v_mfma_f32_32x32x16_bf16 v[56:71], a[56:59], v[148:151], v[56:71]
v_mfma_f32_32x32x16_bf16 v[72:87], a[60:63], v[148:151], v[72:87]
buffer_load_dwordx4 v[184:187], v1, s[4:7], s25 offen offset:0
buffer_load_dwordx4 v[188:191], v1, s[4:7], s24 offen offset:0
s_waitcnt vmcnt(8)
v_mfma_f32_32x32x16_bf16 v[24:39], a[64:67], v[152:155], v[24:39]
v_mfma_f32_32x32x16_bf16 v[40:55], a[68:71], v[152:155], v[40:55]
v_mfma_f32_32x32x16_bf16 v[56:71], a[64:67], v[156:159], v[56:71]
v_mfma_f32_32x32x16_bf16 v[72:87], a[68:71], v[156:159], v[72:87]
buffer_load_dwordx4 v[192:195], v1, s[4:7], s25 offen offset:1024
buffer_load_dwordx4 v[196:199], v1, s[4:7], s24 offen offset:1024
s_waitcnt vmcnt(8)
v_mfma_f32_32x32x16_bf16 v[24:39], a[72:75], v[160:163], v[24:39]
v_mfma_f32_32x32x16_bf16 v[40:55], a[76:79], v[160:163], v[40:55]
v_mfma_f32_32x32x16_bf16 v[56:71], a[72:75], v[164:167], v[56:71]
v_mfma_f32_32x32x16_bf16 v[72:87], a[76:79], v[164:167], v[72:87]
buffer_load_dwordx4 v[200:203], v1, s[4:7], s25 offen offset:2048
buffer_load_dwordx4 v[204:207], v1, s[4:7], s24 offen offset:2048
s_waitcnt vmcnt(8)
v_mfma_f32_32x32x16_bf16 v[24:39], a[80:83], v[168:171], v[24:39]
v_mfma_f32_32x32x16_bf16 v[40:55], a[84:87], v[168:171], v[40:55]
v_mfma_f32_32x32x16_bf16 v[56:71], a[80:83], v[172:175], v[56:71]
v_mfma_f32_32x32x16_bf16 v[72:87], a[84:87], v[172:175], v[72:87]
buffer_load_dwordx4 v[208:211], v1, s[4:7], s25 offen offset:3072
buffer_load_dwordx4 v[212:215], v1, s[4:7], s24 offen offset:3072
s_add_u32 s24, s24, 4096
s_add_u32 s25, s25, 4096
s_waitcnt vmcnt(8)
v_mfma_f32_32x32x16_bf16 v[24:39], a[88:91], v[176:179], v[24:39]
v_mfma_f32_32x32x16_bf16 v[40:55], a[92:95], v[176:179], v[40:55]
v_mfma_f32_32x32x16_bf16 v[56:71], a[88:91], v[180:183], v[56:71]
v_mfma_f32_32x32x16_bf16 v[72:87], a[92:95], v[180:183], v[72:87]
buffer_load_dwordx4 v[88:91], v1, s[4:7], s25 offen offset:0
buffer_load_dwordx4 v[92:95], v1, s[4:7], s24 offen offset:0
s_waitcnt vmcnt(8)
v_mfma_f32_32x32x16_bf16 v[24:39], a[96:99], v[184:187], v[24:39]
v_mfma_f32_32x32x16_bf16 v[40:55], a[100:103], v[184:187], v[40:55]
v_mfma_f32_32x32x16_bf16 v[56:71], a[96:99], v[188:191], v[56:71]
v_mfma_f32_32x32x16_bf16 v[72:87], a[100:103], v[188:191], v[72:87]
buffer_load_dwordx4 v[96:99], v1, s[4:7], s25 offen offset:1024
buffer_load_dwordx4 v[100:103], v1, s[4:7], s24 offen offset:1024
s_waitcnt vmcnt(8)
v_mfma_f32_32x32x16_bf16 v[24:39], a[104:107], v[192:195], v[24:39]
v_mfma_f32_32x32x16_bf16 v[40:55], a[108:111], v[192:195], v[40:55]
v_mfma_f32_32x32x16_bf16 v[56:71], a[104:107], v[196:199], v[56:71]
v_mfma_f32_32x32x16_bf16 v[72:87], a[108:111], v[196:199], v[72:87]
buffer_load_dwordx4 v[104:107], v1, s[4:7], s25 offen offset:2048
buffer_load_dwordx4 v[108:111], v1, s[4:7], s24 offen offset:2048
s_waitcnt vmcnt(8)
v_mfma_f32_32x32x16_bf16 v[24:39], a[112:115], v[200:203], v[24:39]
v_mfma_f32_32x32x16_bf16 v[40:55], a[116:119], v[200:203], v[40:55]
v_mfma_f32_32x32x16_bf16 v[56:71], a[112:115], v[204:207], v[56:71]
v_mfma_f32_32x32x16_bf16 v[72:87], a[116:119], v[204:207], v[72:87]
buffer_load_dwordx4 v[112:115], v1, s[4:7], s25 offen offset:3072
buffer_load_dwordx4 v[116:119], v1, s[4:7], s24 offen offset:3072
s_add_u32 s24, s24, 4096
s_add_u32 s25, s25, 4096
s_waitcnt vmcnt(8)
v_mfma_f32_32x32x16_bf16 v[24:39], a[120:123], v[208:211], v[24:39]
v_mfma_f32_32x32x16_bf16 v[40:55], a[124:127], v[208:211], v[40:55]
v_mfma_f32_32x32x16_bf16 v[56:71], a[120:123], v[212:215], v[56:71]
v_mfma_f32_32x32x16_bf16 v[72:87], a[124:127], v[212:215], v[72:87]
buffer_load_dwordx4 v[120:123], v1, s[4:7], s25 offen offset:0
buffer_load_dwordx4 v[124:127], v1, s[4:7], s24 offen offset:0
s_waitcnt vmcnt(8)
v_mfma_f32_32x32x16_bf16 v[24:39], a[128:131], v[88:91], v[24:39]
v_mfma_f32_32x32x16_bf16 v[40:55], a[132:135], v[88:91], v[40:55]
v_mfma_f32_32x32x16_bf16 v[56:71], a[128:131], v[92:95], v[56:71]
v_mfma_f32_32x32x16_bf16 v[72:87], a[132:135], v[92:95], v[72:87]
buffer_load_dwordx4 v[128:131], v1, s[4:7], s25 offen offset:1024
buffer_load_dwordx4 v[132:135], v1, s[4:7], s24 offen offset:1024
s_waitcnt vmcnt(8)
v_mfma_f32_32x32x16_bf16 v[24:39], a[136:139], v[96:99], v[24:39]
v_mfma_f32_32x32x16_bf16 v[40:55], a[140:143], v[96:99], v[40:55]
v_mfma_f32_32x32x16_bf16 v[56:71], a[136:139], v[100:103], v[56:71]
v_mfma_f32_32x32x16_bf16 v[72:87], a[140:143], v[100:103], v[72:87]
buffer_load_dwordx4 v[136:139], v1, s[4:7], s25 offen offset:2048
buffer_load_dwordx4 v[140:143], v1, s[4:7], s24 offen offset:2048
s_waitcnt vmcnt(8)
v_mfma_f32_32x32x16_bf16 v[24:39], a[144:147], v[104:107], v[24:39]
v_mfma_f32_32x32x16_bf16 v[40:55], a[148:151], v[104:107], v[40:55]
v_mfma_f32_32x32x16_bf16 v[56:71], a[144:147], v[108:111], v[56:71]
v_mfma_f32_32x32x16_bf16 v[72:87], a[148:151], v[108:111], v[72:87]
buffer_load_dwordx4 v[144:147], v1, s[4:7], s25 offen offset:3072
buffer_load_dwordx4 v[148:151], v1, s[4:7], s24 offen offset:3072
s_add_u32 s24, s24, 4096
s_add_u32 s25, s25, 4096
s_waitcnt vmcnt(8)
v_mfma_f32_32x32x16_bf16 v[24:39], a[152:155], v[112:115], v[24:39]
v_mfma_f32_32x32x16_bf16 v[40:55], a[156:159], v[112:115], v[40:55]
v_mfma_f32_32x32x16_bf16 v[56:71], a[152:155], v[116:119], v[56:71]
v_mfma_f32_32x32x16_bf16 v[72:87], a[156:159], v[116:119], v[72:87]
buffer_load_dwordx4 v[152:155], v1, s[4:7], s25 offen offset:0
buffer_load_dwordx4 v[156:159], v1, s[4:7], s24 offen offset:0
s_waitcnt vmcnt(8)
v_mfma_f32_32x32x16_bf16 v[24:39], a[160:163], v[120:123], v[24:39]
v_mfma_f32_32x32x16_bf16 v[40:55], a[164:167], v[120:123], v[40:55]
v_mfma_f32_32x32x16_bf16 v[56:71], a[160:163], v[124:127], v[56:71]
v_mfma_f32_32x32x16_bf16 v[72:87], a[164:167], v[124:127], v[72:87]
buffer_load_dwordx4 v[160:163], v1, s[4:7], s25 offen offset:1024
buffer_load_dwordx4 v[164:167], v1, s[4:7], s24 offen offset:1024
s_waitcnt vmcnt(8)
v_mfma_f32_32x32x16_bf16 v[24:39], a[168:171], v[128:131], v[24:39]
v_mfma_f32_32x32x16_bf16 v[40:55], a[172:175], v[128:131], v[40:55]
v_mfma_f32_32x32x16_bf16 v[56:71], a[168:171], v[132:135], v[56:71]
v_mfma_f32_32x32x16_bf16 v[72:87], a[172:175], v[132:135], v[72:87]
buffer_load_dwordx4 v[168:171], v1, s[4:7], s25 offen offset:2048
buffer_load_dwordx4 v[172:175], v1, s[4:7], s24 offen offset:2048
s_waitcnt vmcnt(8)
v_mfma_f32_32x32x16_bf16 v[24:39], a[176:179], v[136:139], v[24:39]
v_mfma_f32_32x32x16_bf16 v[40:55], a[180:183], v[136:139], v[40:55]
v_mfma_f32_32x32x16_bf16 v[56:71], a[176:179], v[140:143], v[56:71]
v_mfma_f32_32x32x16_bf16 v[72:87], a[180:183], v[140:143], v[72:87]
buffer_load_dwordx4 v[176:179], v1, s[4:7], s25 offen offset:3072
buffer_load_dwordx4 v[180:183], v1, s[4:7], s24 offen offset:3072
s_add_u32 s24, s24, 4096
s_add_u32 s25, s25, 4096
s_waitcnt vmcnt(8)
v_mfma_f32_32x32x16_bf16 v[24:39], a[184:187], v[144:147], v[24:39]
v_mfma_f32_32x32x16_bf16 v[40:55], a[188:191], v[144:147], v[40:55]
v_mfma_f32_32x32x16_bf16 v[56:71], a[184:187], v[148:151], v[56:71]
v_mfma_f32_32x32x16_bf16 v[72:87], a[188:191], v[148:151], v[72:87]
s_cmp_eq_u32 s15, 0
s_cbranch_scc1 Lx20_90
s_waitcnt vmcnt(6)
v_mfma_f32_32x32x16_bf16 v[24:39], a[192:195], v[152:155], v[24:39]
v_mfma_f32_32x32x16_bf16 v[40:55], a[196:199], v[152:155], v[40:55]
v_mfma_f32_32x32x16_bf16 v[56:71], a[192:195], v[156:159], v[56:71]
v_mfma_f32_32x32x16_bf16 v[72:87], a[196:199], v[156:159], v[72:87]
s_waitcnt vmcnt(4)
v_mfma_f32_32x32x16_bf16 v[24:39], a[200:203], v[160:163], v[24:39]
v_mfma_f32_32x32x16_bf16 v[40:55], a[204:207], v[160:163], v[40:55]
v_mfma_f32_32x32x16_bf16 v[56:71], a[200:203], v[164:167], v[56:71]
v_mfma_f32_32x32x16_bf16 v[72:87], a[204:207], v[164:167], v[72:87]
s_waitcnt vmcnt(2)
v_mfma_f32_32x32x16_bf16 v[24:39], a[208:211], v[168:171], v[24:39]
v_mfma_f32_32x32x16_bf16 v[40:55], a[212:215], v[168:171], v[40:55]
v_mfma_f32_32x32x16_bf16 v[56:71], a[208:211], v[172:175], v[56:71]
v_mfma_f32_32x32x16_bf16 v[72:87], a[212:215], v[172:175], v[72:87]
s_waitcnt vmcnt(0)
v_mfma_f32_32x32x16_bf16 v[24:39], a[216:219], v[176:179], v[24:39]
v_mfma_f32_32x32x16_bf16 v[40:55], a[220:223], v[176:179], v[40:55]
v_mfma_f32_32x32x16_bf16 v[56:71], a[216:219], v[180:183], v[56:71]
v_mfma_f32_32x32x16_bf16 v[72:87], a[220:223], v[180:183], v[72:87]
s_branch Lx21_91
Lx20_90:
v_min_u32 v216, 15, v0
v_lshlrev_b32 v216, 7, v216
v_min_u32 v217, 3, v0
v_lshlrev_b32 v217, 7, v217
s_mul_i32 s22, s50, 28
s_lshl_b32 s23, s51, 1
s_add_u32 s22, s22, s23
s_lshl_b32 s22, s22, 10
s_add_u32 s22, s22, 14680064
s_mul_i32 s23, s50, 3584
s_add_u32 s23, s23, 1343488
s_lshr_b32 s21, s51, 1
s_lshl_b32 s21, s21, 9
s_add_u32 s23, s23, s21
buffer_load_dword v16, v216, s[4:7], s22 offen sc1
buffer_load_dword v16, v217, s[4:7], s23 offen sc1
s_waitcnt vmcnt(8)
v_mfma_f32_32x32x16_bf16 v[24:39], a[192:195], v[152:155], v[24:39]
v_mfma_f32_32x32x16_bf16 v[40:55], a[196:199], v[152:155], v[40:55]
v_mfma_f32_32x32x16_bf16 v[56:71], a[192:195], v[156:159], v[56:71]
v_mfma_f32_32x32x16_bf16 v[72:87], a[196:199], v[156:159], v[72:87]
s_waitcnt vmcnt(6)
v_mfma_f32_32x32x16_bf16 v[24:39], a[200:203], v[160:163], v[24:39]
v_mfma_f32_32x32x16_bf16 v[40:55], a[204:207], v[160:163], v[40:55]
v_mfma_f32_32x32x16_bf16 v[56:71], a[200:203], v[164:167], v[56:71]
v_mfma_f32_32x32x16_bf16 v[72:87], a[204:207], v[164:167], v[72:87]
s_waitcnt vmcnt(4)
v_mfma_f32_32x32x16_bf16 v[24:39], a[208:211], v[168:171], v[24:39]
v_mfma_f32_32x32x16_bf16 v[40:55], a[212:215], v[168:171], v[40:55]
v_mfma_f32_32x32x16_bf16 v[56:71], a[208:211], v[172:175], v[56:71]
v_mfma_f32_32x32x16_bf16 v[72:87], a[212:215], v[172:175], v[72:87]
s_waitcnt vmcnt(2)
v_mfma_f32_32x32x16_bf16 v[24:39], a[216:219], v[176:179], v[24:39]
v_mfma_f32_32x32x16_bf16 v[40:55], a[220:223], v[176:179], v[40:55]
v_mfma_f32_32x32x16_bf16 v[56:71], a[216:219], v[180:183], v[56:71]
v_mfma_f32_32x32x16_bf16 v[72:87], a[220:223], v[180:183], v[72:87]
Lx21_91:
s_nop 7
s_nop 3
s_xor_b32 s26, s14, 1
s_mul_i32 s26, s26, 12288
s_add_u32 s26, s26, 86016
v_add_u32 v14, s26, v1
ds_write_b128 v14, v[40:43] offset:0
ds_write_b128 v14, v[44:47] offset:1024
ds_write_b128 v14, v[48:51] offset:2048
ds_write_b128 v14, v[52:55] offset:3072
s_xor_b32 s26, s14, 2
s_mul_i32 s26, s26, 12288
s_add_u32 s26, s26, 90112
v_add_u32 v14, s26, v1
ds_write_b128 v14, v[56:59] offset:0
ds_write_b128 v14, v[60:63] offset:1024
ds_write_b128 v14, v[64:67] offset:2048
ds_write_b128 v14, v[68:71] offset:3072
s_xor_b32 s26, s14, 3
s_mul_i32 s26, s26, 12288
s_add_u32 s26, s26, 94208
v_add_u32 v14, s26, v1
ds_write_b128 v14, v[72:75] offset:0
ds_write_b128 v14, v[76:79] offset:1024
ds_write_b128 v14, v[80:83] offset:2048
ds_write_b128 v14, v[84:87] offset:3072
s_waitcnt lgkmcnt(0)
s_barrier
s_mul_i32 s26, s14, 12288
s_add_u32 s26, s26, 86016
v_add_u32 v14, s26, v1
ds_read_b128 v[88:91], v14 offset:0
ds_read_b128 v[92:95], v14 offset:1024
ds_read_b128 v[96:99], v14 offset:2048
ds_read_b128 v[100:103], v14 offset:3072
ds_read_b128 v[104:107], v14 offset:4096
ds_read_b128 v[108:111], v14 offset:5120
ds_read_b128 v[112:115], v14 offset:6144
ds_read_b128 v[116:119], v14 offset:7168
ds_read_b128 v[120:123], v14 offset:8192
ds_read_b128 v[124:127], v14 offset:9216
ds_read_b128 v[128:131], v14 offset:10240
ds_read_b128 v[132:135], v14 offset:11264
s_waitcnt lgkmcnt(8)
v_pk_add_f32 v[24:25], v[24:25], v[88:89]
v_pk_add_f32 v[26:27], v[26:27], v[90:91]
v_pk_add_f32 v[28:29], v[28:29], v[92:93]
v_pk_add_f32 v[30:31], v[30:31], v[94:95]
v_pk_add_f32 v[32:33], v[32:33], v[96:97]
v_pk_add_f32 v[34:35], v[34:35], v[98:99]
v_pk_add_f32 v[36:37], v[36:37], v[100:101]
v_pk_add_f32 v[38:39], v[38:39], v[102:103]
s_waitcnt lgkmcnt(4)
v_pk_add_f32 v[24:25], v[24:25], v[104:105]
v_pk_add_f32 v[26:27], v[26:27], v[106:107]
v_pk_add_f32 v[28:29], v[28:29], v[108:109]
v_pk_add_f32 v[30:31], v[30:31], v[110:111]
v_pk_add_f32 v[32:33], v[32:33], v[112:113]
v_pk_add_f32 v[34:35], v[34:35], v[114:115]
v_pk_add_f32 v[36:37], v[36:37], v[116:117]
v_pk_add_f32 v[38:39], v[38:39], v[118:119]
s_waitcnt lgkmcnt(0)
v_pk_add_f32 v[24:25], v[24:25], v[120:121]
v_pk_add_f32 v[26:27], v[26:27], v[122:123]
v_pk_add_f32 v[28:29], v[28:29], v[124:125]
v_pk_add_f32 v[30:31], v[30:31], v[126:127]
v_pk_add_f32 v[32:33], v[32:33], v[128:129]
v_pk_add_f32 v[34:35], v[34:35], v[130:131]
v_pk_add_f32 v[36:37], v[36:37], v[132:133]
v_pk_add_f32 v[38:39], v[38:39], v[134:135]
s_cmp_lg_u32 s15, 0
s_cbranch_scc1 Lfin_92
s_mul_i32 s24, s15, 0
s_add_u32 s24, s24, 14680064
s_mul_i32 s25, s15, 0
s_add_u32 s25, s25, 1343488
s_mul_i32 s26, s50, 28
s_lshl_b32 s27, s51, 1
s_add_u32 s26, s26, s27
s_lshl_b32 s26, s26, 10
s_add_u32 s24, s24, s26
s_mul_i32 s26, s50, 3584
s_add_u32 s25, s25, s26
s_lshr_b32 s26, s51, 1
s_lshl_b32 s26, s26, 9
s_add_u32 s25, s25, s26
s_and_b32 s26, s51, 1
s_lshl_b32 s26, s26, 3
s_add_u32 s25, s25, s26
s_mul_i32 s20, s13, 86016
s_mul_i32 s21, s14, 14336
s_add_u32 s20, s20, s21
s_add_u32 s20, s20, 2097152
s_add_u32 s21, s21, 0
s_mov_b32 m0, s21
s_nop 0
buffer_load_dwordx4 v1, s[4:7], s20 offen offset:0 lds
buffer_load_dwordx4 v1, s[4:7], s20 offen offset:1024 lds
s_add_u32 s20, s20, 2048
s_add_u32 s21, s21, 2048
v_lshlrev_b32 v216, 16, v4
v_and_b32 v217, 0xffff0000, v4
v_pk_add_f32 v[24:25], v[24:25], v[216:217]
v_cvt_pk_bf16_f32 v4, v24, v25
s_mov_b32 m0, s21
s_nop 0
buffer_load_dwordx4 v1, s[4:7], s20 offen offset:0 lds
buffer_load_dwordx4 v1, s[4:7], s20 offen offset:1024 lds
s_add_u32 s20, s20, 2048
s_add_u32 s21, s21, 2048
v_lshlrev_b32 v216, 16, v5
v_and_b32 v217, 0xffff0000, v5
v_pk_add_f32 v[26:27], v[26:27], v[216:217]
v_cvt_pk_bf16_f32 v5, v26, v27
s_mov_b32 m0, s21
s_nop 0
buffer_load_dwordx4 v1, s[4:7], s20 offen offset:0 lds
buffer_load_dwordx4 v1, s[4:7], s20 offen offset:1024 lds
s_add_u32 s20, s20, 2048
s_add_u32 s21, s21, 2048
v_lshlrev_b32 v216, 16, v6
v_and_b32 v217, 0xffff0000, v6
v_pk_add_f32 v[28:29], v[28:29], v[216:217]
v_cvt_pk_bf16_f32 v6, v28, v29
s_mov_b32 m0, s21
s_nop 0
buffer_load_dwordx4 v1, s[4:7], s20 offen offset:0 lds
buffer_load_dwordx4 v1, s[4:7], s20 offen offset:1024 lds
s_add_u32 s20, s20, 2048
s_add_u32 s21, s21, 2048
v_lshlrev_b32 v216, 16, v7
v_and_b32 v217, 0xffff0000, v7
v_pk_add_f32 v[30:31], v[30:31], v[216:217]
v_cvt_pk_bf16_f32 v7, v30, v31
s_mov_b32 m0, s21
s_nop 0
buffer_load_dwordx4 v1, s[4:7], s20 offen offset:0 lds
buffer_load_dwordx4 v1, s[4:7], s20 offen offset:1024 lds
s_add_u32 s20, s20, 2048
s_add_u32 s21, s21, 2048
v_lshlrev_b32 v216, 16, v8
v_and_b32 v217, 0xffff0000, v8
v_pk_add_f32 v[32:33], v[32:33], v[216:217]
v_cvt_pk_bf16_f32 v8, v32, v33
s_mov_b32 m0, s21
s_nop 0
buffer_load_dwordx4 v1, s[4:7], s20 offen offset:0 lds
buffer_load_dwordx4 v1, s[4:7], s20 offen offset:1024 lds
s_add_u32 s20, s20, 2048
s_add_u32 s21, s21, 2048
v_lshlrev_b32 v216, 16, v9
v_and_b32 v217, 0xffff0000, v9
v_pk_add_f32 v[34:35], v[34:35], v[216:217]
v_cvt_pk_bf16_f32 v9, v34, v35
s_mov_b32 m0, s21
s_nop 0
buffer_load_dwordx4 v1, s[4:7], s20 offen offset:0 lds
buffer_load_dwordx4 v1, s[4:7], s20 offen offset:1024 lds
s_add_u32 s20, s20, 2048
s_add_u32 s21, s21, 2048
v_lshlrev_b32 v216, 16, v10
v_and_b32 v217, 0xffff0000, v10
v_pk_add_f32 v[36:37], v[36:37], v[216:217]
v_cvt_pk_bf16_f32 v10, v36, v37
v_lshlrev_b32 v216, 16, v11
v_and_b32 v217, 0xffff0000, v11
v_pk_add_f32 v[38:39], v[38:39], v[216:217]
v_cvt_pk_bf16_f32 v11, v38, v39
buffer_store_dwordx4 v[4:7], v1, s[4:7], s24 offen sc1
buffer_store_dwordx4 v[8:11], v1, s[4:7], s24 offen offset:1024 sc1
v_pk_add_f32 v[220:221], v[24:25], v[26:27]
v_pk_mul_f32 v[222:223], v[24:25], v[24:25]
v_pk_fma_f32 v[222:223], v[26:27], v[26:27], v[222:223]
v_pk_add_f32 v[220:221], v[220:221], v[28:29]
v_pk_fma_f32 v[222:223], v[28:29], v[28:29], v[222:223]
v_pk_add_f32 v[220:221], v[220:221], v[30:31]
v_pk_fma_f32 v[222:223], v[30:31], v[30:31], v[222:223]
v_pk_add_f32 v[220:221], v[220:221], v[32:33]
v_pk_fma_f32 v[222:223], v[32:33], v[32:33], v[222:223]
v_pk_add_f32 v[220:221], v[220:221], v[34:35]
v_pk_fma_f32 v[222:223], v[34:35], v[34:35], v[222:223]
v_pk_add_f32 v[220:221], v[220:221], v[36:37]
v_pk_fma_f32 v[222:223], v[36:37], v[36:37], v[222:223]
v_pk_add_f32 v[220:221], v[220:221], v[38:39]
v_pk_fma_f32 v[222:223], v[38:39], v[38:39], v[222:223]
v_add_f32 v218, v220, v221
v_add_f32 v219, v222, v223
v_mov_b32 v216, v218
v_mov_b32 v217, v219
s_nop 0
v_permlane32_swap_b32 v218, v216
v_permlane32_swap_b32 v219, v217
v_add_f32 v218, v218, v216
v_add_f32 v219, v219, v217
v_lshlrev_b32 v12, 4, v3
buffer_store_dwordx2 v[218:219], v12, s[4:7], s25 offen sc1
s_lshl_b32 s28, s50, 7
s_lshl_b32 s29, s51, 2
s_add_u32 s28, s28, s29
s_add_u32 s28, s28, 65536
s_waitcnt vmcnt(0)
v_mov_b32 v16, s16
v_mov_b32 v17, 0
s_mov_b64 exec, 1
buffer_store_dword v16, v17, s[4:7], s28 offen sc1
s_mov_b64 exec, -1
s_barrier
s_mov_b32 s15, 1
s_branch interleave_layers__softmax_full_mha__dense_activation_silu__prompt_kernel_layer
Lfin_92:
v_lshlrev_b32 v216, 16, v4
v_and_b32 v217, 0xffff0000, v4
v_pk_add_f32 v[24:25], v[24:25], v[216:217]
v_cvt_pk_bf16_f32 v4, v24, v25
v_lshlrev_b32 v216, 16, v5
v_and_b32 v217, 0xffff0000, v5
v_pk_add_f32 v[26:27], v[26:27], v[216:217]
v_cvt_pk_bf16_f32 v5, v26, v27
v_lshlrev_b32 v216, 16, v6
v_and_b32 v217, 0xffff0000, v6
v_pk_add_f32 v[28:29], v[28:29], v[216:217]
v_cvt_pk_bf16_f32 v6, v28, v29
v_lshlrev_b32 v216, 16, v7
v_and_b32 v217, 0xffff0000, v7
v_pk_add_f32 v[30:31], v[30:31], v[216:217]
v_cvt_pk_bf16_f32 v7, v30, v31
v_lshlrev_b32 v216, 16, v8
v_and_b32 v217, 0xffff0000, v8
v_pk_add_f32 v[32:33], v[32:33], v[216:217]
v_cvt_pk_bf16_f32 v8, v32, v33
v_lshlrev_b32 v216, 16, v9
v_and_b32 v217, 0xffff0000, v9
v_pk_add_f32 v[34:35], v[34:35], v[216:217]
v_cvt_pk_bf16_f32 v9, v34, v35
v_lshlrev_b32 v216, 16, v10
v_and_b32 v217, 0xffff0000, v10
v_pk_add_f32 v[36:37], v[36:37], v[216:217]
v_cvt_pk_bf16_f32 v10, v36, v37
v_lshlrev_b32 v216, 16, v11
v_and_b32 v217, 0xffff0000, v11
v_pk_add_f32 v[38:39], v[38:39], v[216:217]
v_cvt_pk_bf16_f32 v11, v38, v39
v_mul_u32_u24 v12, 896, v3
v_lshlrev_b32 v13, 4, v2
v_add_u32 v12, v12, v13
s_mul_i32 s26, s50, 28672
s_lshl_b32 s27, s51, 6
s_add_u32 s26, s26, s27
v_permlane32_swap_b32 v4, v6
v_permlane32_swap_b32 v5, v7
v_permlane32_swap_b32 v8, v10
v_permlane32_swap_b32 v9, v11
buffer_store_dwordx4 v[4:7], v12, s[8:11], s26 offen offset:0
buffer_store_dwordx4 v[8:11], v12, s[8:11], s26 offen offset:32
s_branch interleave_layers__softmax_full_mha__dense_activation_silu__prompt_kernel_end
Lskip_65:
s_cmp_lg_u32 s15, 0
s_cbranch_scc1 interleave_layers__softmax_full_mha__dense_activation_silu__prompt_kernel_end
s_waitcnt vmcnt(0) lgkmcnt(0)
s_barrier
s_mul_i32 s20, s13, 86016
s_mul_i32 s21, s14, 14336
s_add_u32 s20, s20, s21
s_add_u32 s20, s20, 2097152
s_add_u32 s21, s21, 0
s_mov_b32 m0, s21
s_nop 0
buffer_load_dwordx4 v1, s[4:7], s20 offen offset:0 lds
buffer_load_dwordx4 v1, s[4:7], s20 offen offset:1024 lds
buffer_load_dwordx4 v1, s[4:7], s20 offen offset:2048 lds
buffer_load_dwordx4 v1, s[4:7], s20 offen offset:3072 lds
s_add_u32 s20, s20, 4096
s_add_u32 s21, s21, 4096
s_mov_b32 m0, s21
s_nop 0
buffer_load_dwordx4 v1, s[4:7], s20 offen offset:0 lds
buffer_load_dwordx4 v1, s[4:7], s20 offen offset:1024 lds
buffer_load_dwordx4 v1, s[4:7], s20 offen offset:2048 lds
buffer_load_dwordx4 v1, s[4:7], s20 offen offset:3072 lds
s_add_u32 s20, s20, 4096
s_add_u32 s21, s21, 4096
s_mov_b32 m0, s21
s_nop 0
buffer_load_dwordx4 v1, s[4:7], s20 offen offset:0 lds
buffer_load_dwordx4 v1, s[4:7], s20 offen offset:1024 lds
buffer_load_dwordx4 v1, s[4:7], s20 offen offset:2048 lds
buffer_load_dwordx4 v1, s[4:7], s20 offen offset:3072 lds
s_add_u32 s20, s20, 4096
s_add_u32 s21, s21, 4096
s_mov_b32 m0, s21
s_nop 0
buffer_load_dwordx4 v1, s[4:7], s20 offen offset:0 lds
buffer_load_dwordx4 v1, s[4:7], s20 offen offset:1024 lds
s_waitcnt vmcnt(0) lgkmcnt(0)
s_barrier
s_mov_b32 s15, 1
s_branch interleave_layers__softmax_full_mha__dense_activation_silu__prompt_kernel_layer
Lfb_67:
s_lshl_b32 s28, s15, 4
s_add_u32 s28, s28, s13
s_lshl_b32 s28, s28, 8
s_add_u32 s28, s28, 0
v_lshlrev_b32 v12, 2, v0
s_mov_b32 s44, 0
buffer_load_dword v16, v12, s[4:7], s28 offen sc1
buffer_load_dword v23, v12, s[4:7], s28 offen sc1
Lpoll_93:
s_waitcnt vmcnt(1)
v_cmp_ne_u32 vcc, s16, v16
s_add_u32 s44, s44, 1
s_cbranch_vccz Lok_94
buffer_load_dword v16, v12, s[4:7], s28 offen sc1
s_waitcnt vmcnt(1)
v_cmp_ne_u32 vcc, s16, v23
s_add_u32 s44, s44, 1
s_cbranch_vccz Lok_94
buffer_load_dword v23, v12, s[4:7], s28 offen sc1
s_cmp_lt_u32 s44, 0x400000
s_cbranch_scc1 Lpoll_93
s_branch interleave_layers__softmax_full_mha__dense_activation_silu__prompt_kernel_abort
Lok_94:
s_mul_i32 s24, s15, 4194304
s_add_u32 s24, s24, 20971520
s_lshl_b32 s26, s13, 18
s_add_u32 s24, s24, s26
v_mov_b32 v204, 0xff800000
s_mov_b32 s25, s24
s_mov_b32 s29, 0
Lfb1_95:
buffer_load_dwordx4 v[88:91], v1, s[4:7], s25 offen
buffer_load_dwordx4 v[92:95], v1, s[4:7], s25 offen offset:1024
s_waitcnt vmcnt(0)
v_mfma_f32_32x32x16_bf16 v[152:167], v[88:91], a[224:227], 0
v_mfma_f32_32x32x16_bf16 v[152:167], v[92:95], a[228:231], v[152:167]
s_nop 11
v_max3_f32 v204, v204, v152, v153
v_max3_f32 v204, v204, v154, v155
v_max3_f32 v204, v204, v156, v157
v_max3_f32 v204, v204, v158, v159
v_max3_f32 v204, v204, v160, v161
v_max3_f32 v204, v204, v162, v163
v_max3_f32 v204, v204, v164, v165
v_max3_f32 v204, v204, v166, v167
s_add_u32 s25, s25, 4096
s_add_u32 s29, s29, 1
s_cmp_lt_u32 s29, 64
s_cbranch_scc1 Lfb1_95
v_mov_b32 v205, v204
s_nop 1
v_permlane32_swap_b32 v204, v205
v_max_f32 v204, v204, v205
v_sub_f32 v204, 0, v204
v_cvt_pk_bf16_f32 v205, v204, v204
v_lshlrev_b32 v206, 16, v205
v_sub_f32 v204, v204, v206
v_cvt_pk_bf16_f32 v206, v204, v204
v_lshlrev_b32 v207, 16, v206
v_sub_f32 v204, v204, v207
v_cvt_pk_bf16_f32 v204, v204, v204
v_and_b32 v205, 0xffff, v205
v_lshl_or_b32 v205, v206, 16, v205
v_and_b32 v204, 0xffff, v204
v_accvgpr_read_b32 v206, a230
v_accvgpr_read_b32 v207, a231
v_cndmask_b32 v206, v206, v205, s[42:43]
v_cndmask_b32 v207, v207, v204, s[42:43]
v_accvgpr_write_b32 a230, v206
v_accvgpr_write_b32 a231, v207
v_mov_b32 v24, 0
v_mov_b32 v25, 0
v_mov_b32 v26, 0
v_mov_b32 v27, 0
v_mov_b32 v28, 0
v_mov_b32 v29, 0
v_mov_b32 v30, 0
v_mov_b32 v31, 0
v_mov_b32 v32, 0
v_mov_b32 v33, 0
v_mov_b32 v34, 0
v_mov_b32 v35, 0
v_mov_b32 v36, 0
v_mov_b32 v37, 0
v_mov_b32 v38, 0
v_mov_b32 v39, 0
s_mov_b32 s25, s24
s_mov_b32 s29, 0
Lfb2_96:
buffer_load_dwordx4 v[88:91], v1, s[4:7], s25 offen offset:0
buffer_load_dwordx4 v[92:95], v1, s[4:7], s25 offen offset:1024
buffer_load_dwordx4 v[96:99], v1, s[4:7], s25 offen offset:2048
buffer_load_dwordx4 v[100:103], v1, s[4:7], s25 offen offset:3072
s_waitcnt vmcnt(0)
v_mfma_f32_32x32x16_bf16 v[152:167], v[88:91], a[224:227], 0
v_mfma_f32_32x32x16_bf16 v[152:167], v[92:95], a[228:231], v[152:167]
s_nop 11
v_exp_f32 v152, v152
v_exp_f32 v153, v153
v_exp_f32 v154, v154
v_exp_f32 v155, v155
v_exp_f32 v156, v156
v_exp_f32 v157, v157
v_exp_f32 v158, v158
v_exp_f32 v159, v159
v_exp_f32 v160, v160
v_exp_f32 v161, v161
v_exp_f32 v162, v162
v_exp_f32 v163, v163
v_exp_f32 v164, v164
v_exp_f32 v165, v165
v_exp_f32 v166, v166
v_exp_f32 v167, v167
v_cvt_pk_bf16_f32 v184, v152, v153
v_cvt_pk_bf16_f32 v185, v154, v155
v_cvt_pk_bf16_f32 v186, v156, v157
v_cvt_pk_bf16_f32 v187, v158, v159
v_cvt_pk_bf16_f32 v188, v160, v161
v_cvt_pk_bf16_f32 v189, v162, v163
v_cvt_pk_bf16_f32 v190, v164, v165
v_cvt_pk_bf16_f32 v191, v166, v167
v_mfma_f32_32x32x16_bf16 v[24:39], v[96:99], v[184:187], v[24:39]
s_nop 0
v_mfma_f32_32x32x16_bf16 v[24:39], v[100:103], v[188:191], v[24:39]
s_add_u32 s25, s25, 4096
s_add_u32 s29, s29, 1
s_cmp_lt_u32 s29, 64
s_nop 7
s_cbranch_scc1 Lfb2_96
s_nop 7
v_mov_b32 v200, v36
v_mov_b32 v201, v36
s_nop 1
v_permlane32_swap_b32 v200, v201
s_nop 1
s_branch Lfbok_68
Lfb_80:
s_lshl_b32 s28, s15, 4
s_add_u32 s28, s28, s13
s_lshl_b32 s28, s28, 8
s_add_u32 s28, s28, 0
v_lshlrev_b32 v12, 2, v0
s_mov_b32 s44, 0
buffer_load_dword v16, v12, s[4:7], s28 offen sc1
buffer_load_dword v23, v12, s[4:7], s28 offen sc1
Lpoll_97:
s_waitcnt vmcnt(1)
v_cmp_ne_u32 vcc, s16, v16
s_add_u32 s44, s44, 1
s_cbranch_vccz Lok_98
buffer_load_dword v16, v12, s[4:7], s28 offen sc1
s_waitcnt vmcnt(1)
v_cmp_ne_u32 vcc, s16, v23
s_add_u32 s44, s44, 1
s_cbranch_vccz Lok_98
buffer_load_dword v23, v12, s[4:7], s28 offen sc1
s_cmp_lt_u32 s44, 0x400000
s_cbranch_scc1 Lpoll_97
s_branch interleave_layers__softmax_full_mha__dense_activation_silu__prompt_kernel_abort
Lok_98:
s_mul_i32 s24, s15, 4194304
s_add_u32 s24, s24, 20971520
s_lshl_b32 s26, s13, 18
s_add_u32 s24, s24, s26
v_mov_b32 v204, 0xff800000
s_mov_b32 s25, s24
s_mov_b32 s29, 0
Lfb1_99:
buffer_load_dwordx4 v[88:91], v1, s[4:7], s25 offen
buffer_load_dwordx4 v[92:95], v1, s[4:7], s25 offen offset:1024
s_waitcnt vmcnt(0)
v_mfma_f32_32x32x16_bf16 v[152:167], v[88:91], a[224:227], 0
v_mfma_f32_32x32x16_bf16 v[152:167], v[92:95], a[228:231], v[152:167]
s_nop 11
v_max3_f32 v204, v204, v152, v153
v_max3_f32 v204, v204, v154, v155
v_max3_f32 v204, v204, v156, v157
v_max3_f32 v204, v204, v158, v159
v_max3_f32 v204, v204, v160, v161
v_max3_f32 v204, v204, v162, v163
v_max3_f32 v204, v204, v164, v165
v_max3_f32 v204, v204, v166, v167
s_add_u32 s25, s25, 4096
s_add_u32 s29, s29, 1
s_cmp_lt_u32 s29, 64
s_cbranch_scc1 Lfb1_99
v_mov_b32 v205, v204
s_nop 1
v_permlane32_swap_b32 v204, v205
v_max_f32 v204, v204, v205
v_sub_f32 v204, 0, v204
v_cvt_pk_bf16_f32 v205, v204, v204
v_lshlrev_b32 v206, 16, v205
v_sub_f32 v204, v204, v206
v_cvt_pk_bf16_f32 v206, v204, v204
v_lshlrev_b32 v207, 16, v206
v_sub_f32 v204, v204, v207
v_cvt_pk_bf16_f32 v204, v204, v204
v_and_b32 v205, 0xffff, v205
v_lshl_or_b32 v205, v206, 16, v205
v_and_b32 v204, 0xffff, v204
v_accvgpr_read_b32 v206, a230
v_accvgpr_read_b32 v207, a231
v_cndmask_b32 v206, v206, v205, s[42:43]
v_cndmask_b32 v207, v207, v204, s[42:43]
v_accvgpr_write_b32 a230, v206
v_accvgpr_write_b32 a231, v207
v_mov_b32 v24, 0
v_mov_b32 v25, 0
v_mov_b32 v26, 0
v_mov_b32 v27, 0
v_mov_b32 v28, 0
v_mov_b32 v29, 0
v_mov_b32 v30, 0
v_mov_b32 v31, 0
v_mov_b32 v32, 0
v_mov_b32 v33, 0
v_mov_b32 v34, 0
v_mov_b32 v35, 0
v_mov_b32 v36, 0
v_mov_b32 v37, 0
v_mov_b32 v38, 0
v_mov_b32 v39, 0
s_mov_b32 s25, s24
s_mov_b32 s29, 0
Lfb2_100:
buffer_load_dwordx4 v[88:91], v1, s[4:7], s25 offen offset:0
buffer_load_dwordx4 v[92:95], v1, s[4:7], s25 offen offset:1024
buffer_load_dwordx4 v[96:99], v1, s[4:7], s25 offen offset:2048
buffer_load_dwordx4 v[100:103], v1, s[4:7], s25 offen offset:3072
s_waitcnt vmcnt(0)
v_mfma_f32_32x32x16_bf16 v[152:167], v[88:91], a[224:227], 0
v_mfma_f32_32x32x16_bf16 v[152:167], v[92:95], a[228:231], v[152:167]
s_nop 11
v_exp_f32 v152, v152
v_exp_f32 v153, v153
v_exp_f32 v154, v154
v_exp_f32 v155, v155
v_exp_f32 v156, v156
v_exp_f32 v157, v157
v_exp_f32 v158, v158
v_exp_f32 v159, v159
v_exp_f32 v160, v160
v_exp_f32 v161, v161
v_exp_f32 v162, v162
v_exp_f32 v163, v163
v_exp_f32 v164, v164
v_exp_f32 v165, v165
v_exp_f32 v166, v166
v_exp_f32 v167, v167
v_cvt_pk_bf16_f32 v184, v152, v153
v_cvt_pk_bf16_f32 v185, v154, v155
v_cvt_pk_bf16_f32 v186, v156, v157
v_cvt_pk_bf16_f32 v187, v158, v159
v_cvt_pk_bf16_f32 v188, v160, v161
v_cvt_pk_bf16_f32 v189, v162, v163
v_cvt_pk_bf16_f32 v190, v164, v165
v_cvt_pk_bf16_f32 v191, v166, v167
v_mfma_f32_32x32x16_bf16 v[24:39], v[96:99], v[184:187], v[24:39]
s_nop 0
v_mfma_f32_32x32x16_bf16 v[24:39], v[100:103], v[188:191], v[24:39]
s_add_u32 s25, s25, 4096
s_add_u32 s29, s29, 1
s_cmp_lt_u32 s29, 64
s_nop 7
s_cbranch_scc1 Lfb2_100
s_nop 7
v_mov_b32 v200, v36
v_mov_b32 v201, v36
s_nop 1
v_permlane32_swap_b32 v200, v201
s_nop 1
s_branch Lfbok_81
interleave_layers__softmax_full_mha__dense_activation_silu__prompt_kernel_abort:
v_mov_b32 v20, 0xdead
v_mov_b32 v21, 4
s_mov_b64 exec, 1
buffer_store_dword v20, v21, s[76:79], 0 offen
s_waitcnt vmcnt(0)
interleave_layers__softmax_full_mha__dense_activation_silu__prompt_kernel_end:
s_endpgm
.section .rodata,"a"
.p2align 6
.amdhsa_kernel interleave_layers__softmax_full_mha__dense_activation_silu__prompt_kernel
  .amdhsa_next_free_vgpr 512
  .amdhsa_next_free_sgpr 102
  .amdhsa_accum_offset 256
  .amdhsa_group_segment_fixed_size 0
  .amdhsa_kernarg_size 72
  .amdhsa_user_sgpr_count 2
  .amdhsa_user_sgpr_kernarg_segment_ptr 1
  .amdhsa_system_sgpr_workgroup_id_x 1
  .amdhsa_float_denorm_mode_32 3
.end_amdhsa_kernel
```
